```python
import torch

def _softmax(x, axis=-1):
    return torch.softmax(x, dim=axis)
def _gelu(x):
    return torch.nn.functional.gelu(x, approximate="tanh")
def _silu(x):
    return torch.nn.functional.silu(x)
def _sigmoid(x):
    return torch.sigmoid(x)
def _layernorm(x, axis=-1, eps=1e-5):
    m = x.mean(dim=axis, keepdim=True)
    v = x.var(dim=axis, keepdim=True, unbiased=False)
    return (x - m) / torch.sqrt(v + eps)
def _scatter_add(tgt, idx, src, axis=0):
    return tgt.clone().index_add_(axis, idx, src)
def _segment_sum(src, seg, n):
    out = torch.zeros((n,) + src.shape[1:], dtype=src.dtype)
    return out.index_add_(0, seg, src)
def _pad(x, pw):
    flat = tuple(v for pair in reversed(pw) for v in pair)
    return torch.nn.functional.pad(x, flat)

kernel_name = 'interleave_layers__mha_block__dense_activation_silu__prompt'

def setup_inputs():

    _w = (lambda a: (lambda t: t.to(torch.bfloat16) if t.is_floating_point() else t)(torch.as_tensor(a)))
    def _A_setup():
        B, S, D, H = 1, 2048, 512, 32
        return {
            "x": _w((lambda *s: torch.randn(*s, dtype=torch.bfloat16) * 0.05)(B, S, D)),
            "wqkv": _w((lambda *s: torch.randn(*s, dtype=torch.bfloat16) * 0.05)(D, 3 * D)),
            "wo": _w((lambda *s: torch.randn(*s, dtype=torch.bfloat16) * 0.05)(D, D)),
        }
    _A_in = _A_setup()

    def _B_setup():
        B, S, D, F = 1, 2048, 512, 1792
        return {
            "x": _w((lambda *s: torch.randn(*s, dtype=torch.bfloat16) * 0.05)(B, S, D)),
            "w1": _w((lambda *s: torch.randn(*s, dtype=torch.bfloat16) * 0.8)(D, F) * (D ** -0.5)),
            "w2": _w((lambda *s: torch.randn(*s, dtype=torch.bfloat16) * 0.2)(F, D) * (F ** -0.5)),
        }
    _B_in = _B_setup()

    return {
        "A_x": _A_in["x"],
        "A_wqkv": _A_in["wqkv"],
        "A_wo": _A_in["wo"],
        "B_x": _B_in["x"],
        "B_w1": _B_in["w1"],
        "B_w2": _B_in["w2"],
    }

def reference(A_x, A_wqkv, A_wo, B_x, B_w1, B_w2):
    def _A_ref(x, wqkv, wo):
        B, S, D = x.shape
        H = 32
        Dh = D // H
        qkv = (lambda x, *d: x.permute(*d))((x @ wqkv).reshape(B, S, 3, H, Dh), 2, 0, 3, 1, 4)
        q, k, v = qkv[0], qkv[1], qkv[2]
        scores = torch.einsum("bhqd,bhkd->bhqk", q, k) * (Dh ** -0.5)
        p = _softmax(scores, axis=-1)
        o = torch.einsum("bhqk,bhkd->bhqd", p, v)
        return (lambda x, *d: x.permute(*d))(o, 0, 2, 1, 3).reshape(B, S, D) @ wo

    def _B_ref(x, w1, w2):
        h = torch.einsum("bsd,df->bsf", x, w1)
        h = _silu(h)
        out = torch.einsum("bsf,fd->bsd", h, w2)
        return out

    x = A_x
    x = x + _A_ref(_layernorm(x, axis=-1), A_wqkv, A_wo)
    x = x + _B_ref(_layernorm(x, axis=-1), B_w1, B_w2)
    x = x + _A_ref(_layernorm(x, axis=-1), A_wqkv, A_wo)
    x = x + _B_ref(_layernorm(x, axis=-1), B_w1, B_w2)
    return x
```

```asm
; @launch grid=(256,1,1) block=(256,1,1) lds=163840
.amdgcn_target "amdgcn-amd-amdhsa--gfx950"
.text
.globl interleave_layers__mha_block__dense_activation_silu__prompt_kernel
.p2align 8
.type interleave_layers__mha_block__dense_activation_silu__prompt_kernel,@function
interleave_layers__mha_block__dense_activation_silu__prompt_kernel:
    s_cmp_ge_u32 s2, 256
    s_cbranch_scc1 L_end
    s_load_dwordx4 s[36:39], s[0:1], 0
    s_load_dwordx2 s[94:95], s[0:1], 16
    s_load_dwordx2 s[90:91], s[0:1], 32
    s_load_dwordx2 s[92:93], s[0:1], 40
    s_load_dwordx4 s[48:51], s[0:1], 48
    s_load_dwordx2 s[52:53], s[0:1], 64
    v_lshrrev_b32 v2, 6, v0
    v_and_b32 v1, 63, v0
    v_readfirstlane_b32 s3, v2
    v_cmp_eq_u32 vcc, 0, v0
    v_lshlrev_b32 v0, 4, v1
    v_mov_b32 v4, 4026531840
    s_and_b32 s4, s2, 7
    s_lshr_b32 s5, s2, 3
    v_cndmask_b32 v4, v4, 0, vcc
    s_getpc_b64 s[22:23]
    s_and_b32 s22, s22, 0xffffff00
    s_lshl_b32 s32, s5, 2
    s_add_u32 s32, s32, s3
    s_lshl_b32 s32, s32, 9
    v_lshl_add_u32 v7, v1, 3, s32
    v_min_u32 v7, CODE_END - CODE_REF - 8, v7
CODE_REF:
    global_load_dwordx2 v[24:25], v7, s[22:23]
    s_and_b32 s54, s4, 1
    s_lshl_b32 s54, s54, 3
    s_and_b32 s96, s5, 7
    s_add_u32 s54, s54, s96
    s_bfe_u32 s55, s5, 0x10003
    s_and_b32 s57, s4, 6
    s_lshr_b32 s96, s5, 4
    s_add_u32 s57, s57, s96
    s_lshl_b32 s57, s57, 3
    s_lshr_b32 s56, s3, 1
    s_lshl_b32 s96, s55, 1
    s_add_u32 s57, s57, s96
    s_and_b32 s96, s3, 1
    s_add_u32 s57, s57, s96
    v_lshrrev_b32 v7, 5, v1
    v_and_b32 v8, 31, v1
    v_xor_b32 v8, v8, v7
    v_lshlrev_b32 v8, 4, v8
    v_lshl_add_u32 v70, v7, 10, v8
    s_lshl_b32 s74, s3, 14
    s_add_u32 s74, s74, 98304
    s_add_u32 s63, s57, 0
    s_lshl_b32 s63, s63, 15
    s_lshl_b32 s22, s56, 9
    s_add_u32 s63, s63, s22
    s_waitcnt lgkmcnt(0)
    s_mov_b32 s16, s36
    s_and_b32 s17, s37, 0xffff
    s_mov_b32 s18, 2097152
    s_mov_b32 s19, 0x20000
    s_add_u32 m0, s74, 0
    v_xor_b32 v72, 0, v70
    buffer_load_dwordx4 v72, s[16:19], s63 offen offset:0  lds
    s_add_u32 s63, s63, 2048
    s_add_u32 m0, s74, 1024
    v_xor_b32 v73, 32, v70
    buffer_load_dwordx4 v73, s[16:19], s63 offen offset:0  lds
    s_add_u32 s63, s63, 2048
    s_add_u32 m0, s74, 2048
    v_xor_b32 v72, 64, v70
    buffer_load_dwordx4 v72, s[16:19], s63 offen offset:0  lds
    s_add_u32 s63, s63, 2048
    s_add_u32 m0, s74, 3072
    v_xor_b32 v73, 96, v70
    buffer_load_dwordx4 v73, s[16:19], s63 offen offset:0  lds
    s_add_u32 s63, s63, 2048
    s_mov_b32 s8, s52
    s_and_b32 s9, s53, 0xffff
    s_mov_b32 s10, 45285376
    s_mov_b32 s11, 0x20000
    s_add_u32 s12, s8, 5177344
    s_addc_u32 s13, s9, 0
    s_mov_b32 s14, 40108032
    s_mov_b32 s15, 0x20000
    s_and_b32 s22, s2, 15
    s_lshl_b32 s22, s22, 13
    s_bfe_u32 s23, s2, 0x10004
    s_mul_i32 s23, s23, 20054016
    s_add_u32 s22, s22, s23
    s_lshr_b32 s46, s2, 5
    s_add_u32 s46, s46, s3
    s_cmp_eq_u32 s46, 0
    s_cselect_b32 s23, 0, 4026531840
    v_or_b32 v7, s23, v0
    v_mov_b32 v20, 0
    v_mov_b32 v21, 0
    v_mov_b32 v22, 0
    v_mov_b32 v23, 0
    buffer_store_dwordx4 v[20:23], v7, s[12:15], s22 offen offset:0 sc1
    buffer_store_dwordx4 v[20:23], v7, s[12:15], s22 offen offset:1024 sc1
    buffer_store_dwordx4 v[20:23], v7, s[12:15], s22 offen offset:2048 sc1
    buffer_store_dwordx4 v[20:23], v7, s[12:15], s22 offen offset:3072 sc1
    s_add_u32 s22, s22, 4096
    buffer_store_dwordx4 v[20:23], v7, s[12:15], s22 offen offset:0 sc1
    buffer_store_dwordx4 v[20:23], v7, s[12:15], s22 offen offset:1024 sc1
    buffer_store_dwordx4 v[20:23], v7, s[12:15], s22 offen offset:2048 sc1
    buffer_store_dwordx4 v[20:23], v7, s[12:15], s22 offen offset:3072 sc1
    s_add_u32 m0, s74, 4096
    v_xor_b32 v72, 128, v70
    buffer_load_dwordx4 v72, s[16:19], s63 offen offset:0  lds
    s_add_u32 s63, s63, 2048
    v_lshrrev_b32 v7, 3, v1
    v_mul_u32_u24 v68, 3072, v7
    s_add_u32 m0, s74, 5120
    v_xor_b32 v73, 160, v70
    buffer_load_dwordx4 v73, s[16:19], s63 offen offset:0  lds
    s_add_u32 s63, s63, 2048
    v_bfe_u32 v7, v1, 4, 1
    v_lshlrev_b32 v7, 2, v7
    s_add_u32 m0, s74, 6144
    v_xor_b32 v72, 192, v70
    buffer_load_dwordx4 v72, s[16:19], s63 offen offset:0  lds
    s_add_u32 s63, s63, 2048
    v_and_b32 v8, 7, v1
    s_add_u32 m0, s74, 7168
    v_xor_b32 v73, 224, v70
    buffer_load_dwordx4 v73, s[16:19], s63 offen offset:0  lds
    s_add_u32 s63, s63, 2048
    v_xor_b32 v7, v7, v8
    v_lshl_add_u32 v68, v7, 4, v68
    s_add_u32 m0, s74, 8192
    v_xor_b32 v72, 0, v70
    buffer_load_dwordx4 v72, s[16:19], s63 offen offset:0  lds
    s_add_u32 s63, s63, 2048
    v_lshrrev_b32 v7, 2, v1
    s_add_u32 m0, s74, 9216
    v_xor_b32 v73, 32, v70
    buffer_load_dwordx4 v73, s[16:19], s63 offen offset:0  lds
    s_add_u32 s63, s63, 2048
    v_mul_u32_u24 v69, 3072, v7
    v_and_b32 v7, 3, v1
    s_add_u32 m0, s74, 10240
    v_xor_b32 v72, 64, v70
    buffer_load_dwordx4 v72, s[16:19], s63 offen offset:0  lds
    s_add_u32 s63, s63, 2048
    v_lshl_add_u32 v69, v7, 4, v69
    s_mov_b32 s28, s38
    s_and_b32 s29, s39, 0xffff
    s_mov_b32 s30, 1572864
    s_mov_b32 s31, 0x20000
    s_add_u32 m0, s74, 11264
    v_xor_b32 v73, 96, v70
    buffer_load_dwordx4 v73, s[16:19], s63 offen offset:0  lds
    s_add_u32 s63, s63, 2048
    s_add_u32 m0, s74, 12288
    v_xor_b32 v72, 128, v70
    buffer_load_dwordx4 v72, s[16:19], s63 offen offset:0  lds
    s_add_u32 s63, s63, 2048
    s_add_u32 m0, s74, 13312
    v_xor_b32 v73, 160, v70
    buffer_load_dwordx4 v73, s[16:19], s63 offen offset:0  lds
    s_add_u32 s63, s63, 2048
    s_mov_b32 s24, s50
    s_and_b32 s25, s51, 0xffff
    s_mov_b32 s26, 256
    s_mov_b32 s27, 0x20000
    s_add_u32 m0, s74, 14336
    v_xor_b32 v72, 192, v70
    buffer_load_dwordx4 v72, s[16:19], s63 offen offset:0  lds
    s_add_u32 s63, s63, 2048
    s_add_u32 m0, s74, 15360
    v_xor_b32 v73, 224, v70
    buffer_load_dwordx4 v73, s[16:19], s63 offen offset:0  lds
    s_add_u32 s63, s63, 2048
    s_add_u32 s22, s3, 0
    s_mul_i32 s23, s22, 3072
    s_mul_i32 s22, s22, 49152
    s_lshl_b32 s32, s54, 6
    s_mov_b32 m0, s23
    s_add_u32 s59, s22, s32
    s_add_u32 s22, s59, s32
    buffer_load_dwordx4 v68, s[28:31], s22 offen offset:0  lds
    v_mov_b32 v3, 1
    v_add_u32 v252, 4096, v0
    v_add_u32 v253, 8192, v0
    v_add_u32 v254, 12288, v0
    s_mov_b32 s7, 1
    s_mov_b32 s6, 0
    s_mov_b32 s20, 0x0000ffff
    s_mov_b32 s21, 0x0000ffff
    s_mov_b32 s34, -1
    s_mov_b32 s35, 0
    s_mov_b32 s47, 5177344
    s_lshl_b32 s50, s2, 2
    s_add_u32 s50, s50, s3
    s_lshl_b32 s50, s50, 7
    s_add_u32 m0, s23, 1024
    s_add_u32 s22, s22, 24576
    buffer_load_dwordx4 v68, s[28:31], s22 offen offset:0  lds
    s_add_u32 s50, s50, 5046272
    s_cmp_eq_u32 s3, 1
    s_cselect_b32 s33, 0, 4026531840
    s_cselect_b32 s39, 1, 0
    s_cselect_b32 s43, 14, 0
    s_cselect_b32 s44, 16, 0
    s_cselect_b32 s45, 32, 0
    s_cselect_b32 s42, 48, 0
    v_mov_b32 v2, s33
    s_add_u32 m0, s23, 2048
    s_add_u32 s59, s59, 2048
    buffer_load_dwordx4 v69, s[28:31], s59 offen offset:0  lds
    s_mul_i32 s96, s56, 49152
    s_add_u32 s22, s3, 16
    s_mul_i32 s23, s22, 3072
    s_mul_i32 s22, s22, 49152
    s_lshl_b32 s32, s54, 6
    s_mov_b32 m0, s23
    s_add_u32 s59, s22, s32
    s_add_u32 s22, s59, s32
    buffer_load_dwordx4 v68, s[28:31], s22 offen offset:0  lds
    s_lshl_b32 s97, s56, 5
    v_lshrrev_b32 v7, 5, v1
    v_bfe_u32 v8, v1, 2, 2
    v_lshl_add_u32 v7, v7, 2, v8
    v_and_b32 v11, 3, v1
    v_lshlrev_b32 v11, 3, v11
    v_bfe_u32 v10, v1, 4, 1
    v_lshl_add_u32 v11, v10, 5, v11
    v_add_u32 v11, s96, v11
    v_xor_b32 v9, s97, v11
    v_lshl_add_u32 v9, v7, 7, v9
    v_bfe_u32 v8, v1, 3, 1
    v_lshl_add_u32 v9, v8, 6, v9
    v_xor_b32 v10, 64, v9
    s_add_u32 m0, s23, 1024
    s_add_u32 s22, s22, 24576
    buffer_load_dwordx4 v68, s[28:31], s22 offen offset:0  lds
    v_lshl_add_u32 v11, v7, 6, v11
    v_add_u32 v11, 2048, v11
    s_lshl_b32 s97, s56, 8
    v_xor_b32 v12, s97, v0
    s_lshl_b32 s96, s3, 14
    s_add_u32 m0, s23, 2048
    s_add_u32 s59, s59, 2048
    buffer_load_dwordx4 v69, s[28:31], s59 offen offset:0  lds
    s_add_u32 s96, s96, 98304
    v_add_u32 v13, s96, v0
    s_xor_b32 s97, s3, 2
    s_lshl_b32 s97, s97, 14
    s_add_u32 s97, s97, 98304
    s_add_u32 s22, s3, 4
    s_mul_i32 s23, s22, 3072
    s_mul_i32 s22, s22, 49152
    s_lshl_b32 s32, s54, 6
    s_mov_b32 m0, s23
    s_add_u32 s59, s22, s32
    s_add_u32 s22, s59, s32
    buffer_load_dwordx4 v68, s[28:31], s22 offen offset:0  lds
    v_add_u32 v14, s97, v0
    v_lshrrev_b32 v7, 4, v12
    v_and_b32 v15, 0x33, v7
    v_bfe_u32 v8, v7, 2, 1
    v_lshl_or_b32 v15, v8, 3, v15
    v_bfe_u32 v8, v7, 3, 1
    v_lshl_or_b32 v15, v8, 2, v15
    v_lshlrev_b32 v15, 4, v15
    s_cmp_lt_u32 s54, 8
    s_cselect_b64 s[98:99], -1, 0
    s_cselect_b32 s58, 0x3eb8aa3b, 1.0
    v_cndmask_b32 v15, v15, v12, s[98:99]
    v_bfe_u32 v7, v1, 4, 1
    v_lshlrev_b32 v16, 16, v7
    s_add_u32 m0, s23, 1024
    s_add_u32 s22, s22, 24576
    buffer_load_dwordx4 v68, s[28:31], s22 offen offset:0  lds
    v_lshrrev_b32 v7, 5, v1
    v_lshl_add_u32 v16, v7, 8, v16
    v_and_b32 v7, 15, v1
    v_lshl_add_u32 v16, v7, 4, v16
    v_mov_b32 v19, 0x3f803f80
    s_add_u32 m0, s23, 2048
    s_add_u32 s59, s59, 2048
    buffer_load_dwordx4 v69, s[28:31], s59 offen offset:0  lds
    s_lshl_b32 s66, s54, 18
    s_lshl_b32 s96, s56, 16
    s_add_u32 s66, s66, s96
    s_lshl_b32 s96, s57, 10
    s_add_u32 s66, s66, s96
    s_add_u32 s22, s3, 20
    s_mul_i32 s23, s22, 3072
    s_mul_i32 s22, s22, 49152
    s_lshl_b32 s32, s54, 6
    s_mov_b32 m0, s23
    s_add_u32 s59, s22, s32
    s_add_u32 s22, s59, s32
    buffer_load_dwordx4 v68, s[28:31], s22 offen offset:0  lds
    s_add_u32 s66, s66, 2228224
    s_add_u32 s67, s66, 131072
    s_lshl_b32 s68, s54, 17
    s_add_u32 s68, s68, s96
    s_lshl_b32 s96, s56, 9
    s_add_u32 s68, s68, s96
    s_add_u32 s68, s68, 6422528
    s_lshl_b32 s69, s54, 9
    s_add_u32 s69, s69, s47
    s_add_u32 s69, s69, 0
    s_and_b32 s96, s54, 7
    s_lshl_b32 s96, s96, 1
    s_lshl_b32 s41, s96, 9
    s_add_u32 s41, s41, s47
    s_add_u32 m0, s23, 1024
    s_add_u32 s22, s22, 24576
    buffer_load_dwordx4 v68, s[28:31], s22 offen offset:0  lds
    s_add_u32 s41, s41, 0
    s_and_b32 s33, s3, 1
    s_lshl_b32 s75, s33, 5
    s_mul_i32 s33, s33, 3072
    v_subrev_u32 v113, s33, v9
    s_add_u32 m0, s23, 2048
    s_add_u32 s59, s59, 2048
    buffer_load_dwordx4 v69, s[28:31], s59 offen offset:0  lds
    v_add_u32 v9, s33, v9
    v_subrev_u32 v114, s33, v10
    v_add_u32 v10, s33, v10
    v_subrev_u32 v115, s33, v11
    v_add_u32 v11, s33, v11
    s_lshl_b32 s84, s2, 2
    s_add_u32 s84, s84, s3
    s_cmp_lt_u32 s84, 128
    s_cselect_b64 s[96:97], s[94:95], s[92:93]
    s_mov_b32 s98, 1835008
    s_cselect_b32 s98, 524288, s98
    s_cselect_b32 s86, 0, 576
    s_mov_b32 s80, 229376
    s_cselect_b32 s80, 65536, s80
    s_mov_b32 s81, 524288
    s_cselect_b32 s81, 0, s81
    s_sub_u32 s86, s84, s86
    s_and_b32 s85, s86, 7
    s_lshr_b32 s86, s86, 3
    s_mul_i32 s80, s85, s80
    s_add_u32 s80, s80, s81
    s_lshl_b32 s81, s86, 12
    s_add_u32 s80, s80, s81
    s_sub_u32 s84, s84, 128
    s_lshr_b32 s82, s84, 4
    s_and_b32 s83, s84, 15
    s_lshl_b32 s81, s82, 16
    s_lshl_b32 s87, s83, 11
    s_add_u32 s81, s81, s87
    s_add_u32 s81, s81, 2359296
    s_cmp_lt_u32 s84, 448
    s_cselect_b64 s[96:97], s[90:91], s[96:97]
    s_cselect_b32 s98, 1835008, s98
    s_cselect_b32 s86, s83, s86
    s_cselect_b32 s85, s82, s85
    s_mov_b32 s87, 1024
    s_cselect_b32 s87, 3584, s87
    s_cselect_b32 s90, s81, s80
    s_mov_b32 s80, 1024
    s_cselect_b32 s80, 32768, s80
    s_mov_b32 s81, 2048
    s_cselect_b32 s81, 1024, s81
    s_and_b32 s97, s97, 0xffff
    s_mov_b32 s99, 0x20000
    s_add_u32 s91, s90, s80
    s_add_u32 s92, s90, s81
    s_add_u32 s93, s92, s80
    v_lshrrev_b32 v71, 3, v1
    v_mul_lo_u32 v71, v71, s87
    v_and_b32 v7, 7, v1
    v_lshl_add_u32 v71, v7, 4, v71
    s_lshl_b32 s87, s87, 3
    s_mul_i32 s86, s86, s87
    s_lshl_b32 s86, s86, 2
    s_lshl_b32 s85, s85, 7
    s_add_u32 s86, s86, s85
    s_waitcnt vmcnt(12)
    v_lshrrev_b32 v7, 4, v12
    v_and_b32 v7, 31, v7
    v_and_b32 v8, 15, v7
    v_lshlrev_b32 v8, 4, v8
    v_lshl_add_u32 v8, v7, 9, v8
    v_lshrrev_b32 v7, 5, v1
    v_lshl_add_u32 v8, v7, 3, v8
    v_add_u32 v8, s74, v8
    v_xor_b32 v8, s75, v8
    v_xor_b32 v72, 0, v8
    ds_read_b64 v[120:121], v72 offset:0
    ds_read_b64 v[152:153], v72 offset:256
    v_xor_b32 v73, 16, v8
    ds_read_b64 v[122:123], v73 offset:0
    ds_read_b64 v[154:155], v73 offset:256
    v_xor_b32 v74, 32, v8
    ds_read_b64 v[124:125], v74 offset:0
    ds_read_b64 v[156:157], v74 offset:256
    v_xor_b32 v75, 48, v8
    ds_read_b64 v[126:127], v75 offset:0
    ds_read_b64 v[158:159], v75 offset:256
    v_xor_b32 v72, 64, v8
    ds_read_b64 v[128:129], v72 offset:0
    ds_read_b64 v[160:161], v72 offset:256
    v_xor_b32 v73, 80, v8
    ds_read_b64 v[130:131], v73 offset:0
    ds_read_b64 v[162:163], v73 offset:256
    v_xor_b32 v74, 96, v8
    ds_read_b64 v[132:133], v74 offset:0
    ds_read_b64 v[164:165], v74 offset:256
    v_xor_b32 v75, 112, v8
    ds_read_b64 v[134:135], v75 offset:0
    ds_read_b64 v[166:167], v75 offset:256
    v_xor_b32 v72, 128, v8
    ds_read_b64 v[136:137], v72 offset:0
    ds_read_b64 v[168:169], v72 offset:256
    v_xor_b32 v73, 144, v8
    ds_read_b64 v[138:139], v73 offset:0
    ds_read_b64 v[170:171], v73 offset:256
    v_xor_b32 v74, 160, v8
    ds_read_b64 v[140:141], v74 offset:0
    ds_read_b64 v[172:173], v74 offset:256
    v_xor_b32 v75, 176, v8
    ds_read_b64 v[142:143], v75 offset:0
    ds_read_b64 v[174:175], v75 offset:256
    v_xor_b32 v72, 192, v8
    ds_read_b64 v[144:145], v72 offset:0
    ds_read_b64 v[176:177], v72 offset:256
    v_xor_b32 v73, 208, v8
    ds_read_b64 v[146:147], v73 offset:0
    ds_read_b64 v[178:179], v73 offset:256
    v_xor_b32 v74, 224, v8
    ds_read_b64 v[148:149], v74 offset:0
    ds_read_b64 v[180:181], v74 offset:256
    v_xor_b32 v75, 240, v8
    ds_read_b64 v[150:151], v75 offset:0
    ds_read_b64 v[182:183], v75 offset:256
    s_waitcnt lgkmcnt(0)
    s_add_u32 s22, s8, s50
    s_addc_u32 s23, s9, 0
    s_cmp_eq_u32 s46, 0
    s_cselect_b64 s[22:23], s[24:25], s[22:23]
    s_mov_b32 s33, 1
    s_atomic_add s33, s[22:23], 0x0 glc
    s_add_u32 s22, s3, 8
    s_mul_i32 s23, s22, 3072
    s_mul_i32 s22, s22, 49152
    s_lshl_b32 s32, s54, 6
    s_mov_b32 m0, s23
    s_add_u32 s59, s22, s32
    s_add_u32 s22, s59, s32
    buffer_load_dwordx4 v68, s[28:31], s22 offen offset:0  lds
    s_add_u32 m0, s23, 1024
    s_add_u32 s22, s22, 24576
    buffer_load_dwordx4 v68, s[28:31], s22 offen offset:0  lds
    s_add_u32 m0, s23, 2048
    s_add_u32 s59, s59, 2048
    buffer_load_dwordx4 v69, s[28:31], s59 offen offset:0  lds
    s_add_u32 s22, s3, 24
    s_mul_i32 s23, s22, 3072
    s_mul_i32 s22, s22, 49152
    s_lshl_b32 s32, s54, 6
    s_mov_b32 m0, s23
    s_add_u32 s59, s22, s32
    s_add_u32 s22, s59, s32
    buffer_load_dwordx4 v68, s[28:31], s22 offen offset:0  lds
    s_add_u32 m0, s23, 1024
    s_add_u32 s22, s22, 24576
    buffer_load_dwordx4 v68, s[28:31], s22 offen offset:0  lds
    s_add_u32 m0, s23, 2048
    s_add_u32 s59, s59, 2048
    buffer_load_dwordx4 v69, s[28:31], s59 offen offset:0  lds
    v_mov_b32 v116, v19
    v_mov_b32 v117, v19
    v_mov_b32 v118, v19
    v_mov_b32 v119, v19
    s_waitcnt vmcnt(12)
    s_barrier
    ds_read_b64_tr_b16 a[192:193], v9 offset:0
    ds_read_b64_tr_b16 a[194:195], v9 offset:1024
    ds_read_b64_tr_b16 a[196:197], v10 offset:0
    ds_read_b64_tr_b16 a[198:199], v10 offset:1024
    ds_read_b64_tr_b16 a[200:201], v11 offset:0
    ds_read_b64_tr_b16 a[202:203], v11 offset:512
    ds_read_b64_tr_b16 a[204:205], v113 offset:3072
    ds_read_b64_tr_b16 a[206:207], v113 offset:4096
    ds_read_b64_tr_b16 a[208:209], v114 offset:3072
    ds_read_b64_tr_b16 a[210:211], v114 offset:4096
    ds_read_b64_tr_b16 a[212:213], v115 offset:3072
    ds_read_b64_tr_b16 a[214:215], v115 offset:3584
    s_waitcnt lgkmcnt(6)
    v_mfma_f32_32x32x16_bf16 v[20:35], a[192:195], v[120:123], 0
    ds_read_b64_tr_b16 a[216:217], v9 offset:6144
    ds_read_b64_tr_b16 a[218:219], v9 offset:7168
    s_add_u32 s22, s3, 12
    s_mul_i32 s23, s22, 3072
    s_mul_i32 s22, s22, 49152
    s_lshl_b32 s32, s54, 6
    s_mov_b32 m0, s23
    s_add_u32 s59, s22, s32
    s_add_u32 s22, s59, s32
    buffer_load_dwordx4 v68, s[28:31], s22 offen offset:0  lds
    v_mfma_f32_32x32x16_bf16 v[36:51], a[196:199], v[120:123], 0
    ds_read_b64_tr_b16 a[220:221], v10 offset:6144
    ds_read_b64_tr_b16 a[222:223], v10 offset:7168
    v_mfma_f32_32x32x16_bf16 v[52:67], v[120:123], a[200:203], 0
    ds_read_b64_tr_b16 a[224:225], v11 offset:6144
    ds_read_b64_tr_b16 a[226:227], v11 offset:6656
    s_add_u32 m0, s23, 1024
    s_add_u32 s22, s22, 24576
    buffer_load_dwordx4 v68, s[28:31], s22 offen offset:0  lds
    v_mfma_f32_4x4x4_16b_bf16 a[0:3], v[116:117], a[192:193], 0
    v_mfma_f32_4x4x4_16b_bf16 a[16:19], v[116:117], a[196:197], 0
    v_mfma_f32_4x4x4_16b_bf16 a[32:35], v[116:117], a[200:201], 0
    v_mfma_f32_4x4x4_16b_bf16 a[0:3], v[116:117], a[194:195], a[0:3]
    v_mfma_f32_4x4x4_16b_bf16 a[16:19], v[116:117], a[198:199], a[16:19]
    v_mfma_f32_4x4x4_16b_bf16 a[32:35], v[116:117], a[202:203], a[32:35]
    s_waitcnt lgkmcnt(6)
    v_mfma_f32_32x32x16_bf16 v[20:35], a[204:207], v[124:127], v[20:35]
    ds_read_b64_tr_b16 a[192:193], v113 offset:9216
    ds_read_b64_tr_b16 a[194:195], v113 offset:10240
    s_add_u32 m0, s23, 2048
    s_add_u32 s59, s59, 2048
    buffer_load_dwordx4 v69, s[28:31], s59 offen offset:0  lds
    v_mfma_f32_32x32x16_bf16 v[36:51], a[208:211], v[124:127], v[36:51]
    ds_read_b64_tr_b16 a[196:197], v114 offset:9216
    ds_read_b64_tr_b16 a[198:199], v114 offset:10240
    s_add_u32 s22, s3, 28
    s_mul_i32 s23, s22, 3072
    s_mul_i32 s22, s22, 49152
    s_lshl_b32 s32, s54, 6
    s_mov_b32 m0, s23
    s_add_u32 s59, s22, s32
    s_add_u32 s22, s59, s32
    buffer_load_dwordx4 v68, s[28:31], s22 offen offset:0  lds
    v_mfma_f32_32x32x16_bf16 v[52:67], v[124:127], a[212:215], v[52:67]
    ds_read_b64_tr_b16 a[200:201], v115 offset:9216
    ds_read_b64_tr_b16 a[202:203], v115 offset:9728
    v_and_b32 v255, 31, v1
    v_cmp_eq_u32 vcc, 16, v255
    v_mov_b32 v255, 0x3f803f80
    s_nop 0
    v_cndmask_b32 v255, 0, v255, vcc
    s_waitcnt vmcnt(10)
    s_barrier
    s_waitcnt lgkmcnt(6)
    v_mfma_f32_32x32x16_bf16 v[20:35], a[216:219], v[128:131], v[20:35]
    ds_read_b64_tr_b16 a[204:205], v9 offset:12288
    ds_read_b64_tr_b16 a[206:207], v9 offset:13312
    s_add_u32 m0, s23, 1024
    s_add_u32 s22, s22, 24576
    buffer_load_dwordx4 v68, s[28:31], s22 offen offset:0  lds
    v_accvgpr_write_b32 a64, v255
    v_mfma_f32_32x32x16_bf16 v[36:51], a[220:223], v[128:131], v[36:51]
    ds_read_b64_tr_b16 a[208:209], v10 offset:12288
    ds_read_b64_tr_b16 a[210:211], v10 offset:13312
    s_add_u32 m0, s23, 2048
    s_add_u32 s59, s59, 2048
    buffer_load_dwordx4 v69, s[28:31], s59 offen offset:0  lds
    v_accvgpr_write_b32 a65, v255
    v_mfma_f32_32x32x16_bf16 v[52:67], v[128:131], a[224:227], v[52:67]
    ds_read_b64_tr_b16 a[212:213], v11 offset:12288
    ds_read_b64_tr_b16 a[214:215], v11 offset:12800
    s_add_u32 s63, s57, 4
    s_lshl_b32 s63, s63, 15
    s_lshl_b32 s22, s56, 9
    s_add_u32 s63, s63, s22
    v_mfma_f32_4x4x4_16b_bf16 a[0:3], v[116:117], a[216:217], a[0:3]
    v_mfma_f32_4x4x4_16b_bf16 a[16:19], v[116:117], a[220:221], a[16:19]
    v_mfma_f32_4x4x4_16b_bf16 a[32:35], v[116:117], a[224:225], a[32:35]
    v_mfma_f32_4x4x4_16b_bf16 a[0:3], v[116:117], a[218:219], a[0:3]
    v_mfma_f32_4x4x4_16b_bf16 a[16:19], v[116:117], a[222:223], a[16:19]
    v_mfma_f32_4x4x4_16b_bf16 a[32:35], v[116:117], a[226:227], a[32:35]
    s_waitcnt lgkmcnt(6)
    v_mfma_f32_32x32x16_bf16 v[20:35], a[192:195], v[132:135], v[20:35]
    ds_read_b64_tr_b16 a[216:217], v113 offset:15360
    ds_read_b64_tr_b16 a[218:219], v113 offset:16384
    v_accvgpr_write_b32 a66, v255
    v_accvgpr_write_b32 a67, v255
    v_accvgpr_write_b32 a68, v255
    v_accvgpr_write_b32 a69, v255
    v_mfma_f32_32x32x16_bf16 v[36:51], a[196:199], v[132:135], v[36:51]
    ds_read_b64_tr_b16 a[220:221], v114 offset:15360
    ds_read_b64_tr_b16 a[222:223], v114 offset:16384
    s_add_u32 m0, s74, 0
    v_xor_b32 v72, 0, v70
    buffer_load_dwordx4 v72, s[16:19], s63 offen offset:0  lds
    s_add_u32 s63, s63, 2048
    v_mfma_f32_32x32x16_bf16 v[52:67], v[132:135], a[200:203], v[52:67]
    ds_read_b64_tr_b16 a[224:225], v115 offset:15360
    ds_read_b64_tr_b16 a[226:227], v115 offset:15872
    v_accvgpr_write_b32 a70, v255
    v_accvgpr_write_b32 a71, v255
    s_waitcnt lgkmcnt(6)
    v_mfma_f32_32x32x16_bf16 v[20:35], a[204:207], v[136:139], v[20:35]
    ds_read_b64_tr_b16 a[192:193], v9 offset:18432
    ds_read_b64_tr_b16 a[194:195], v9 offset:19456
    s_add_u32 m0, s74, 1024
    v_xor_b32 v73, 32, v70
    buffer_load_dwordx4 v73, s[16:19], s63 offen offset:0  lds
    s_add_u32 s63, s63, 2048
    v_mfma_f32_32x32x16_bf16 v[36:51], a[208:211], v[136:139], v[36:51]
    ds_read_b64_tr_b16 a[196:197], v10 offset:18432
    ds_read_b64_tr_b16 a[198:199], v10 offset:19456
    v_accvgpr_write_b32 a72, v255
    v_accvgpr_write_b32 a73, v255
    v_accvgpr_write_b32 a74, v255
    v_accvgpr_write_b32 a75, v255
    v_mfma_f32_32x32x16_bf16 v[52:67], v[136:139], a[212:215], v[52:67]
    ds_read_b64_tr_b16 a[200:201], v11 offset:18432
    ds_read_b64_tr_b16 a[202:203], v11 offset:18944
    s_add_u32 m0, s74, 2048
    v_xor_b32 v72, 64, v70
    buffer_load_dwordx4 v72, s[16:19], s63 offen offset:0  lds
    s_add_u32 s63, s63, 2048
    v_mfma_f32_4x4x4_16b_bf16 a[0:3], v[116:117], a[204:205], a[0:3]
    v_mfma_f32_4x4x4_16b_bf16 a[16:19], v[116:117], a[208:209], a[16:19]
    v_mfma_f32_4x4x4_16b_bf16 a[32:35], v[116:117], a[212:213], a[32:35]
    v_mfma_f32_4x4x4_16b_bf16 a[0:3], v[116:117], a[206:207], a[0:3]
    v_mfma_f32_4x4x4_16b_bf16 a[16:19], v[116:117], a[210:211], a[16:19]
    v_mfma_f32_4x4x4_16b_bf16 a[32:35], v[116:117], a[214:215], a[32:35]
    s_waitcnt lgkmcnt(6)
    v_mfma_f32_32x32x16_bf16 v[20:35], a[216:219], v[140:143], v[20:35]
    ds_read_b64_tr_b16 a[204:205], v113 offset:21504
    ds_read_b64_tr_b16 a[206:207], v113 offset:22528
    v_accvgpr_write_b32 a76, v255
    v_accvgpr_write_b32 a77, v255
    v_accvgpr_write_b32 a78, v255
    v_accvgpr_write_b32 a79, v255
    v_mfma_f32_32x32x16_bf16 v[36:51], a[220:223], v[140:143], v[36:51]
    ds_read_b64_tr_b16 a[208:209], v114 offset:21504
    ds_read_b64_tr_b16 a[210:211], v114 offset:22528
    s_add_u32 m0, s74, 3072
    v_xor_b32 v73, 96, v70
    buffer_load_dwordx4 v73, s[16:19], s63 offen offset:0  lds
    s_add_u32 s63, s63, 2048
    v_mfma_f32_32x32x16_bf16 v[52:67], v[140:143], a[224:227], v[52:67]
    ds_read_b64_tr_b16 a[212:213], v115 offset:21504
    ds_read_b64_tr_b16 a[214:215], v115 offset:22016
    v_accvgpr_write_b32 a80, v255
    v_accvgpr_write_b32 a81, v255
    s_waitcnt vmcnt(10)
    s_barrier
    s_waitcnt lgkmcnt(0)
    s_cmp_eq_u32 s33, 31
    s_cselect_b32 s46, s46, 1
    s_cmp_eq_u32 s46, 0
    s_cselect_b32 s22, 0, 4026531840
    v_or_b32 v5, s22, v4
    buffer_store_dword v3, v5, s[24:27], 0 offen offset:128 sc1
    v_mfma_f32_32x32x16_bf16 v[20:35], a[192:195], v[144:147], v[20:35]
    ds_read_b64_tr_b16 a[216:217], v9 offset:24576
    ds_read_b64_tr_b16 a[218:219], v9 offset:25600
    s_add_u32 m0, s74, 4096
    v_xor_b32 v72, 128, v70
    buffer_load_dwordx4 v72, s[16:19], s63 offen offset:0  lds
    s_add_u32 s63, s63, 2048
    v_mfma_f32_32x32x16_bf16 v[36:51], a[196:199], v[144:147], v[36:51]
    ds_read_b64_tr_b16 a[220:221], v10 offset:24576
    ds_read_b64_tr_b16 a[222:223], v10 offset:25600
    v_accvgpr_write_b32 a82, v255
    v_accvgpr_write_b32 a83, v255
    v_accvgpr_write_b32 a84, v255
    v_accvgpr_write_b32 a85, v255
    v_mfma_f32_32x32x16_bf16 v[52:67], v[144:147], a[200:203], v[52:67]
    ds_read_b64_tr_b16 a[224:225], v11 offset:24576
    ds_read_b64_tr_b16 a[226:227], v11 offset:25088
    s_add_u32 m0, s74, 5120
    v_xor_b32 v73, 160, v70
    buffer_load_dwordx4 v73, s[16:19], s63 offen offset:0  lds
    s_add_u32 s63, s63, 2048
    v_mfma_f32_4x4x4_16b_bf16 a[0:3], v[116:117], a[192:193], a[0:3]
    v_mfma_f32_4x4x4_16b_bf16 a[16:19], v[116:117], a[196:197], a[16:19]
    v_mfma_f32_4x4x4_16b_bf16 a[32:35], v[116:117], a[200:201], a[32:35]
    v_mfma_f32_4x4x4_16b_bf16 a[0:3], v[116:117], a[194:195], a[0:3]
    v_mfma_f32_4x4x4_16b_bf16 a[16:19], v[116:117], a[198:199], a[16:19]
    v_mfma_f32_4x4x4_16b_bf16 a[32:35], v[116:117], a[202:203], a[32:35]
    v_mfma_f32_32x32x16_bf16 v[20:35], a[204:207], v[148:151], v[20:35]
    ds_read_b64_tr_b16 a[192:193], v113 offset:27648
    ds_read_b64_tr_b16 a[194:195], v113 offset:28672
    v_accvgpr_write_b32 a86, v255
    v_accvgpr_write_b32 a87, v255
    v_accvgpr_write_b32 a88, v255
    v_accvgpr_write_b32 a89, v255
    v_mfma_f32_32x32x16_bf16 v[36:51], a[208:211], v[148:151], v[36:51]
    ds_read_b64_tr_b16 a[196:197], v114 offset:27648
    ds_read_b64_tr_b16 a[198:199], v114 offset:28672
    s_add_u32 m0, s74, 6144
    v_xor_b32 v72, 192, v70
    buffer_load_dwordx4 v72, s[16:19], s63 offen offset:0  lds
    s_add_u32 s63, s63, 2048
    v_mfma_f32_32x32x16_bf16 v[52:67], v[148:151], a[212:215], v[52:67]
    ds_read_b64_tr_b16 a[200:201], v115 offset:27648
    ds_read_b64_tr_b16 a[202:203], v115 offset:28160
    v_accvgpr_write_b32 a90, v255
    v_accvgpr_write_b32 a91, v255
    s_waitcnt lgkmcnt(6)
    v_mfma_f32_32x32x16_bf16 v[20:35], a[216:219], v[152:155], v[20:35]
    ds_read_b64_tr_b16 a[204:205], v9 offset:30720
    ds_read_b64_tr_b16 a[206:207], v9 offset:31744
    s_add_u32 m0, s74, 7168
    v_xor_b32 v73, 224, v70
    buffer_load_dwordx4 v73, s[16:19], s63 offen offset:0  lds
    s_add_u32 s63, s63, 2048
    v_mfma_f32_32x32x16_bf16 v[36:51], a[220:223], v[152:155], v[36:51]
    ds_read_b64_tr_b16 a[208:209], v10 offset:30720
    ds_read_b64_tr_b16 a[210:211], v10 offset:31744
    s_add_u32 m0, s74, 8192
    v_xor_b32 v72, 0, v70
    buffer_load_dwordx4 v72, s[16:19], s63 offen offset:0  lds
    s_add_u32 s63, s63, 2048
    v_mfma_f32_32x32x16_bf16 v[52:67], v[152:155], a[224:227], v[52:67]
    ds_read_b64_tr_b16 a[212:213], v11 offset:30720
    ds_read_b64_tr_b16 a[214:215], v11 offset:31232
    s_add_u32 m0, s74, 9216
    v_xor_b32 v73, 32, v70
    buffer_load_dwordx4 v73, s[16:19], s63 offen offset:0  lds
    s_add_u32 s63, s63, 2048
    v_mfma_f32_4x4x4_16b_bf16 a[0:3], v[116:117], a[216:217], a[0:3]
    v_mfma_f32_4x4x4_16b_bf16 a[16:19], v[116:117], a[220:221], a[16:19]
    v_mfma_f32_4x4x4_16b_bf16 a[32:35], v[116:117], a[224:225], a[32:35]
    v_mfma_f32_4x4x4_16b_bf16 a[0:3], v[116:117], a[218:219], a[0:3]
    v_mfma_f32_4x4x4_16b_bf16 a[16:19], v[116:117], a[222:223], a[16:19]
    v_mfma_f32_4x4x4_16b_bf16 a[32:35], v[116:117], a[226:227], a[32:35]
    s_waitcnt lgkmcnt(6)
    v_mfma_f32_32x32x16_bf16 v[20:35], a[192:195], v[156:159], v[20:35]
    ds_read_b64_tr_b16 a[216:217], v113 offset:33792
    ds_read_b64_tr_b16 a[218:219], v113 offset:34816
    s_add_u32 m0, s74, 10240
    v_xor_b32 v72, 64, v70
    buffer_load_dwordx4 v72, s[16:19], s63 offen offset:0  lds
    s_add_u32 s63, s63, 2048
    v_mfma_f32_32x32x16_bf16 v[36:51], a[196:199], v[156:159], v[36:51]
    ds_read_b64_tr_b16 a[220:221], v114 offset:33792
    ds_read_b64_tr_b16 a[222:223], v114 offset:34816
    s_add_u32 m0, s74, 11264
    v_xor_b32 v73, 96, v70
    buffer_load_dwordx4 v73, s[16:19], s63 offen offset:0  lds
    s_add_u32 s63, s63, 2048
    v_mfma_f32_32x32x16_bf16 v[52:67], v[156:159], a[200:203], v[52:67]
    ds_read_b64_tr_b16 a[224:225], v115 offset:33792
    ds_read_b64_tr_b16 a[226:227], v115 offset:34304
    s_add_u32 m0, s74, 12288
    v_xor_b32 v72, 128, v70
    buffer_load_dwordx4 v72, s[16:19], s63 offen offset:0  lds
    s_add_u32 s63, s63, 2048
    s_waitcnt vmcnt(14)
    s_barrier
    s_waitcnt lgkmcnt(6)
    v_mfma_f32_32x32x16_bf16 v[20:35], a[204:207], v[160:163], v[20:35]
    ds_read_b64_tr_b16 a[192:193], v9 offset:36864
    ds_read_b64_tr_b16 a[194:195], v9 offset:37888
    s_add_u32 m0, s74, 13312
    v_xor_b32 v73, 160, v70
    buffer_load_dwordx4 v73, s[16:19], s63 offen offset:0  lds
    s_add_u32 s63, s63, 2048
    v_mfma_f32_32x32x16_bf16 v[36:51], a[208:211], v[160:163], v[36:51]
    ds_read_b64_tr_b16 a[196:197], v10 offset:36864
    ds_read_b64_tr_b16 a[198:199], v10 offset:37888
    s_add_u32 m0, s74, 14336
    v_xor_b32 v72, 192, v70
    buffer_load_dwordx4 v72, s[16:19], s63 offen offset:0  lds
    s_add_u32 s63, s63, 2048
    v_mfma_f32_32x32x16_bf16 v[52:67], v[160:163], a[212:215], v[52:67]
    ds_read_b64_tr_b16 a[200:201], v11 offset:36864
    ds_read_b64_tr_b16 a[202:203], v11 offset:37376
    s_add_u32 m0, s74, 15360
    v_xor_b32 v73, 224, v70
    buffer_load_dwordx4 v73, s[16:19], s63 offen offset:0  lds
    s_add_u32 s63, s63, 2048
    v_mfma_f32_4x4x4_16b_bf16 a[0:3], v[116:117], a[204:205], a[0:3]
    v_mfma_f32_4x4x4_16b_bf16 a[16:19], v[116:117], a[208:209], a[16:19]
    v_mfma_f32_4x4x4_16b_bf16 a[32:35], v[116:117], a[212:213], a[32:35]
    v_mfma_f32_4x4x4_16b_bf16 a[0:3], v[116:117], a[206:207], a[0:3]
    v_mfma_f32_4x4x4_16b_bf16 a[16:19], v[116:117], a[210:211], a[16:19]
    v_mfma_f32_4x4x4_16b_bf16 a[32:35], v[116:117], a[214:215], a[32:35]
    s_waitcnt lgkmcnt(6)
    v_mfma_f32_32x32x16_bf16 v[20:35], a[216:219], v[164:167], v[20:35]
    ds_read_b64_tr_b16 a[204:205], v113 offset:39936
    ds_read_b64_tr_b16 a[206:207], v113 offset:40960
    v_accvgpr_write_b32 a92, v255
    v_accvgpr_write_b32 a93, v255
    v_accvgpr_write_b32 a94, v255
    v_accvgpr_write_b32 a95, v255
    v_mfma_f32_32x32x16_bf16 v[36:51], a[220:223], v[164:167], v[36:51]
    ds_read_b64_tr_b16 a[208:209], v114 offset:39936
    ds_read_b64_tr_b16 a[210:211], v114 offset:40960
    v_accvgpr_write_b32 a96, v255
    v_accvgpr_write_b32 a97, v255
    v_accvgpr_write_b32 a98, v255
    v_accvgpr_write_b32 a99, v255
    v_mfma_f32_32x32x16_bf16 v[52:67], v[164:167], a[224:227], v[52:67]
    ds_read_b64_tr_b16 a[212:213], v115 offset:39936
    ds_read_b64_tr_b16 a[214:215], v115 offset:40448
    v_accvgpr_write_b32 a100, v255
    v_accvgpr_write_b32 a101, v255
    s_waitcnt lgkmcnt(6)
    v_mfma_f32_32x32x16_bf16 v[20:35], a[192:195], v[168:171], v[20:35]
    ds_read_b64_tr_b16 a[216:217], v9 offset:43008
    ds_read_b64_tr_b16 a[218:219], v9 offset:44032
    v_accvgpr_write_b32 a102, v255
    v_accvgpr_write_b32 a103, v255
    v_accvgpr_write_b32 a104, v255
    v_accvgpr_write_b32 a105, v255
    v_mfma_f32_32x32x16_bf16 v[36:51], a[196:199], v[168:171], v[36:51]
    ds_read_b64_tr_b16 a[220:221], v10 offset:43008
    ds_read_b64_tr_b16 a[222:223], v10 offset:44032
    v_accvgpr_write_b32 a106, v255
    v_accvgpr_write_b32 a107, v255
    v_accvgpr_write_b32 a108, v255
    v_accvgpr_write_b32 a109, v255
    v_mfma_f32_32x32x16_bf16 v[52:67], v[168:171], a[200:203], v[52:67]
    ds_read_b64_tr_b16 a[224:225], v11 offset:43008
    ds_read_b64_tr_b16 a[226:227], v11 offset:43520
    v_accvgpr_write_b32 a110, v255
    v_accvgpr_write_b32 a111, v255
    v_mfma_f32_4x4x4_16b_bf16 a[0:3], v[116:117], a[192:193], a[0:3]
    v_mfma_f32_4x4x4_16b_bf16 a[16:19], v[116:117], a[196:197], a[16:19]
    v_mfma_f32_4x4x4_16b_bf16 a[32:35], v[116:117], a[200:201], a[32:35]
    v_mfma_f32_4x4x4_16b_bf16 a[0:3], v[116:117], a[194:195], a[0:3]
    v_mfma_f32_4x4x4_16b_bf16 a[16:19], v[116:117], a[198:199], a[16:19]
    v_mfma_f32_4x4x4_16b_bf16 a[32:35], v[116:117], a[202:203], a[32:35]
    s_waitcnt lgkmcnt(6)
    v_mfma_f32_32x32x16_bf16 v[20:35], a[204:207], v[172:175], v[20:35]
    ds_read_b64_tr_b16 a[192:193], v113 offset:46080
    ds_read_b64_tr_b16 a[194:195], v113 offset:47104
    v_accvgpr_write_b32 a112, v255
    v_accvgpr_write_b32 a113, v255
    v_accvgpr_write_b32 a114, v255
    v_accvgpr_write_b32 a115, v255
    v_mfma_f32_32x32x16_bf16 v[36:51], a[208:211], v[172:175], v[36:51]
    ds_read_b64_tr_b16 a[196:197], v114 offset:46080
    ds_read_b64_tr_b16 a[198:199], v114 offset:47104
    v_accvgpr_write_b32 a116, v255
    v_accvgpr_write_b32 a117, v255
    v_accvgpr_write_b32 a118, v255
    v_accvgpr_write_b32 a119, v255
    v_mfma_f32_32x32x16_bf16 v[52:67], v[172:175], a[212:215], v[52:67]
    ds_read_b64_tr_b16 a[200:201], v115 offset:46080
    ds_read_b64_tr_b16 a[202:203], v115 offset:46592
    v_accvgpr_write_b32 a120, v255
    v_accvgpr_write_b32 a121, v255
    s_waitcnt lgkmcnt(6)
    v_mfma_f32_32x32x16_bf16 v[20:35], a[216:219], v[176:179], v[20:35]
    v_accvgpr_write_b32 a122, v255
    v_accvgpr_write_b32 a123, v255
    v_mfma_f32_32x32x16_bf16 v[36:51], a[220:223], v[176:179], v[36:51]
    v_accvgpr_write_b32 a124, v255
    v_mfma_f32_32x32x16_bf16 v[52:67], v[176:179], a[224:227], v[52:67]
    v_accvgpr_write_b32 a125, v255
    v_accvgpr_write_b32 a126, v255
    v_mfma_f32_4x4x4_16b_bf16 a[0:3], v[116:117], a[216:217], a[0:3]
    v_mfma_f32_4x4x4_16b_bf16 a[16:19], v[116:117], a[220:221], a[16:19]
    v_mfma_f32_4x4x4_16b_bf16 a[32:35], v[116:117], a[224:225], a[32:35]
    v_mfma_f32_4x4x4_16b_bf16 a[0:3], v[116:117], a[218:219], a[0:3]
    v_mfma_f32_4x4x4_16b_bf16 a[16:19], v[116:117], a[222:223], a[16:19]
    v_mfma_f32_4x4x4_16b_bf16 a[32:35], v[116:117], a[226:227], a[32:35]
    s_waitcnt lgkmcnt(0)
    v_mfma_f32_32x32x16_bf16 v[20:35], a[192:195], v[180:183], v[20:35]
    v_accvgpr_write_b32 a127, v255
    v_mfma_f32_32x32x16_bf16 v[36:51], a[196:199], v[180:183], v[36:51]
    v_mfma_f32_32x32x16_bf16 v[52:67], v[180:183], a[200:203], v[52:67]
    s_and_b32 s22, s3, 1
    s_mul_i32 s22, s22, 3072
    v_subrev_u32 v9, s22, v9
    v_subrev_u32 v10, s22, v10
    v_subrev_u32 v11, s22, v11
    s_waitcnt vmcnt(0)
    v_lshrrev_b32 v7, 4, v12
    v_and_b32 v7, 31, v7
    v_and_b32 v8, 15, v7
    v_lshlrev_b32 v8, 4, v8
    v_lshl_add_u32 v8, v7, 9, v8
    v_lshrrev_b32 v7, 5, v1
    v_lshl_add_u32 v8, v7, 3, v8
    v_add_u32 v8, s74, v8
    v_xor_b32 v72, 0, v8
    ds_read_b64 v[184:185], v72 offset:0
    ds_read_b64 v[216:217], v72 offset:256
    v_xor_b32 v73, 16, v8
    ds_read_b64 v[186:187], v73 offset:0
    ds_read_b64 v[218:219], v73 offset:256
    v_xor_b32 v74, 32, v8
    ds_read_b64 v[188:189], v74 offset:0
    ds_read_b64 v[220:221], v74 offset:256
    v_xor_b32 v75, 48, v8
    ds_read_b64 v[190:191], v75 offset:0
    ds_read_b64 v[222:223], v75 offset:256
    v_xor_b32 v72, 64, v8
    ds_read_b64 v[192:193], v72 offset:0
    ds_read_b64 v[224:225], v72 offset:256
    v_xor_b32 v73, 80, v8
    ds_read_b64 v[194:195], v73 offset:0
    ds_read_b64 v[226:227], v73 offset:256
    v_xor_b32 v74, 96, v8
    ds_read_b64 v[196:197], v74 offset:0
    ds_read_b64 v[228:229], v74 offset:256
    v_xor_b32 v75, 112, v8
    ds_read_b64 v[198:199], v75 offset:0
    ds_read_b64 v[230:231], v75 offset:256
    v_xor_b32 v72, 128, v8
    ds_read_b64 v[200:201], v72 offset:0
    ds_read_b64 v[232:233], v72 offset:256
    v_xor_b32 v73, 144, v8
    ds_read_b64 v[202:203], v73 offset:0
    ds_read_b64 v[234:235], v73 offset:256
    v_xor_b32 v74, 160, v8
    ds_read_b64 v[204:205], v74 offset:0
    ds_read_b64 v[236:237], v74 offset:256
    v_xor_b32 v75, 176, v8
    ds_read_b64 v[206:207], v75 offset:0
    ds_read_b64 v[238:239], v75 offset:256
    v_xor_b32 v72, 192, v8
    ds_read_b64 v[208:209], v72 offset:0
    ds_read_b64 v[240:241], v72 offset:256
    v_xor_b32 v73, 208, v8
    ds_read_b64 v[210:211], v73 offset:0
    ds_read_b64 v[242:243], v73 offset:256
    v_xor_b32 v74, 224, v8
    ds_read_b64 v[212:213], v74 offset:0
    ds_read_b64 v[244:245], v74 offset:256
    v_xor_b32 v75, 240, v8
    ds_read_b64 v[214:215], v75 offset:0
    ds_read_b64 v[246:247], v75 offset:256
    s_waitcnt lgkmcnt(0)
    v_and_b32 v7, 31, v1
    v_lshl_add_u32 v8, v7, 2, s74
    s_lshl_b32 s22, s56, 6
    v_xor_b32 v7, s22, v8
    v_accvgpr_read_b32 v80, a0
    v_mov_b32 v83, v80
    s_nop 1
    v_permlane32_swap_b32 v80, v83
    v_add_f32 v80, v80, v83
    ds_write_b32 v7, v80 offset:8192
    v_accvgpr_read_b32 v81, a16
    v_mov_b32 v83, v81
    s_nop 1
    v_permlane32_swap_b32 v81, v83
    v_add_f32 v81, v81, v83
    ds_write_b32 v7, v81 offset:8320
    v_accvgpr_read_b32 v82, a32
    v_mov_b32 v83, v82
    s_nop 1
    v_permlane32_swap_b32 v82, v83
    v_add_f32 v82, v82, v83
    ds_write_b32 v8, v82 offset:8448
    v_subrev_u32 v84, s74, v7
    v_subrev_u32 v85, s74, v8
    v_add_u32 v84, 98304, v84
    v_add_u32 v85, 98304, v85
    s_mov_b32 s32, 128
    buffer_load_dword v5, v2, s[24:27], s32 offen sc1
    s_add_u32 m0, s74, 12288
    s_nop 0
    buffer_load_dwordx4 v71, s[96:99], s86 offen offset:0  lds
    s_add_u32 s86, s86, s87
    s_add_u32 m0, s74, 13312
    s_nop 0
    buffer_load_dwordx4 v71, s[96:99], s86 offen offset:0  lds
    s_add_u32 s86, s86, s87
    s_add_u32 m0, s74, 14336
    s_nop 0
    buffer_load_dwordx4 v71, s[96:99], s86 offen offset:0  lds
    s_add_u32 s86, s86, s87
    s_add_u32 m0, s74, 15360
    s_nop 0
    buffer_load_dwordx4 v71, s[96:99], s86 offen offset:0  lds
    s_add_u32 s86, s86, s87
    s_waitcnt lgkmcnt(0)
    s_barrier
    ds_read_b32 v88, v84 offset:8192
    ds_read_b32 v89, v84 offset:24576
    ds_read_b32 v90, v84 offset:40960
    ds_read_b32 v91, v84 offset:57344
    ds_read_b32 v92, v84 offset:8320
    ds_read_b32 v93, v84 offset:24704
    ds_read_b32 v94, v84 offset:41088
    ds_read_b32 v95, v84 offset:57472
    ds_read_b32 v96, v85 offset:8448
    ds_read_b32 v97, v85 offset:24832
    ds_read_b32 v98, v85 offset:41216
    ds_read_b32 v99, v85 offset:57600
    v_mov_b32 v76, 0
    v_mov_b32 v77, 0
    v_mov_b32 v78, 0
    v_mov_b32 v79, 0
    v_dot2c_f32_bf16 v76, v120, v19
    v_dot2c_f32_bf16 v77, v120, v120
    v_dot2c_f32_bf16 v78, v121, v19
    v_dot2c_f32_bf16 v79, v121, v121
    v_dot2c_f32_bf16 v76, v122, v19
    v_dot2c_f32_bf16 v77, v122, v122
    v_dot2c_f32_bf16 v78, v123, v19
    v_dot2c_f32_bf16 v79, v123, v123
    v_dot2c_f32_bf16 v76, v124, v19
    v_dot2c_f32_bf16 v77, v124, v124
    v_dot2c_f32_bf16 v78, v125, v19
    v_dot2c_f32_bf16 v79, v125, v125
    v_dot2c_f32_bf16 v76, v126, v19
    v_dot2c_f32_bf16 v77, v126, v126
    v_dot2c_f32_bf16 v78, v127, v19
    v_dot2c_f32_bf16 v79, v127, v127
    v_dot2c_f32_bf16 v76, v128, v19
    v_dot2c_f32_bf16 v77, v128, v128
    v_dot2c_f32_bf16 v78, v129, v19
    v_dot2c_f32_bf16 v79, v129, v129
    v_dot2c_f32_bf16 v76, v130, v19
    v_dot2c_f32_bf16 v77, v130, v130
    v_dot2c_f32_bf16 v78, v131, v19
    v_dot2c_f32_bf16 v79, v131, v131
    v_dot2c_f32_bf16 v76, v132, v19
    v_dot2c_f32_bf16 v77, v132, v132
    v_dot2c_f32_bf16 v78, v133, v19
    v_dot2c_f32_bf16 v79, v133, v133
    v_dot2c_f32_bf16 v76, v134, v19
    v_dot2c_f32_bf16 v77, v134, v134
    v_dot2c_f32_bf16 v78, v135, v19
    v_dot2c_f32_bf16 v79, v135, v135
    v_dot2c_f32_bf16 v76, v136, v19
    v_dot2c_f32_bf16 v77, v136, v136
    v_dot2c_f32_bf16 v78, v137, v19
    v_dot2c_f32_bf16 v79, v137, v137
    v_dot2c_f32_bf16 v76, v138, v19
    v_dot2c_f32_bf16 v77, v138, v138
    v_dot2c_f32_bf16 v78, v139, v19
    v_dot2c_f32_bf16 v79, v139, v139
    v_dot2c_f32_bf16 v76, v140, v19
    v_dot2c_f32_bf16 v77, v140, v140
    v_dot2c_f32_bf16 v78, v141, v19
    v_dot2c_f32_bf16 v79, v141, v141
    v_dot2c_f32_bf16 v76, v142, v19
    v_dot2c_f32_bf16 v77, v142, v142
    v_dot2c_f32_bf16 v78, v143, v19
    v_dot2c_f32_bf16 v79, v143, v143
    v_dot2c_f32_bf16 v76, v144, v19
    v_dot2c_f32_bf16 v77, v144, v144
    v_dot2c_f32_bf16 v78, v145, v19
    v_dot2c_f32_bf16 v79, v145, v145
    v_dot2c_f32_bf16 v76, v146, v19
    v_dot2c_f32_bf16 v77, v146, v146
    v_dot2c_f32_bf16 v78, v147, v19
    v_dot2c_f32_bf16 v79, v147, v147
    v_dot2c_f32_bf16 v76, v148, v19
    v_dot2c_f32_bf16 v77, v148, v148
    v_dot2c_f32_bf16 v78, v149, v19
    v_dot2c_f32_bf16 v79, v149, v149
    v_dot2c_f32_bf16 v76, v150, v19
    v_dot2c_f32_bf16 v77, v150, v150
    v_dot2c_f32_bf16 v78, v151, v19
    v_dot2c_f32_bf16 v79, v151, v151
    v_dot2c_f32_bf16 v76, v152, v19
    v_dot2c_f32_bf16 v77, v152, v152
    v_dot2c_f32_bf16 v78, v153, v19
    v_dot2c_f32_bf16 v79, v153, v153
    v_dot2c_f32_bf16 v76, v154, v19
    v_dot2c_f32_bf16 v77, v154, v154
    v_dot2c_f32_bf16 v78, v155, v19
    v_dot2c_f32_bf16 v79, v155, v155
    v_dot2c_f32_bf16 v76, v156, v19
    v_dot2c_f32_bf16 v77, v156, v156
    v_dot2c_f32_bf16 v78, v157, v19
    v_dot2c_f32_bf16 v79, v157, v157
    v_dot2c_f32_bf16 v76, v158, v19
    v_dot2c_f32_bf16 v77, v158, v158
    v_dot2c_f32_bf16 v78, v159, v19
    v_dot2c_f32_bf16 v79, v159, v159
    v_dot2c_f32_bf16 v76, v160, v19
    v_dot2c_f32_bf16 v77, v160, v160
    v_dot2c_f32_bf16 v78, v161, v19
    v_dot2c_f32_bf16 v79, v161, v161
    v_dot2c_f32_bf16 v76, v162, v19
    v_dot2c_f32_bf16 v77, v162, v162
    v_dot2c_f32_bf16 v78, v163, v19
    v_dot2c_f32_bf16 v79, v163, v163
    v_dot2c_f32_bf16 v76, v164, v19
    v_dot2c_f32_bf16 v77, v164, v164
    v_dot2c_f32_bf16 v78, v165, v19
    v_dot2c_f32_bf16 v79, v165, v165
    v_dot2c_f32_bf16 v76, v166, v19
    v_dot2c_f32_bf16 v77, v166, v166
    v_dot2c_f32_bf16 v78, v167, v19
    v_dot2c_f32_bf16 v79, v167, v167
    v_dot2c_f32_bf16 v76, v168, v19
    v_dot2c_f32_bf16 v77, v168, v168
    v_dot2c_f32_bf16 v78, v169, v19
    v_dot2c_f32_bf16 v79, v169, v169
    v_dot2c_f32_bf16 v76, v170, v19
    v_dot2c_f32_bf16 v77, v170, v170
    v_dot2c_f32_bf16 v78, v171, v19
    v_dot2c_f32_bf16 v79, v171, v171
    v_dot2c_f32_bf16 v76, v172, v19
    v_dot2c_f32_bf16 v77, v172, v172
    v_dot2c_f32_bf16 v78, v173, v19
    v_dot2c_f32_bf16 v79, v173, v173
    v_dot2c_f32_bf16 v76, v174, v19
    v_dot2c_f32_bf16 v77, v174, v174
    v_dot2c_f32_bf16 v78, v175, v19
    v_dot2c_f32_bf16 v79, v175, v175
    v_dot2c_f32_bf16 v76, v176, v19
    v_dot2c_f32_bf16 v77, v176, v176
    v_dot2c_f32_bf16 v78, v177, v19
    v_dot2c_f32_bf16 v79, v177, v177
    v_dot2c_f32_bf16 v76, v178, v19
    v_dot2c_f32_bf16 v77, v178, v178
    v_dot2c_f32_bf16 v78, v179, v19
    v_dot2c_f32_bf16 v79, v179, v179
    v_dot2c_f32_bf16 v76, v180, v19
    v_dot2c_f32_bf16 v77, v180, v180
    v_dot2c_f32_bf16 v78, v181, v19
    v_dot2c_f32_bf16 v79, v181, v181
    v_dot2c_f32_bf16 v76, v182, v19
    v_dot2c_f32_bf16 v77, v182, v182
    v_dot2c_f32_bf16 v78, v183, v19
    v_dot2c_f32_bf16 v79, v183, v183
    s_nop 1
    v_add_f32 v76, v76, v78
    v_add_f32 v77, v77, v79
    s_nop 1
    v_permlane32_swap_b32 v76, v77
    v_add_f32 v250, v76, v77
    v_mov_b32 v7, v250
    v_mov_b32 v8, v250
    s_nop 1
    v_permlane32_swap_b32 v7, v8
    v_mul_f32 v7, 0xbb000000, v7
    v_mov_b32 v118, 0
    v_mov_b32 v119, 0
    v_cvt_pk_bf16_f32 v116, v7, v7
    v_lshlrev_b32 v8, 16, v116
    v_sub_f32 v8, v7, v8
    v_cvt_pk_bf16_f32 v117, v8, v118
    s_waitcnt lgkmcnt(8)
    v_add_f32 v88, v88, v89
    v_add_f32 v90, v90, v91
    v_add_f32 v88, v88, v90
    v_mov_b32 v102, 0
    v_mov_b32 v103, 0
    v_cvt_pk_bf16_f32 v101, v88, v102
    v_lshlrev_b32 v89, 16, v101
    v_sub_f32 v89, v88, v89
    v_cvt_pk_bf16_f32 v100, v88, v89
    v_cndmask_b32 v100, 0, v100, s[34:35]
    v_cndmask_b32 v101, 0, v101, s[34:35]
    v_accvgpr_write_b32 a228, v100
    v_accvgpr_write_b32 a229, v101
    v_accvgpr_write_b32 a230, v102
    v_accvgpr_write_b32 a231, v103
    s_waitcnt lgkmcnt(4)
    v_add_f32 v92, v92, v93
    v_add_f32 v94, v94, v95
    v_add_f32 v92, v92, v94
    v_mov_b32 v106, 0
    v_mov_b32 v107, 0
    v_cvt_pk_bf16_f32 v105, v92, v106
    v_lshlrev_b32 v93, 16, v105
    v_sub_f32 v93, v92, v93
    v_cvt_pk_bf16_f32 v104, v92, v93
    v_cndmask_b32 v104, 0, v104, s[34:35]
    v_cndmask_b32 v105, 0, v105, s[34:35]
    v_accvgpr_write_b32 a232, v104
    v_accvgpr_write_b32 a233, v105
    v_accvgpr_write_b32 a234, v106
    v_accvgpr_write_b32 a235, v107
    s_waitcnt lgkmcnt(0)
    v_add_f32 v96, v96, v97
    v_add_f32 v98, v98, v99
    v_add_f32 v96, v96, v98
    v_mov_b32 v110, 0
    v_mov_b32 v111, 0
    v_cvt_pk_bf16_f32 v109, v96, v110
    v_lshlrev_b32 v97, 16, v109
    v_sub_f32 v97, v96, v97
    v_cvt_pk_bf16_f32 v108, v96, v97
    v_cndmask_b32 v108, 0, v108, s[34:35]
    v_cndmask_b32 v109, 0, v109, s[34:35]
    v_accvgpr_write_b32 a236, v108
    v_accvgpr_write_b32 a237, v109
    v_accvgpr_write_b32 a238, v110
    v_accvgpr_write_b32 a239, v111
    v_mfma_f32_32x32x16_bf16 v[20:35], a[228:231], v[116:119], v[20:35]
    v_mfma_f32_32x32x16_bf16 v[36:51], a[232:235], v[116:119], v[36:51]
    v_mfma_f32_32x32x16_bf16 v[52:67], v[116:119], a[236:239], v[52:67]
    v_sub_u32 v8, v13, v0
    v_lshl_add_u32 v7, v1, 2, v8
    ds_write_b32 v7, v250 offset:6144
    s_nop 6
    ds_write_b128 v13, v[28:31] offset:0
    ds_write_b128 v13, v[32:35] offset:1024
    ds_write_b128 v13, v[44:47] offset:2048
    ds_write_b128 v13, v[48:51] offset:3072
    ds_write_b128 v13, v[60:63] offset:4096
    ds_write_b128 v13, v[64:67] offset:5120
    s_waitcnt lgkmcnt(0)
    s_waitcnt vmcnt(4)
    v_cmp_gt_u32 vcc, s39, v5
    s_cbranch_vccnz init_sp
init_go:
    s_barrier
    v_xor_b32 v7, 16, v1
    v_sub_u32 v8, v14, v0
    v_lshl_add_u32 v7, v7, 2, v8
    ds_read_b32 v116, v7 offset:6144
    v_xor_b32 v8, 256, v14
    ds_read_b128 v[28:31], v8 offset:0
    ds_read_b128 v[32:35], v8 offset:1024
    ds_read_b128 v[44:47], v8 offset:2048
    ds_read_b128 v[48:51], v8 offset:3072
    ds_read_b128 v[60:63], v14 offset:4096
    ds_read_b128 v[64:67], v14 offset:5120
    s_waitcnt lgkmcnt(4)
    v_add_f32 v20, v20, v28
    v_add_f32 v116, v250, v116
    v_add_f32 v21, v21, v29
    v_mov_b32 v117, v116
    v_add_f32 v22, v22, v30
    s_nop 0
    v_permlane32_swap_b32 v116, v117
    v_add_f32 v23, v23, v31
    v_add_f32 v24, v24, v32
    v_add_f32 v25, v25, v33
    v_mul_f32 v116, 0.001953125, v116
    v_add_f32 v26, v26, v34
    v_mul_f32 v117, 0.001953125, v117
    v_add_f32 v27, v27, v35
    v_fma_f32 v117, -v116, v116, v117
    s_waitcnt lgkmcnt(2)
    v_max_f32 v117, 0, v117
    v_add_f32 v36, v36, v44
    v_add_f32 v37, v37, v45
    v_add_f32 v117, 0x3727c5ac, v117
    v_add_f32 v38, v38, v46
    v_rsq_f32 v18, v117
    v_add_f32 v39, v39, v47
    v_add_f32 v40, v40, v48
    v_and_b32 v7, 31, v1
    v_add_f32 v41, v41, v49
    v_sub_u32 v8, v13, v0
    v_add_f32 v42, v42, v50
    v_add_f32 v43, v43, v51
    v_lshl_add_u32 v7, v7, 2, v8
    s_waitcnt lgkmcnt(0)
    ds_write_b32 v7, v18 offset:7168
    v_add_f32 v52, v52, v60
    v_lshrrev_b32 v7, 5, v1
    v_add_f32 v53, v53, v61
    v_lshl_add_u32 v7, v7, 4, v8
    v_add_f32 v54, v54, v62
    v_add_f32 v55, v55, v63
    v_mul_f32 v17, s58, v18
    v_add_f32 v56, v56, v64
    s_waitcnt lgkmcnt(0)
    v_add_f32 v57, v57, v65
    ds_read_b128 v[120:123], v7 offset:7168
    v_add_f32 v58, v58, v66
    ds_read_b128 v[124:127], v7 offset:7200
    v_add_f32 v59, v59, v67
    v_mul_f32 v20, v20, v17
    v_mul_f32 v21, v21, v17
    v_mul_f32 v22, v22, v17
    v_mul_f32 v23, v23, v17
    v_mul_f32 v24, v24, v17
    v_mul_f32 v25, v25, v17
    v_mul_f32 v26, v26, v17
    v_mul_f32 v27, v27, v17
    v_cvt_pk_bf16_f32 v20, v20, v21
    v_cvt_pk_bf16_f32 v21, v22, v23
    v_cvt_pk_bf16_f32 v22, v24, v25
    v_cvt_pk_bf16_f32 v23, v26, v27
    v_mul_f32 v36, v36, v17
    v_mul_f32 v37, v37, v17
    v_mul_f32 v38, v38, v17
    v_mul_f32 v39, v39, v17
    v_mul_f32 v40, v40, v17
    v_mul_f32 v41, v41, v17
    v_mul_f32 v42, v42, v17
    v_mul_f32 v43, v43, v17
    v_cvt_pk_bf16_f32 v36, v36, v37
    v_cvt_pk_bf16_f32 v37, v38, v39
    v_cvt_pk_bf16_f32 v38, v40, v41
    v_cvt_pk_bf16_f32 v39, v42, v43
    s_waitcnt lgkmcnt(0)
    v_mul_f32 v52, v52, v120
    v_mul_f32 v53, v53, v121
    v_mul_f32 v54, v54, v122
    v_mul_f32 v55, v55, v123
    v_mul_f32 v56, v56, v124
    v_mul_f32 v57, v57, v125
    v_mul_f32 v58, v58, v126
    v_mul_f32 v59, v59, v127
    v_cvt_pk_bf16_f32 v52, v52, v53
    v_cvt_pk_bf16_f32 v53, v54, v55
    v_cvt_pk_bf16_f32 v54, v56, v57
    v_cvt_pk_bf16_f32 v55, v58, v59
    buffer_store_dwordx4 v[20:23], v15, s[12:15], s66 offen offset:0 sc1
    buffer_store_dwordx4 v[36:39], v15, s[12:15], s67 offen offset:0 sc1
    buffer_store_dwordx4 v[52:55], v16, s[12:15], s68 offen offset:0 sc1
    s_add_u32 s66, s66, 4096
    s_add_u32 s67, s67, 4096
    s_add_u32 s68, s68, 4096
    v_mov_b32 v76, 0
    v_mov_b32 v77, 0
    v_mov_b32 v78, 0
    v_mov_b32 v79, 0
    v_dot2c_f32_bf16 v76, v184, v19
    v_dot2c_f32_bf16 v77, v184, v184
    v_dot2c_f32_bf16 v78, v185, v19
    v_dot2c_f32_bf16 v79, v185, v185
    v_dot2c_f32_bf16 v76, v186, v19
    v_dot2c_f32_bf16 v77, v186, v186
    v_dot2c_f32_bf16 v78, v187, v19
    v_dot2c_f32_bf16 v79, v187, v187
    v_dot2c_f32_bf16 v76, v188, v19
    v_dot2c_f32_bf16 v77, v188, v188
    v_dot2c_f32_bf16 v78, v189, v19
    v_dot2c_f32_bf16 v79, v189, v189
    v_dot2c_f32_bf16 v76, v190, v19
    v_dot2c_f32_bf16 v77, v190, v190
    v_dot2c_f32_bf16 v78, v191, v19
    v_dot2c_f32_bf16 v79, v191, v191
    v_dot2c_f32_bf16 v76, v192, v19
    v_dot2c_f32_bf16 v77, v192, v192
    v_dot2c_f32_bf16 v78, v193, v19
    v_dot2c_f32_bf16 v79, v193, v193
    v_dot2c_f32_bf16 v76, v194, v19
    v_dot2c_f32_bf16 v77, v194, v194
    v_dot2c_f32_bf16 v78, v195, v19
    v_dot2c_f32_bf16 v79, v195, v195
    v_dot2c_f32_bf16 v76, v196, v19
    v_dot2c_f32_bf16 v77, v196, v196
    v_dot2c_f32_bf16 v78, v197, v19
    v_dot2c_f32_bf16 v79, v197, v197
    v_dot2c_f32_bf16 v76, v198, v19
    v_dot2c_f32_bf16 v77, v198, v198
    v_dot2c_f32_bf16 v78, v199, v19
    v_dot2c_f32_bf16 v79, v199, v199
    v_dot2c_f32_bf16 v76, v200, v19
    v_dot2c_f32_bf16 v77, v200, v200
    v_dot2c_f32_bf16 v78, v201, v19
    v_dot2c_f32_bf16 v79, v201, v201
    v_dot2c_f32_bf16 v76, v202, v19
    v_dot2c_f32_bf16 v77, v202, v202
    v_dot2c_f32_bf16 v78, v203, v19
    v_dot2c_f32_bf16 v79, v203, v203
    v_dot2c_f32_bf16 v76, v204, v19
    v_dot2c_f32_bf16 v77, v204, v204
    v_dot2c_f32_bf16 v78, v205, v19
    v_dot2c_f32_bf16 v79, v205, v205
    v_dot2c_f32_bf16 v76, v206, v19
    v_dot2c_f32_bf16 v77, v206, v206
    v_dot2c_f32_bf16 v78, v207, v19
    v_dot2c_f32_bf16 v79, v207, v207
    v_dot2c_f32_bf16 v76, v208, v19
    v_dot2c_f32_bf16 v77, v208, v208
    v_dot2c_f32_bf16 v78, v209, v19
    v_dot2c_f32_bf16 v79, v209, v209
    v_dot2c_f32_bf16 v76, v210, v19
    v_dot2c_f32_bf16 v77, v210, v210
    v_dot2c_f32_bf16 v78, v211, v19
    v_dot2c_f32_bf16 v79, v211, v211
    v_dot2c_f32_bf16 v76, v212, v19
    v_dot2c_f32_bf16 v77, v212, v212
    v_dot2c_f32_bf16 v78, v213, v19
    v_dot2c_f32_bf16 v79, v213, v213
    v_dot2c_f32_bf16 v76, v214, v19
    v_dot2c_f32_bf16 v77, v214, v214
    v_dot2c_f32_bf16 v78, v215, v19
    v_dot2c_f32_bf16 v79, v215, v215
    v_dot2c_f32_bf16 v76, v216, v19
    v_dot2c_f32_bf16 v77, v216, v216
    v_dot2c_f32_bf16 v78, v217, v19
    v_dot2c_f32_bf16 v79, v217, v217
    v_dot2c_f32_bf16 v76, v218, v19
    v_dot2c_f32_bf16 v77, v218, v218
    v_dot2c_f32_bf16 v78, v219, v19
    v_dot2c_f32_bf16 v79, v219, v219
    v_dot2c_f32_bf16 v76, v220, v19
    v_dot2c_f32_bf16 v77, v220, v220
    v_dot2c_f32_bf16 v78, v221, v19
    v_dot2c_f32_bf16 v79, v221, v221
    v_dot2c_f32_bf16 v76, v222, v19
    v_dot2c_f32_bf16 v77, v222, v222
    v_dot2c_f32_bf16 v78, v223, v19
    v_dot2c_f32_bf16 v79, v223, v223
    v_dot2c_f32_bf16 v76, v224, v19
    v_dot2c_f32_bf16 v77, v224, v224
    v_dot2c_f32_bf16 v78, v225, v19
    v_dot2c_f32_bf16 v79, v225, v225
    v_dot2c_f32_bf16 v76, v226, v19
    v_dot2c_f32_bf16 v77, v226, v226
    v_dot2c_f32_bf16 v78, v227, v19
    v_dot2c_f32_bf16 v79, v227, v227
    v_dot2c_f32_bf16 v76, v228, v19
    v_dot2c_f32_bf16 v77, v228, v228
    v_dot2c_f32_bf16 v78, v229, v19
    v_dot2c_f32_bf16 v79, v229, v229
    v_dot2c_f32_bf16 v76, v230, v19
    v_dot2c_f32_bf16 v77, v230, v230
    v_dot2c_f32_bf16 v78, v231, v19
    v_dot2c_f32_bf16 v79, v231, v231
    v_dot2c_f32_bf16 v76, v232, v19
    v_dot2c_f32_bf16 v77, v232, v232
    v_dot2c_f32_bf16 v78, v233, v19
    v_dot2c_f32_bf16 v79, v233, v233
    v_dot2c_f32_bf16 v76, v234, v19
    v_dot2c_f32_bf16 v77, v234, v234
    v_dot2c_f32_bf16 v78, v235, v19
    v_dot2c_f32_bf16 v79, v235, v235
    v_dot2c_f32_bf16 v76, v236, v19
    v_dot2c_f32_bf16 v77, v236, v236
    v_dot2c_f32_bf16 v78, v237, v19
    v_dot2c_f32_bf16 v79, v237, v237
    v_dot2c_f32_bf16 v76, v238, v19
    v_dot2c_f32_bf16 v77, v238, v238
    v_dot2c_f32_bf16 v78, v239, v19
    v_dot2c_f32_bf16 v79, v239, v239
    v_dot2c_f32_bf16 v76, v240, v19
    v_dot2c_f32_bf16 v77, v240, v240
    v_dot2c_f32_bf16 v78, v241, v19
    v_dot2c_f32_bf16 v79, v241, v241
    v_dot2c_f32_bf16 v76, v242, v19
    v_dot2c_f32_bf16 v77, v242, v242
    v_dot2c_f32_bf16 v78, v243, v19
    v_dot2c_f32_bf16 v79, v243, v243
    v_dot2c_f32_bf16 v76, v244, v19
    v_dot2c_f32_bf16 v77, v244, v244
    v_dot2c_f32_bf16 v78, v245, v19
    v_dot2c_f32_bf16 v79, v245, v245
    v_dot2c_f32_bf16 v76, v246, v19
    v_dot2c_f32_bf16 v77, v246, v246
    v_dot2c_f32_bf16 v78, v247, v19
    v_dot2c_f32_bf16 v79, v247, v247
    s_nop 1
    v_add_f32 v76, v76, v78
    v_add_f32 v77, v77, v79
    s_nop 1
    v_permlane32_swap_b32 v76, v77
    v_add_f32 v251, v76, v77
    ds_read_b64_tr_b16 a[192:193], v9 offset:0
    ds_read_b64_tr_b16 a[194:195], v9 offset:1024
    ds_read_b64_tr_b16 a[196:197], v10 offset:0
    ds_read_b64_tr_b16 a[198:199], v10 offset:1024
    ds_read_b64_tr_b16 a[200:201], v11 offset:0
    ds_read_b64_tr_b16 a[202:203], v11 offset:512
    ds_read_b64_tr_b16 a[204:205], v9 offset:3072
    ds_read_b64_tr_b16 a[206:207], v9 offset:4096
    ds_read_b64_tr_b16 a[208:209], v10 offset:3072
    ds_read_b64_tr_b16 a[210:211], v10 offset:4096
    ds_read_b64_tr_b16 a[212:213], v11 offset:3072
    ds_read_b64_tr_b16 a[214:215], v11 offset:3584
    s_waitcnt lgkmcnt(6)
    v_mfma_f32_32x32x16_bf16 v[68:83], a[192:195], v[184:187], 0
    ds_read_b64_tr_b16 a[216:217], v9 offset:6144
    ds_read_b64_tr_b16 a[218:219], v9 offset:7168
    s_and_b32 s76, s5, 3
    s_lshl_b32 s79, s4, 2
    s_add_u32 s76, s76, s79
    v_mfma_f32_32x32x16_bf16 v[84:99], a[196:199], v[184:187], 0
    ds_read_b64_tr_b16 a[220:221], v10 offset:6144
    ds_read_b64_tr_b16 a[222:223], v10 offset:7168
    s_lshr_b32 s77, s5, 2
    s_lshl_b32 s79, s76, 16
    v_mfma_f32_32x32x16_bf16 v[100:115], v[184:187], a[200:203], 0
    ds_read_b64_tr_b16 a[224:225], v11 offset:6144
    ds_read_b64_tr_b16 a[226:227], v11 offset:6656
    s_lshl_b32 s88, s77, 13
    s_add_u32 s78, s79, s88
    s_waitcnt lgkmcnt(6)
    v_mfma_f32_32x32x16_bf16 v[68:83], a[204:207], v[188:191], v[68:83]
    ds_read_b64_tr_b16 a[192:193], v9 offset:9216
    ds_read_b64_tr_b16 a[194:195], v9 offset:10240
    s_add_u32 s78, s78, 2228224
    s_lshl_b32 s88, s3, 14
    v_mfma_f32_32x32x16_bf16 v[84:99], a[208:211], v[188:191], v[84:99]
    ds_read_b64_tr_b16 a[196:197], v10 offset:9216
    ds_read_b64_tr_b16 a[198:199], v10 offset:10240
    v_lshrrev_b32 v168, 5, v1
    s_add_u32 s79, s79, s88
    s_add_u32 s80, s79, 4325376
    v_mfma_f32_32x32x16_bf16 v[100:115], v[188:191], a[212:215], v[100:115]
    ds_read_b64_tr_b16 a[200:201], v11 offset:9216
    ds_read_b64_tr_b16 a[202:203], v11 offset:9728
    v_bfe_u32 v169, v1, 2, 2
    s_add_u32 s84, s79, 6422528
    s_waitcnt lgkmcnt(6)
    v_mfma_f32_32x32x16_bf16 v[68:83], a[216:219], v[192:195], v[68:83]
    ds_read_b64_tr_b16 a[204:205], v9 offset:12288
    ds_read_b64_tr_b16 a[206:207], v9 offset:13312
    s_add_u32 s81, s79, 4333568
    v_lshl_add_u32 v168, v168, 2, v169
    s_add_u32 s85, s79, 6430720
    s_add_u32 s82, s79, 4329472
    v_mfma_f32_32x32x16_bf16 v[84:99], a[220:223], v[192:195], v[84:99]
    ds_read_b64_tr_b16 a[208:209], v10 offset:12288
    ds_read_b64_tr_b16 a[210:211], v10 offset:13312
    v_lshlrev_b32 v168, 7, v168
    s_add_u32 s86, s79, 6426624
    s_add_u32 s83, s79, 4337664
    v_mfma_f32_32x32x16_bf16 v[100:115], v[192:195], a[224:227], v[100:115]
    ds_read_b64_tr_b16 a[212:213], v11 offset:12288
    ds_read_b64_tr_b16 a[214:215], v11 offset:12800
    v_bfe_u32 v169, v1, 4, 1
    s_add_u32 s87, s79, 6434816
    s_waitcnt lgkmcnt(6)
    v_mfma_f32_32x32x16_bf16 v[68:83], a[192:195], v[196:199], v[68:83]
    ds_read_b64_tr_b16 a[216:217], v9 offset:15360
    ds_read_b64_tr_b16 a[218:219], v9 offset:16384
    v_lshrrev_b32 v248, 5, v1
    v_lshl_add_u32 v168, v169, 5, v168
    v_and_b32 v249, 15, v1
    v_lshlrev_b32 v249, 4, v249
    v_mfma_f32_32x32x16_bf16 v[84:99], a[196:199], v[196:199], v[84:99]
    ds_read_b64_tr_b16 a[220:221], v10 offset:15360
    ds_read_b64_tr_b16 a[222:223], v10 offset:16384
    v_and_b32 v169, 3, v1
    v_lshl_add_u32 v248, v248, 8, v249
    s_lshr_b32 s40, s76, 1
    v_mfma_f32_32x32x16_bf16 v[100:115], v[196:199], a[200:203], v[100:115]
    ds_read_b64_tr_b16 a[224:225], v11 offset:15360
    ds_read_b64_tr_b16 a[226:227], v11 offset:15872
    v_lshl_add_u32 v168, v169, 3, v168
    s_lshl_b32 s40, s40, 9
    s_waitcnt lgkmcnt(6)
    v_mfma_f32_32x32x16_bf16 v[68:83], a[204:207], v[200:203], v[68:83]
    ds_read_b64_tr_b16 a[192:193], v9 offset:18432
    ds_read_b64_tr_b16 a[194:195], v9 offset:19456
    s_waitcnt vmcnt(0)
    s_barrier
    s_cmp_lg_u32 s3, 0
    s_cbranch_scc1 sg1
    s_atomic_add s7, s[8:9], s69
    s_add_u32 s51, s69, 128
    s_atomic_add s7, s[8:9], s51
    s_atomic_add s7, s[8:9], s41
    s_add_u32 s51, s41, 128
    s_atomic_add s7, s[8:9], s51
    s_add_u32 s51, s41, 512
    s_atomic_add s7, s[8:9], s51
    s_add_u32 s51, s41, 640
    s_atomic_add s7, s[8:9], s51
sg1:
    v_mfma_f32_32x32x16_bf16 v[84:99], a[208:211], v[200:203], v[84:99]
    ds_read_b64_tr_b16 a[196:197], v10 offset:18432
    ds_read_b64_tr_b16 a[198:199], v10 offset:19456
    s_add_u32 s40, s40, s47
    s_bfe_u32 s33, s5, 65538
    s_lshl_b32 s33, s33, 7
    s_add_u32 s40, s40, s33
    v_mfma_f32_32x32x16_bf16 v[100:115], v[200:203], a[212:215], v[100:115]
    ds_read_b64_tr_b16 a[200:201], v11 offset:18432
    ds_read_b64_tr_b16 a[202:203], v11 offset:18944
    v_add_u32 v168, s74, v168
    v_accvgpr_write_b32 a128, v255
    s_waitcnt lgkmcnt(6)
    v_mfma_f32_32x32x16_bf16 v[68:83], a[216:219], v[204:207], v[68:83]
    ds_read_b64_tr_b16 a[204:205], v9 offset:21504
    ds_read_b64_tr_b16 a[206:207], v9 offset:22528
    s_lshl_b32 s23, s54, 1
    s_add_u32 s23, s23, s56
    s_mul_i32 s23, s23, 1536
    s_add_u32 s23, s23, 4456448
    s_cmp_eq_u32 s57, 0
    s_cselect_b32 s22, 0, 4026531840
    v_lshl_or_b32 v170, v1, 3, s22
    v_mfma_f32_32x32x16_bf16 v[84:99], a[220:223], v[204:207], v[84:99]
    ds_read_b64_tr_b16 a[208:209], v10 offset:21504
    ds_read_b64_tr_b16 a[210:211], v10 offset:22528
    v_accvgpr_write_b32 a129, v255
    v_accvgpr_write_b32 a130, v255
    v_accvgpr_write_b32 a131, v255
    v_accvgpr_write_b32 a132, v255
    v_mfma_f32_32x32x16_bf16 v[100:115], v[204:207], a[224:227], v[100:115]
    ds_read_b64_tr_b16 a[212:213], v11 offset:21504
    ds_read_b64_tr_b16 a[214:215], v11 offset:22016
    v_accvgpr_write_b32 a133, v255
    v_accvgpr_write_b32 a134, v255
    s_waitcnt lgkmcnt(6)
    v_mfma_f32_32x32x16_bf16 v[68:83], a[192:195], v[208:211], v[68:83]
    ds_read_b64_tr_b16 a[216:217], v9 offset:24576
    ds_read_b64_tr_b16 a[218:219], v9 offset:25600
    v_accvgpr_write_b32 a135, v255
    v_accvgpr_write_b32 a136, v255
    v_accvgpr_write_b32 a137, v255
    v_accvgpr_write_b32 a138, v255
    v_mfma_f32_32x32x16_bf16 v[84:99], a[196:199], v[208:211], v[84:99]
    ds_read_b64_tr_b16 a[220:221], v10 offset:24576
    ds_read_b64_tr_b16 a[222:223], v10 offset:25600
    v_accvgpr_write_b32 a139, v255
    v_accvgpr_write_b32 a140, v255
    v_accvgpr_write_b32 a141, v255
    v_mfma_f32_32x32x16_bf16 v[100:115], v[208:211], a[200:203], v[100:115]
    ds_read_b64_tr_b16 a[224:225], v11 offset:24576
    ds_read_b64_tr_b16 a[226:227], v11 offset:25088
    v_accvgpr_write_b32 a142, v255
    v_accvgpr_write_b32 a143, v255
    s_waitcnt lgkmcnt(6)
    v_mfma_f32_32x32x16_bf16 v[68:83], a[204:207], v[212:215], v[68:83]
    ds_read_b64_tr_b16 a[192:193], v9 offset:27648
    ds_read_b64_tr_b16 a[194:195], v9 offset:28672
    v_accvgpr_write_b32 a144, v255
    v_accvgpr_write_b32 a145, v255
    v_mfma_f32_32x32x16_bf16 v[84:99], a[208:211], v[212:215], v[84:99]
    ds_read_b64_tr_b16 a[196:197], v10 offset:27648
    ds_read_b64_tr_b16 a[198:199], v10 offset:28672
    v_accvgpr_write_b32 a146, v255
    v_accvgpr_write_b32 a147, v255
    v_accvgpr_write_b32 a148, v255
    v_mfma_f32_32x32x16_bf16 v[100:115], v[212:215], a[212:215], v[100:115]
    ds_read_b64_tr_b16 a[200:201], v11 offset:27648
    ds_read_b64_tr_b16 a[202:203], v11 offset:28160
    v_accvgpr_write_b32 a149, v255
    v_accvgpr_write_b32 a150, v255
    s_waitcnt lgkmcnt(6)
    v_mfma_f32_32x32x16_bf16 v[68:83], a[216:219], v[216:219], v[68:83]
    ds_read_b64_tr_b16 a[204:205], v9 offset:30720
    ds_read_b64_tr_b16 a[206:207], v9 offset:31744
    v_accvgpr_write_b32 a151, v255
    v_accvgpr_write_b32 a152, v255
    v_mfma_f32_32x32x16_bf16 v[84:99], a[220:223], v[216:219], v[84:99]
    ds_read_b64_tr_b16 a[208:209], v10 offset:30720
    ds_read_b64_tr_b16 a[210:211], v10 offset:31744
    v_accvgpr_write_b32 a153, v255
    v_accvgpr_write_b32 a154, v255
    v_mfma_f32_32x32x16_bf16 v[100:115], v[216:219], a[224:227], v[100:115]
    ds_read_b64_tr_b16 a[212:213], v11 offset:30720
    ds_read_b64_tr_b16 a[214:215], v11 offset:31232
    v_accvgpr_write_b32 a155, v255
    v_accvgpr_write_b32 a156, v255
    s_waitcnt lgkmcnt(6)
    v_mfma_f32_32x32x16_bf16 v[68:83], a[192:195], v[220:223], v[68:83]
    ds_read_b64_tr_b16 a[216:217], v9 offset:33792
    ds_read_b64_tr_b16 a[218:219], v9 offset:34816
    v_accvgpr_write_b32 a157, v255
    v_accvgpr_write_b32 a158, v255
    v_mfma_f32_32x32x16_bf16 v[84:99], a[196:199], v[220:223], v[84:99]
    ds_read_b64_tr_b16 a[220:221], v10 offset:33792
    ds_read_b64_tr_b16 a[222:223], v10 offset:34816
    v_accvgpr_write_b32 a159, v255
    v_accvgpr_write_b32 a160, v255
    v_mfma_f32_32x32x16_bf16 v[100:115], v[220:223], a[200:203], v[100:115]
    ds_read_b64_tr_b16 a[224:225], v11 offset:33792
    ds_read_b64_tr_b16 a[226:227], v11 offset:34304
    ds_read_b64_tr_b16 v[152:153], v168 offset:12288
    ds_read_b64_tr_b16 v[154:155], v168 offset:13312
    s_waitcnt lgkmcnt(8)
    v_mfma_f32_32x32x16_bf16 v[68:83], a[204:207], v[224:227], v[68:83]
    ds_read_b64_tr_b16 a[192:193], v9 offset:36864
    ds_read_b64_tr_b16 a[194:195], v9 offset:37888
    ds_read_b64_tr_b16 v[156:157], v168 offset:12352
    ds_read_b64_tr_b16 v[158:159], v168 offset:13376
    v_accvgpr_write_b32 a161, v255
    v_accvgpr_write_b32 a162, v255
    v_mfma_f32_32x32x16_bf16 v[84:99], a[208:211], v[224:227], v[84:99]
    ds_read_b64_tr_b16 a[196:197], v10 offset:36864
    ds_read_b64_tr_b16 a[198:199], v10 offset:37888
    ds_read_b64_tr_b16 v[160:161], v168 offset:14336
    ds_read_b64_tr_b16 v[162:163], v168 offset:15360
    ds_read_b64_tr_b16 v[164:165], v168 offset:14400
    v_mov_b32 v7, v251
    v_mfma_f32_32x32x16_bf16 v[100:115], v[224:227], a[212:215], v[100:115]
    ds_read_b64_tr_b16 a[200:201], v11 offset:36864
    ds_read_b64_tr_b16 a[202:203], v11 offset:37376
    ds_read_b64_tr_b16 v[166:167], v168 offset:15424
    ds_read_b32 a255, v0
    ds_read_b32 a255, v0
    ds_read_b32 a255, v0
    ds_read_b32 a255, v0
    ds_read_b32 a255, v0
    ds_read_b32 a255, v0
    s_waitcnt lgkmcnt(6)
    v_mfma_f32_32x32x16_bf16 v[68:83], a[216:219], v[228:231], v[68:83]
    ds_read_b64_tr_b16 a[204:205], v9 offset:39936
    ds_read_b64_tr_b16 a[206:207], v9 offset:40960
    v_mov_b32 v8, v251
    v_accvgpr_write_b32 a163, v255
    v_accvgpr_write_b32 a164, v255
    v_accvgpr_write_b32 a165, v255
    v_mfma_f32_32x32x16_bf16 v[84:99], a[220:223], v[228:231], v[84:99]
    ds_read_b64_tr_b16 a[208:209], v10 offset:39936
    ds_read_b64_tr_b16 a[210:211], v10 offset:40960
    v_permlane32_swap_b32 v7, v8
    v_accvgpr_write_b32 a166, v255
    v_accvgpr_write_b32 a167, v255
    v_mfma_f32_32x32x16_bf16 v[100:115], v[228:231], a[224:227], v[100:115]
    ds_read_b64_tr_b16 a[212:213], v11 offset:39936
    ds_read_b64_tr_b16 a[214:215], v11 offset:40448
    v_accvgpr_write_b32 a168, v255
    v_mul_f32 v7, 0xbb000000, v7
    v_mfma_f32_32x32x16_bf16 v[68:83], a[192:195], v[232:235], v[68:83]
    ds_read_b64_tr_b16 a[216:217], v9 offset:43008
    ds_read_b64_tr_b16 a[218:219], v9 offset:44032
    v_mov_b32 v118, 0
    v_accvgpr_write_b32 a169, v255
    v_accvgpr_write_b32 a170, v255
    v_accvgpr_write_b32 a171, v255
    v_mfma_f32_32x32x16_bf16 v[84:99], a[196:199], v[232:235], v[84:99]
    ds_read_b64_tr_b16 a[220:221], v10 offset:43008
    ds_read_b64_tr_b16 a[222:223], v10 offset:44032
    buffer_store_dwordx4 v[152:155], v0, s[8:11], s90 offen offset:0 sc1
    v_mov_b32 v119, 0
    v_accvgpr_write_b32 a172, v255
    v_accvgpr_write_b32 a173, v255
    v_mfma_f32_32x32x16_bf16 v[100:115], v[232:235], a[200:203], v[100:115]
    ds_read_b64_tr_b16 a[224:225], v11 offset:43008
    ds_read_b64_tr_b16 a[226:227], v11 offset:43520
    v_cvt_pk_bf16_f32 v116, v7, v7
    v_accvgpr_write_b32 a174, v255
    s_waitcnt lgkmcnt(6)
    v_mfma_f32_32x32x16_bf16 v[68:83], a[204:207], v[236:239], v[68:83]
    ds_read_b64_tr_b16 a[192:193], v9 offset:46080
    ds_read_b64_tr_b16 a[194:195], v9 offset:47104
    buffer_store_dwordx4 v[156:159], v0, s[8:11], s91 offen offset:0 sc1
    v_accvgpr_write_b32 a175, v255
    v_lshlrev_b32 v8, 16, v116
    v_accvgpr_write_b32 a176, v255
    v_mfma_f32_32x32x16_bf16 v[84:99], a[208:211], v[236:239], v[84:99]
    ds_read_b64_tr_b16 a[196:197], v10 offset:46080
    ds_read_b64_tr_b16 a[198:199], v10 offset:47104
    v_accvgpr_write_b32 a177, v255
    v_sub_f32 v8, v7, v8
    v_cvt_pk_bf16_f32 v117, v8, v118
    v_accvgpr_write_b32 a178, v255
    v_mfma_f32_32x32x16_bf16 v[100:115], v[236:239], a[212:215], v[100:115]
    ds_read_b64_tr_b16 a[200:201], v11 offset:46080
    ds_read_b64_tr_b16 a[202:203], v11 offset:46592
    v_sub_u32 v8, v13, v0
    v_lshl_add_u32 v7, v1, 2, v8
    s_cmp_lg_u32 s3, 1
    s_cbranch_scc1 pl2
    s_mov_b32 s36, 0
    s_atomic_add s36, s[8:9], s40 glc
pl2:
    ds_read_b32 a255, v0
    s_waitcnt lgkmcnt(7)
    v_mfma_f32_32x32x16_bf16 v[68:83], a[216:219], v[240:243], v[68:83]
    ds_write_b32 v7, v251 offset:6144
    buffer_store_dwordx4 v[160:163], v0, s[8:11], s92 offen offset:0 sc1
    v_accvgpr_write_b32 a179, v255
    v_accvgpr_write_b32 a180, v255
    v_accvgpr_write_b32 a181, v255
    ds_read_b32 a255, v0
    ds_read_b32 a255, v0
    ds_read_b32 a255, v0
    ds_read_b32 a255, v0
    ds_read_b32 a255, v0
    s_waitcnt lgkmcnt(7)
    v_mfma_f32_32x32x16_bf16 v[68:83], a[192:195], v[244:247], v[68:83]
    v_accvgpr_write_b32 a182, v255
    v_accvgpr_write_b32 a183, v255
    v_accvgpr_write_b32 a184, v255
    v_accvgpr_write_b32 a185, v255
    v_accvgpr_write_b32 a186, v255
    v_mfma_f32_32x32x16_bf16 v[68:83], a[228:231], v[116:119], v[68:83]
    v_accvgpr_write_b32 a187, v255
    v_accvgpr_write_b32 a188, v255
    v_accvgpr_write_b32 a189, v255
    v_accvgpr_write_b32 a190, v255
    v_accvgpr_write_b32 a191, v255
    v_mfma_f32_32x32x16_bf16 v[84:99], a[220:223], v[240:243], v[84:99]
    buffer_store_dwordx4 v[164:167], v0, s[8:11], s93 offen offset:0 sc1
    s_nop 3
    v_mfma_f32_32x32x16_bf16 v[84:99], a[196:199], v[244:247], v[84:99]
    ds_write_b128 v13, v[76:79] offset:0
    v_mfma_f32_32x32x16_bf16 v[84:99], a[232:235], v[116:119], v[84:99]
    ds_write_b128 v13, v[80:83] offset:1024
    buffer_store_dwordx2 a[228:229], v170, s[8:11], s23 offen offset:0 sc1
    buffer_store_dwordx2 a[232:233], v170, s[8:11], s23 offen offset:512 sc1
    buffer_store_dwordx2 a[236:237], v170, s[8:11], s23 offen offset:1024 sc1
    s_nop 1
    v_mfma_f32_32x32x16_bf16 v[100:115], v[240:243], a[224:227], v[100:115]
    s_nop 4
    v_mfma_f32_32x32x16_bf16 v[100:115], v[244:247], a[200:203], v[100:115]
    ds_write_b128 v13, v[92:95] offset:2048
    v_mfma_f32_32x32x16_bf16 v[100:115], v[116:119], a[236:239], v[100:115]
    ds_write_b128 v13, v[96:99] offset:3072
    s_nop 10
    ds_write_b128 v13, v[108:111] offset:4096
    ds_write_b128 v13, v[112:115] offset:5120
    ds_read_b32 a255, v0
    ds_read_b32 a255, v0
    ds_read_b32 a255, v0
    ds_read_b32 a255, v0
    ds_read_b32 a255, v0
    ds_read_b32 a255, v0
    ds_read_b32 a255, v0
    s_waitcnt lgkmcnt(7)
    s_waitcnt lgkmcnt(0)
    s_cmp_lt_u32 s36, s42
    s_cbranch_scc1 ta0_sp
ta0_go:
    s_barrier
    buffer_load_dwordx4 v[20:23], v0, s[12:15], s78 offen offset:0 sc1
    v_xor_b32 v7, 16, v1
    v_sub_u32 v8, v14, v0
    v_lshl_add_u32 v7, v7, 2, v8
    ds_read_b32 v116, v7 offset:6144
    v_xor_b32 v8, 256, v14
    ds_read_b128 v[76:79], v8 offset:0
    ds_read_b128 v[80:83], v8 offset:1024
    buffer_load_dwordx4 a[0:3], v0, s[12:15], s80 offen offset:0 sc1
    ds_read_b128 v[92:95], v8 offset:2048
    ds_read_b128 v[96:99], v8 offset:3072
    ds_read_b128 v[108:111], v14 offset:4096
    ds_read_b128 v[112:115], v14 offset:5120
    s_waitcnt lgkmcnt(4)
    buffer_load_dwordx4 v[24:27], v0, s[12:15], s78 offen offset:1024 sc1
    v_add_f32 v68, v68, v76
    v_add_f32 v116, v251, v116
    v_add_f32 v69, v69, v77
    v_mov_b32 v117, v116
    v_add_f32 v70, v70, v78
    s_nop 0
    v_permlane32_swap_b32 v116, v117
    s_mov_b64 exec, s[20:21]
    buffer_load_dwordx4 a[64:67], v248, s[12:15], s84 offen offset:0 sc1
    buffer_load_dwordx4 a[68:71], v248, s[12:15], s84 offen offset:512 sc1
    s_mov_b64 exec, -1
    v_add_f32 v71, v71, v79
    v_add_f32 v72, v72, v80
    v_add_f32 v73, v73, v81
    v_mul_f32 v116, 0.001953125, v116
    v_add_f32 v74, v74, v82
    v_mul_f32 v117, 0.001953125, v117
    v_add_f32 v75, v75, v83
    v_fma_f32 v117, -v116, v116, v117
    s_waitcnt lgkmcnt(2)
    v_max_f32 v117, 0, v117
    v_add_f32 v84, v84, v92
    v_add_f32 v85, v85, v93
    v_add_f32 v117, 0x3727c5ac, v117
    v_add_f32 v86, v86, v94
    v_rsq_f32 v18, v117
    v_add_f32 v87, v87, v95
    v_add_f32 v88, v88, v96
    v_and_b32 v7, 31, v1
    v_add_f32 v89, v89, v97
    v_sub_u32 v8, v13, v0
    v_add_f32 v90, v90, v98
    v_add_f32 v91, v91, v99
    v_lshl_add_u32 v7, v7, 2, v8
    s_waitcnt lgkmcnt(0)
    ds_write_b32 v7, v18 offset:7168
    buffer_load_dwordx4 v[172:175], v0, s[12:15], s78 offen offset:2048 sc1
    v_add_f32 v100, v100, v108
    v_lshrrev_b32 v7, 5, v1
    v_add_f32 v101, v101, v109
    v_lshl_add_u32 v7, v7, 4, v8
    v_add_f32 v102, v102, v110
    v_add_f32 v103, v103, v111
    buffer_load_dwordx4 v[176:179], v0, s[12:15], s78 offen offset:3072 sc1
    v_mul_f32 v17, s58, v18
    v_add_f32 v104, v104, v112
    s_waitcnt lgkmcnt(0)
    v_add_f32 v105, v105, v113
    ds_read_b128 v[128:131], v7 offset:7168
    v_add_f32 v106, v106, v114
    ds_read_b128 v[132:135], v7 offset:7200
    buffer_load_dwordx4 a[4:7], v0, s[12:15], s80 offen offset:1024 sc1
    v_add_f32 v107, v107, v115
    v_mul_f32 v68, v68, v17
    v_mul_f32 v69, v69, v17
    v_mul_f32 v70, v70, v17
    v_mul_f32 v71, v71, v17
    v_mul_f32 v72, v72, v17
    s_mov_b64 exec, s[20:21]
    buffer_load_dwordx4 a[72:75], v248, s[12:15], s84 offen offset:1024 sc1
    buffer_load_dwordx4 a[76:79], v248, s[12:15], s84 offen offset:1536 sc1
    s_mov_b64 exec, -1
    v_mul_f32 v73, v73, v17
    v_mul_f32 v74, v74, v17
    v_mul_f32 v75, v75, v17
    v_cvt_pk_bf16_f32 v68, v68, v69
    v_cvt_pk_bf16_f32 v69, v70, v71
    v_cvt_pk_bf16_f32 v70, v72, v73
    v_cvt_pk_bf16_f32 v71, v74, v75
    v_mul_f32 v84, v84, v17
    v_mul_f32 v85, v85, v17
    v_mul_f32 v86, v86, v17
    v_mul_f32 v87, v87, v17
    v_mul_f32 v88, v88, v17
    v_mul_f32 v89, v89, v17
    v_mul_f32 v90, v90, v17
    v_mul_f32 v91, v91, v17
    v_cvt_pk_bf16_f32 v84, v84, v85
    v_cvt_pk_bf16_f32 v85, v86, v87
    v_cvt_pk_bf16_f32 v86, v88, v89
    v_cvt_pk_bf16_f32 v87, v90, v91
    s_waitcnt lgkmcnt(0)
    v_mul_f32 v100, v100, v128
    v_mul_f32 v101, v101, v129
    v_mul_f32 v102, v102, v130
    v_mul_f32 v103, v103, v131
    v_mul_f32 v104, v104, v132
    v_mul_f32 v105, v105, v133
    buffer_load_dwordx4 a[8:11], v0, s[12:15], s80 offen offset:2048 sc1
    v_mul_f32 v106, v106, v134
    v_mul_f32 v107, v107, v135
    v_cvt_pk_bf16_f32 v100, v100, v101
    v_cvt_pk_bf16_f32 v101, v102, v103
    v_cvt_pk_bf16_f32 v102, v104, v105
    v_cvt_pk_bf16_f32 v103, v106, v107
    buffer_store_dwordx4 v[68:71], v15, s[12:15], s66 offen offset:0 sc1
    buffer_store_dwordx4 v[84:87], v15, s[12:15], s67 offen offset:0 sc1
    buffer_store_dwordx4 v[100:103], v16, s[12:15], s68 offen offset:0 sc1
L_att:
    v_mov_b32 v14, 0
    v_mov_b32 v15, 0
    v_mov_b32 v9, 0xdddddddd
    s_lshl_b32 s22, s3, 11
    s_add_u32 s22, s22, 98304
    v_mfma_f32_32x32x8_bf16 v[28:43], v[14:15], v[14:15], 0
    v_add_u32 v10, s22, v0
    s_lshl_b32 s22, s3, 2
    s_add_u32 s22, s22, 131072
    v_add_u32 v11, s22, v0
    v_mfma_f32_32x32x8_bf16 v[44:59], v[14:15], v[14:15], 0
    s_waitcnt vmcnt(12)
    v_mfma_f32_32x32x16_bf16 v[60:75], a[0:3], v[20:23], 0
    v_mfma_f32_32x32x8_bf16 v[120:135], v[14:15], v[14:15], 0
    s_waitcnt vmcnt(11)
    v_mfma_f32_32x32x16_bf16 v[76:91], a[0:3], v[24:27], 0
    v_mfma_f32_32x32x8_bf16 v[136:151], v[14:15], v[14:15], 0
    s_nop 7
    v_exp_f32 v60, v60
    v_exp_f32 v61, v61
    v_exp_f32 v62, v62
    v_exp_f32 v63, v63
    v_exp_f32 v64, v64
    s_waitcnt vmcnt(8)
    v_mfma_f32_32x32x16_bf16 v[92:107], a[0:3], v[172:175], 0
    v_exp_f32 v65, v65
    v_exp_f32 v66, v66
    v_exp_f32 v67, v67
    v_exp_f32 v68, v68
    v_exp_f32 v69, v69
    v_smfmac_f32_32x32x32_bf16 v[28:43], a[64:67], v[60:67], v9
    v_exp_f32 v70, v70
    v_exp_f32 v71, v71
    v_exp_f32 v72, v72
    v_exp_f32 v73, v73
    v_exp_f32 v74, v74
    v_exp_f32 v75, v75
    v_exp_f32 v76, v76
    v_exp_f32 v77, v77
    v_smfmac_f32_32x32x32_bf16 v[28:43], a[68:71], v[68:75], v9
    v_exp_f32 v78, v78
    v_exp_f32 v79, v79
    v_exp_f32 v80, v80
    s_waitcnt vmcnt(7)
    v_mfma_f32_32x32x16_bf16 v[60:75], a[0:3], v[176:179], 0
    s_mov_b64 exec, s[20:21]
    buffer_load_dwordx4 a[80:83], v248, s[12:15], s84 offen offset:2048 sc1
    buffer_load_dwordx4 a[84:87], v248, s[12:15], s84 offen offset:2560 sc1
    s_mov_b64 exec, -1
    v_exp_f32 v81, v81
    v_exp_f32 v82, v82
    v_exp_f32 v83, v83
    v_exp_f32 v84, v84
    v_exp_f32 v85, v85
    v_smfmac_f32_32x32x32_bf16 v[44:59], a[64:67], v[76:83], v9
    v_exp_f32 v86, v86
    v_exp_f32 v87, v87
    v_exp_f32 v88, v88
    v_exp_f32 v89, v89
    v_exp_f32 v90, v90
    v_exp_f32 v91, v91
    v_exp_f32 v92, v92
    v_exp_f32 v93, v93
    v_smfmac_f32_32x32x32_bf16 v[44:59], a[68:71], v[84:91], v9
    v_exp_f32 v94, v94
    v_exp_f32 v95, v95
    v_exp_f32 v96, v96
    s_waitcnt vmcnt(8)
    v_mfma_f32_32x32x16_bf16 v[76:91], a[4:7], v[20:23], 0
    buffer_load_dwordx4 a[12:15], v0, s[12:15], s80 offen offset:3072 sc1
    v_exp_f32 v97, v97
    v_exp_f32 v98, v98
    v_exp_f32 v99, v99
    v_exp_f32 v100, v100
    v_exp_f32 v101, v101
    v_smfmac_f32_32x32x32_bf16 v[120:135], a[64:67], v[92:99], v9
    v_exp_f32 v102, v102
    v_exp_f32 v103, v103
    v_exp_f32 v104, v104
    v_exp_f32 v105, v105
    v_exp_f32 v106, v106
    v_exp_f32 v107, v107
    v_exp_f32 v60, v60
    v_exp_f32 v61, v61
    v_smfmac_f32_32x32x32_bf16 v[120:135], a[68:71], v[100:107], v9
    v_exp_f32 v62, v62
    v_exp_f32 v63, v63
    v_exp_f32 v64, v64
    v_mfma_f32_32x32x16_bf16 v[92:107], a[4:7], v[24:27], 0
    v_exp_f32 v65, v65
    v_exp_f32 v66, v66
    v_exp_f32 v67, v67
    v_exp_f32 v68, v68
    v_exp_f32 v69, v69
    v_smfmac_f32_32x32x32_bf16 v[136:151], a[64:67], v[60:67], v9
    v_exp_f32 v70, v70
    v_exp_f32 v71, v71
    v_exp_f32 v72, v72
    v_exp_f32 v73, v73
    v_exp_f32 v74, v74
    v_exp_f32 v75, v75
    v_exp_f32 v76, v76
    v_exp_f32 v77, v77
    v_smfmac_f32_32x32x32_bf16 v[136:151], a[68:71], v[68:75], v9
    v_exp_f32 v78, v78
    v_exp_f32 v79, v79
    v_exp_f32 v80, v80
    v_mfma_f32_32x32x16_bf16 v[60:75], a[4:7], v[172:175], 0
    s_mov_b64 exec, s[20:21]
    buffer_load_dwordx4 a[88:91], v248, s[12:15], s84 offen offset:3072 sc1
    buffer_load_dwordx4 a[92:95], v248, s[12:15], s84 offen offset:3584 sc1
    s_mov_b64 exec, -1
    v_exp_f32 v81, v81
    v_exp_f32 v82, v82
    v_exp_f32 v83, v83
    v_exp_f32 v84, v84
    v_exp_f32 v85, v85
    s_waitcnt vmcnt(9)
    v_smfmac_f32_32x32x32_bf16 v[28:43], a[72:75], v[76:83], v9
    v_exp_f32 v86, v86
    v_exp_f32 v87, v87
    v_exp_f32 v88, v88
    v_exp_f32 v89, v89
    v_exp_f32 v90, v90
    v_exp_f32 v91, v91
    v_exp_f32 v92, v92
    v_exp_f32 v93, v93
    v_smfmac_f32_32x32x32_bf16 v[28:43], a[76:79], v[84:91], v9
    v_exp_f32 v94, v94
    v_exp_f32 v95, v95
    v_exp_f32 v96, v96
    v_mfma_f32_32x32x16_bf16 v[76:91], a[4:7], v[176:179], 0
    buffer_load_dwordx4 a[16:19], v0, s[12:15], s81 offen offset:0 sc1
    v_exp_f32 v97, v97
    v_exp_f32 v98, v98
    v_exp_f32 v99, v99
    v_exp_f32 v100, v100
    v_exp_f32 v101, v101
    v_smfmac_f32_32x32x32_bf16 v[44:59], a[72:75], v[92:99], v9
    v_exp_f32 v102, v102
    v_exp_f32 v103, v103
    v_exp_f32 v104, v104
    v_exp_f32 v105, v105
    v_exp_f32 v106, v106
    v_exp_f32 v107, v107
    v_exp_f32 v60, v60
    v_exp_f32 v61, v61
    v_smfmac_f32_32x32x32_bf16 v[44:59], a[76:79], v[100:107], v9
    v_exp_f32 v62, v62
    v_exp_f32 v63, v63
    v_exp_f32 v64, v64
    s_waitcnt vmcnt(9)
    v_mfma_f32_32x32x16_bf16 v[92:107], a[8:11], v[20:23], 0
    v_exp_f32 v65, v65
    v_exp_f32 v66, v66
    v_exp_f32 v67, v67
    v_exp_f32 v68, v68
    v_exp_f32 v69, v69
    v_smfmac_f32_32x32x32_bf16 v[120:135], a[72:75], v[60:67], v9
    v_exp_f32 v70, v70
    v_exp_f32 v71, v71
    v_exp_f32 v72, v72
    v_exp_f32 v73, v73
    v_exp_f32 v74, v74
    v_exp_f32 v75, v75
    v_exp_f32 v76, v76
    v_exp_f32 v77, v77
    v_smfmac_f32_32x32x32_bf16 v[120:135], a[76:79], v[68:75], v9
    v_exp_f32 v78, v78
    v_exp_f32 v79, v79
    v_exp_f32 v80, v80
    v_mfma_f32_32x32x16_bf16 v[60:75], a[8:11], v[24:27], 0
    s_mov_b64 exec, s[20:21]
    buffer_load_dwordx4 a[96:99], v248, s[12:15], s85 offen offset:0 sc1
    buffer_load_dwordx4 a[100:103], v248, s[12:15], s85 offen offset:512 sc1
    s_mov_b64 exec, -1
    v_exp_f32 v81, v81
    v_exp_f32 v82, v82
    v_exp_f32 v83, v83
    v_exp_f32 v84, v84
    v_exp_f32 v85, v85
    v_smfmac_f32_32x32x32_bf16 v[136:151], a[72:75], v[76:83], v9
    s_waitcnt lgkmcnt(0)
    s_waitcnt vmcnt(8)
    s_barrier
    s_cmp_lg_u32 s3, 0
    s_cbranch_scc1 sg3
    s_add_u32 s51, s69, 8192
    s_atomic_add s7, s[8:9], s51
    s_add_u32 s51, s69, 8320
    s_atomic_add s7, s[8:9], s51
    s_add_u32 s51, s41, 8192
    s_atomic_add s7, s[8:9], s51
    s_add_u32 s51, s41, 8320
    s_atomic_add s7, s[8:9], s51
    s_add_u32 s51, s41, 8704
    s_atomic_add s7, s[8:9], s51
    s_add_u32 s51, s41, 8832
    s_atomic_add s7, s[8:9], s51
sg3:
    s_cmp_lg_u32 s6, 0
    s_cbranch_scc1 cva
    s_lshl_b32 s22, s4, 7
    s_add_u32 s22, s22, 5251072
    s_mov_b32 s23, s3
    s_cmp_eq_u32 s23, 0
    s_cselect_b32 s22, s22, s50
    s_mov_b32 s46, 1
    s_atomic_add s46, s[8:9], s22 glc
cva:
    v_exp_f32 v86, v86
    v_exp_f32 v87, v87
    v_exp_f32 v88, v88
    v_exp_f32 v89, v89
    v_exp_f32 v90, v90
    v_exp_f32 v91, v91
    v_exp_f32 v92, v92
    v_exp_f32 v93, v93
    v_smfmac_f32_32x32x32_bf16 v[136:151], a[76:79], v[84:91], v9
    v_exp_f32 v94, v94
    v_exp_f32 v95, v95
    v_exp_f32 v96, v96
    v_mfma_f32_32x32x16_bf16 v[76:91], a[8:11], v[172:175], 0
    buffer_load_dwordx4 a[20:23], v0, s[12:15], s81 offen offset:1024 sc1
    v_exp_f32 v97, v97
    v_exp_f32 v98, v98
    v_exp_f32 v99, v99
    v_exp_f32 v100, v100
    v_exp_f32 v101, v101
    s_waitcnt vmcnt(7)
    v_smfmac_f32_32x32x32_bf16 v[28:43], a[80:83], v[92:99], v9
    v_exp_f32 v102, v102
    v_exp_f32 v103, v103
    v_exp_f32 v104, v104
    v_exp_f32 v105, v105
    v_exp_f32 v106, v106
    v_exp_f32 v107, v107
    v_exp_f32 v60, v60
    v_exp_f32 v61, v61
    v_smfmac_f32_32x32x32_bf16 v[28:43], a[84:87], v[100:107], v9
    v_exp_f32 v62, v62
    v_exp_f32 v63, v63
    v_exp_f32 v64, v64
    v_mfma_f32_32x32x16_bf16 v[92:107], a[8:11], v[176:179], 0
    v_exp_f32 v65, v65
    v_exp_f32 v66, v66
    v_exp_f32 v67, v67
    v_exp_f32 v68, v68
    v_exp_f32 v69, v69
    v_smfmac_f32_32x32x32_bf16 v[44:59], a[80:83], v[60:67], v9
    v_exp_f32 v70, v70
    v_exp_f32 v71, v71
    v_exp_f32 v72, v72
    v_exp_f32 v73, v73
    v_exp_f32 v74, v74
    v_exp_f32 v75, v75
    v_exp_f32 v76, v76
    v_exp_f32 v77, v77
    v_smfmac_f32_32x32x32_bf16 v[44:59], a[84:87], v[68:75], v9
    v_exp_f32 v78, v78
    v_exp_f32 v79, v79
    v_exp_f32 v80, v80
    s_waitcnt vmcnt(6)
    v_mfma_f32_32x32x16_bf16 v[60:75], a[12:15], v[20:23], 0
    s_mov_b64 exec, s[20:21]
    buffer_load_dwordx4 a[104:107], v248, s[12:15], s85 offen offset:1024 sc1
    buffer_load_dwordx4 a[108:111], v248, s[12:15], s85 offen offset:1536 sc1
    s_mov_b64 exec, -1
    v_exp_f32 v81, v81
    v_exp_f32 v82, v82
    v_exp_f32 v83, v83
    v_exp_f32 v84, v84
    v_exp_f32 v85, v85
    v_smfmac_f32_32x32x32_bf16 v[120:135], a[80:83], v[76:83], v9
    v_exp_f32 v86, v86
    v_exp_f32 v87, v87
    v_exp_f32 v88, v88
    v_exp_f32 v89, v89
    v_exp_f32 v90, v90
    v_exp_f32 v91, v91
    v_exp_f32 v92, v92
    v_exp_f32 v93, v93
    v_smfmac_f32_32x32x32_bf16 v[120:135], a[84:87], v[84:91], v9
    v_exp_f32 v94, v94
    v_exp_f32 v95, v95
    v_exp_f32 v96, v96
    v_mfma_f32_32x32x16_bf16 v[76:91], a[12:15], v[24:27], 0
    buffer_load_dwordx4 a[24:27], v0, s[12:15], s81 offen offset:2048 sc1
    v_exp_f32 v97, v97
    v_exp_f32 v98, v98
    v_exp_f32 v99, v99
    v_exp_f32 v100, v100
    v_exp_f32 v101, v101
    v_smfmac_f32_32x32x32_bf16 v[136:151], a[80:83], v[92:99], v9
    v_exp_f32 v102, v102
    v_exp_f32 v103, v103
    v_exp_f32 v104, v104
    v_exp_f32 v105, v105
    v_exp_f32 v106, v106
    v_exp_f32 v107, v107
    v_exp_f32 v60, v60
    v_exp_f32 v61, v61
    v_smfmac_f32_32x32x32_bf16 v[136:151], a[84:87], v[100:107], v9
    v_exp_f32 v62, v62
    v_exp_f32 v63, v63
    v_exp_f32 v64, v64
    v_mfma_f32_32x32x16_bf16 v[92:107], a[12:15], v[172:175], 0
    v_exp_f32 v65, v65
    v_exp_f32 v66, v66
    v_exp_f32 v67, v67
    v_exp_f32 v68, v68
    v_exp_f32 v69, v69
    s_waitcnt vmcnt(7)
    v_smfmac_f32_32x32x32_bf16 v[28:43], a[88:91], v[60:67], v9
    v_exp_f32 v70, v70
    v_exp_f32 v71, v71
    v_exp_f32 v72, v72
    v_exp_f32 v73, v73
    v_exp_f32 v74, v74
    v_exp_f32 v75, v75
    v_exp_f32 v76, v76
    v_exp_f32 v77, v77
    v_smfmac_f32_32x32x32_bf16 v[28:43], a[92:95], v[68:75], v9
    v_exp_f32 v78, v78
    v_exp_f32 v79, v79
    v_exp_f32 v80, v80
    v_mfma_f32_32x32x16_bf16 v[60:75], a[12:15], v[176:179], 0
    s_mov_b64 exec, s[20:21]
    buffer_load_dwordx4 a[112:115], v248, s[12:15], s85 offen offset:2048 sc1
    buffer_load_dwordx4 a[116:119], v248, s[12:15], s85 offen offset:2560 sc1
    s_mov_b64 exec, -1
    v_exp_f32 v81, v81
    v_exp_f32 v82, v82
    v_exp_f32 v83, v83
    v_exp_f32 v84, v84
    v_exp_f32 v85, v85
    v_smfmac_f32_32x32x32_bf16 v[44:59], a[88:91], v[76:83], v9
    v_exp_f32 v86, v86
    v_exp_f32 v87, v87
    v_exp_f32 v88, v88
    v_exp_f32 v89, v89
    v_exp_f32 v90, v90
    v_exp_f32 v91, v91
    v_exp_f32 v92, v92
    v_exp_f32 v93, v93
    v_smfmac_f32_32x32x32_bf16 v[44:59], a[92:95], v[84:91], v9
    v_exp_f32 v94, v94
    v_exp_f32 v95, v95
    v_exp_f32 v96, v96
    s_waitcnt vmcnt(8)
    v_mfma_f32_32x32x16_bf16 v[76:91], a[16:19], v[20:23], 0
    buffer_load_dwordx4 a[28:31], v0, s[12:15], s81 offen offset:3072 sc1
    v_exp_f32 v97, v97
    v_exp_f32 v98, v98
    v_exp_f32 v99, v99
    v_exp_f32 v100, v100
    v_exp_f32 v101, v101
    v_smfmac_f32_32x32x32_bf16 v[120:135], a[88:91], v[92:99], v9
    v_exp_f32 v102, v102
    v_exp_f32 v103, v103
    v_exp_f32 v104, v104
    v_exp_f32 v105, v105
    v_exp_f32 v106, v106
    v_exp_f32 v107, v107
    v_exp_f32 v60, v60
    v_exp_f32 v61, v61
    v_smfmac_f32_32x32x32_bf16 v[120:135], a[92:95], v[100:107], v9
    s_cmp_lg_u32 s6, 0
    s_cbranch_scc1 cvb
    s_waitcnt lgkmcnt(0)
    s_mov_b32 s22, 5252096
    s_cmp_eq_u32 s46, 31
    s_cselect_b32 s23, s23, 1
    s_cmp_eq_u32 s23, 0
    s_cselect_b32 s22, s22, s50
    s_mov_b32 s46, 1
    s_atomic_add s46, s[8:9], s22 glc
cvb:
    v_exp_f32 v62, v62
    v_exp_f32 v63, v63
    v_exp_f32 v64, v64
    v_mfma_f32_32x32x16_bf16 v[92:107], a[16:19], v[24:27], 0
    v_exp_f32 v65, v65
    v_exp_f32 v66, v66
    v_exp_f32 v67, v67
    v_exp_f32 v68, v68
    v_exp_f32 v69, v69
    v_smfmac_f32_32x32x32_bf16 v[136:151], a[88:91], v[60:67], v9
    v_exp_f32 v70, v70
    v_exp_f32 v71, v71
    v_exp_f32 v72, v72
    v_exp_f32 v73, v73
    v_exp_f32 v74, v74
    v_exp_f32 v75, v75
    v_exp_f32 v76, v76
    v_exp_f32 v77, v77
    v_smfmac_f32_32x32x32_bf16 v[136:151], a[92:95], v[68:75], v9
    v_exp_f32 v78, v78
    v_exp_f32 v79, v79
    v_exp_f32 v80, v80
    v_mfma_f32_32x32x16_bf16 v[60:75], a[16:19], v[172:175], 0
    s_mov_b64 exec, s[20:21]
    buffer_load_dwordx4 a[120:123], v248, s[12:15], s85 offen offset:3072 sc1
    buffer_load_dwordx4 a[124:127], v248, s[12:15], s85 offen offset:3584 sc1
    s_mov_b64 exec, -1
    v_exp_f32 v81, v81
    v_exp_f32 v82, v82
    v_exp_f32 v83, v83
    v_exp_f32 v84, v84
    v_exp_f32 v85, v85
    s_waitcnt vmcnt(9)
    v_smfmac_f32_32x32x32_bf16 v[28:43], a[96:99], v[76:83], v9
    v_exp_f32 v86, v86
    v_exp_f32 v87, v87
    v_exp_f32 v88, v88
    v_exp_f32 v89, v89
    v_exp_f32 v90, v90
    v_exp_f32 v91, v91
    v_exp_f32 v92, v92
    v_exp_f32 v93, v93
    v_smfmac_f32_32x32x32_bf16 v[28:43], a[100:103], v[84:91], v9
    v_exp_f32 v94, v94
    v_exp_f32 v95, v95
    v_exp_f32 v96, v96
    v_mfma_f32_32x32x16_bf16 v[76:91], a[16:19], v[176:179], 0
    v_exp_f32 v97, v97
    v_exp_f32 v98, v98
    v_exp_f32 v99, v99
    v_exp_f32 v100, v100
    v_exp_f32 v101, v101
    v_smfmac_f32_32x32x32_bf16 v[44:59], a[96:99], v[92:99], v9
    v_exp_f32 v102, v102
    v_exp_f32 v103, v103
    v_exp_f32 v104, v104
    v_exp_f32 v105, v105
    v_exp_f32 v106, v106
    v_exp_f32 v107, v107
    v_exp_f32 v60, v60
    v_exp_f32 v61, v61
    v_smfmac_f32_32x32x32_bf16 v[44:59], a[100:103], v[100:107], v9
    v_exp_f32 v62, v62
    v_exp_f32 v63, v63
    v_exp_f32 v64, v64
    s_waitcnt vmcnt(8)
    v_mfma_f32_32x32x16_bf16 v[92:107], a[20:23], v[20:23], 0
    v_exp_f32 v65, v65
    v_exp_f32 v66, v66
    v_exp_f32 v67, v67
    v_exp_f32 v68, v68
    v_exp_f32 v69, v69
    v_smfmac_f32_32x32x32_bf16 v[120:135], a[96:99], v[60:67], v9
    v_exp_f32 v70, v70
    v_exp_f32 v71, v71
    v_exp_f32 v72, v72
    v_exp_f32 v73, v73
    v_exp_f32 v74, v74
    v_exp_f32 v75, v75
    v_exp_f32 v76, v76
    v_exp_f32 v77, v77
    v_smfmac_f32_32x32x32_bf16 v[120:135], a[100:103], v[68:75], v9
    s_add_u32 s40, s40, 8192
    s_cmp_lg_u32 s3, 1
    s_cbranch_scc1 pl4
    s_mov_b32 s36, 0
    s_atomic_add s36, s[8:9], s40 glc
pl4:
    v_exp_f32 v78, v78
    v_exp_f32 v79, v79
    v_exp_f32 v80, v80
    v_mfma_f32_32x32x16_bf16 v[60:75], a[20:23], v[24:27], 0
    v_exp_f32 v81, v81
    v_exp_f32 v82, v82
    v_exp_f32 v83, v83
    v_exp_f32 v84, v84
    v_exp_f32 v85, v85
    v_smfmac_f32_32x32x32_bf16 v[136:151], a[96:99], v[76:83], v9
    v_exp_f32 v86, v86
    v_exp_f32 v87, v87
    v_exp_f32 v88, v88
    v_exp_f32 v89, v89
    v_exp_f32 v90, v90
    v_exp_f32 v91, v91
    v_exp_f32 v92, v92
    v_exp_f32 v93, v93
    v_smfmac_f32_32x32x32_bf16 v[136:151], a[100:103], v[84:91], v9
    v_exp_f32 v94, v94
    v_exp_f32 v95, v95
    v_exp_f32 v96, v96
    v_mfma_f32_32x32x16_bf16 v[76:91], a[20:23], v[172:175], 0
    v_exp_f32 v97, v97
    v_exp_f32 v98, v98
    v_exp_f32 v99, v99
    v_exp_f32 v100, v100
    v_exp_f32 v101, v101
    s_waitcnt vmcnt(6)
    v_smfmac_f32_32x32x32_bf16 v[28:43], a[104:107], v[92:99], v9
    v_exp_f32 v102, v102
    v_exp_f32 v103, v103
    v_exp_f32 v104, v104
    v_exp_f32 v105, v105
    v_exp_f32 v106, v106
    v_exp_f32 v107, v107
    v_exp_f32 v60, v60
    v_exp_f32 v61, v61
    v_smfmac_f32_32x32x32_bf16 v[28:43], a[108:111], v[100:107], v9
    v_exp_f32 v62, v62
    v_exp_f32 v63, v63
    v_exp_f32 v64, v64
    v_mfma_f32_32x32x16_bf16 v[92:107], a[20:23], v[176:179], 0
    v_exp_f32 v65, v65
    v_exp_f32 v66, v66
    v_exp_f32 v67, v67
    v_exp_f32 v68, v68
    v_exp_f32 v69, v69
    v_smfmac_f32_32x32x32_bf16 v[44:59], a[104:107], v[60:67], v9
    v_exp_f32 v70, v70
    v_exp_f32 v71, v71
    v_exp_f32 v72, v72
    v_exp_f32 v73, v73
    v_exp_f32 v74, v74
    v_exp_f32 v75, v75
    v_exp_f32 v76, v76
    v_exp_f32 v77, v77
    v_smfmac_f32_32x32x32_bf16 v[44:59], a[108:111], v[68:75], v9
    v_exp_f32 v78, v78
    v_exp_f32 v79, v79
    v_exp_f32 v80, v80
    s_waitcnt vmcnt(5)
    v_mfma_f32_32x32x16_bf16 v[60:75], a[24:27], v[20:23], 0
    v_exp_f32 v81, v81
    v_exp_f32 v82, v82
    v_exp_f32 v83, v83
    v_exp_f32 v84, v84
    v_exp_f32 v85, v85
    v_smfmac_f32_32x32x32_bf16 v[120:135], a[104:107], v[76:83], v9
    v_exp_f32 v86, v86
    v_exp_f32 v87, v87
    v_exp_f32 v88, v88
    v_exp_f32 v89, v89
    v_exp_f32 v90, v90
    v_exp_f32 v91, v91
    v_exp_f32 v92, v92
    v_exp_f32 v93, v93
    v_smfmac_f32_32x32x32_bf16 v[120:135], a[108:111], v[84:91], v9
    v_exp_f32 v94, v94
    v_exp_f32 v95, v95
    v_exp_f32 v96, v96
    v_mfma_f32_32x32x16_bf16 v[76:91], a[24:27], v[24:27], 0
    v_exp_f32 v97, v97
    v_exp_f32 v98, v98
    v_exp_f32 v99, v99
    v_exp_f32 v100, v100
    v_exp_f32 v101, v101
    v_smfmac_f32_32x32x32_bf16 v[136:151], a[104:107], v[92:99], v9
    v_exp_f32 v102, v102
    v_exp_f32 v103, v103
    v_exp_f32 v104, v104
    v_exp_f32 v105, v105
    v_exp_f32 v106, v106
    v_exp_f32 v107, v107
    v_exp_f32 v60, v60
    v_exp_f32 v61, v61
    v_smfmac_f32_32x32x32_bf16 v[136:151], a[108:111], v[100:107], v9
    v_exp_f32 v62, v62
    v_exp_f32 v63, v63
    v_exp_f32 v64, v64
    v_mfma_f32_32x32x16_bf16 v[92:107], a[24:27], v[172:175], 0
    v_exp_f32 v65, v65
    v_exp_f32 v66, v66
    v_exp_f32 v67, v67
    v_exp_f32 v68, v68
    v_exp_f32 v69, v69
    s_waitcnt vmcnt(3)
    v_smfmac_f32_32x32x32_bf16 v[28:43], a[112:115], v[60:67], v9
    v_exp_f32 v70, v70
    v_exp_f32 v71, v71
    v_exp_f32 v72, v72
    v_exp_f32 v73, v73
    v_exp_f32 v74, v74
    v_exp_f32 v75, v75
    v_exp_f32 v76, v76
    v_exp_f32 v77, v77
    v_smfmac_f32_32x32x32_bf16 v[28:43], a[116:119], v[68:75], v9
    s_waitcnt lgkmcnt(0)
    s_cmp_lt_u32 s36, s42
    s_cbranch_scc1 tb_sp
tb_go:
    s_barrier
    v_exp_f32 v78, v78
    v_exp_f32 v79, v79
    v_exp_f32 v80, v80
    v_mfma_f32_32x32x16_bf16 v[60:75], a[24:27], v[176:179], 0
    v_exp_f32 v81, v81
    v_exp_f32 v82, v82
    v_exp_f32 v83, v83
    v_exp_f32 v84, v84
    v_exp_f32 v85, v85
    v_smfmac_f32_32x32x32_bf16 v[44:59], a[112:115], v[76:83], v9
    v_exp_f32 v86, v86
    v_exp_f32 v87, v87
    v_exp_f32 v88, v88
    v_exp_f32 v89, v89
    v_exp_f32 v90, v90
    v_exp_f32 v91, v91
    v_exp_f32 v92, v92
    v_exp_f32 v93, v93
    v_smfmac_f32_32x32x32_bf16 v[44:59], a[116:119], v[84:91], v9
    v_exp_f32 v94, v94
    v_exp_f32 v95, v95
    v_exp_f32 v96, v96
    s_waitcnt vmcnt(2)
    v_mfma_f32_32x32x16_bf16 v[76:91], a[28:31], v[20:23], 0
    buffer_load_dwordx4 a[32:35], v0, s[12:15], s82 offen offset:0 sc1
    v_exp_f32 v97, v97
    v_exp_f32 v98, v98
    v_exp_f32 v99, v99
    v_exp_f32 v100, v100
    v_exp_f32 v101, v101
    v_smfmac_f32_32x32x32_bf16 v[120:135], a[112:115], v[92:99], v9
    v_exp_f32 v102, v102
    v_exp_f32 v103, v103
    v_exp_f32 v104, v104
    v_exp_f32 v105, v105
    v_exp_f32 v106, v106
    v_exp_f32 v107, v107
    v_exp_f32 v60, v60
    v_exp_f32 v61, v61
    v_smfmac_f32_32x32x32_bf16 v[120:135], a[116:119], v[100:107], v9
    s_mov_b32 s32, 5252224
    s_cmp_lg_u32 s6, 0
    s_cbranch_scc1 cvc
    s_waitcnt lgkmcnt(0)
    s_cmp_eq_u32 s46, 7
    s_cselect_b32 s23, s23, 1
    s_cmp_eq_u32 s23, 0
    s_cselect_b32 s22, 0, 4026531840
    v_or_b32 v17, s22, v4
    buffer_store_dword v3, v17, s[8:11], s32 offen sc1
cvc:
    v_exp_f32 v62, v62
    v_exp_f32 v63, v63
    v_exp_f32 v64, v64
    v_mfma_f32_32x32x16_bf16 v[92:107], a[28:31], v[24:27], 0
    s_mov_b64 exec, s[20:21]
    buffer_load_dwordx4 a[128:131], v248, s[12:15], s86 offen offset:0 sc1
    buffer_load_dwordx4 a[132:135], v248, s[12:15], s86 offen offset:512 sc1
    s_mov_b64 exec, -1
    v_exp_f32 v65, v65
    v_exp_f32 v66, v66
    v_exp_f32 v67, v67
    v_exp_f32 v68, v68
    v_exp_f32 v69, v69
    v_smfmac_f32_32x32x32_bf16 v[136:151], a[112:115], v[60:67], v9
    v_exp_f32 v70, v70
    v_exp_f32 v71, v71
    v_exp_f32 v72, v72
    v_exp_f32 v73, v73
    v_exp_f32 v74, v74
    v_exp_f32 v75, v75
    v_exp_f32 v76, v76
    v_exp_f32 v77, v77
    v_smfmac_f32_32x32x32_bf16 v[136:151], a[116:119], v[68:75], v9
    v_exp_f32 v78, v78
    v_exp_f32 v79, v79
    v_exp_f32 v80, v80
    v_mfma_f32_32x32x16_bf16 v[60:75], a[28:31], v[172:175], 0
    buffer_load_dwordx4 a[36:39], v0, s[12:15], s82 offen offset:1024 sc1
    v_exp_f32 v81, v81
    v_exp_f32 v82, v82
    v_exp_f32 v83, v83
    v_exp_f32 v84, v84
    v_exp_f32 v85, v85
    s_waitcnt vmcnt(4)
    v_smfmac_f32_32x32x32_bf16 v[28:43], a[120:123], v[76:83], v9
    v_exp_f32 v86, v86
    v_exp_f32 v87, v87
    v_exp_f32 v88, v88
    v_exp_f32 v89, v89
    v_exp_f32 v90, v90
    v_exp_f32 v91, v91
    v_exp_f32 v92, v92
    v_exp_f32 v93, v93
    v_smfmac_f32_32x32x32_bf16 v[28:43], a[124:127], v[84:91], v9
    v_exp_f32 v94, v94
    v_exp_f32 v95, v95
    v_exp_f32 v96, v96
    v_mfma_f32_32x32x16_bf16 v[76:91], a[28:31], v[176:179], 0
    s_mov_b64 exec, s[20:21]
    buffer_load_dwordx4 a[136:139], v248, s[12:15], s86 offen offset:1024 sc1
    buffer_load_dwordx4 a[140:143], v248, s[12:15], s86 offen offset:1536 sc1
    s_mov_b64 exec, -1
    v_exp_f32 v97, v97
    v_exp_f32 v98, v98
    v_exp_f32 v99, v99
    v_exp_f32 v100, v100
    v_exp_f32 v101, v101
    v_smfmac_f32_32x32x32_bf16 v[44:59], a[120:123], v[92:99], v9
    v_exp_f32 v102, v102
    v_exp_f32 v103, v103
    v_exp_f32 v104, v104
    v_exp_f32 v105, v105
    v_exp_f32 v106, v106
    v_exp_f32 v107, v107
    v_exp_f32 v60, v60
    v_exp_f32 v61, v61
    v_smfmac_f32_32x32x32_bf16 v[44:59], a[124:127], v[100:107], v9
    v_exp_f32 v62, v62
    v_exp_f32 v63, v63
    v_exp_f32 v64, v64
    s_waitcnt vmcnt(5)
    v_mfma_f32_32x32x16_bf16 v[92:107], a[32:35], v[20:23], 0
    buffer_load_dwordx4 a[40:43], v0, s[12:15], s82 offen offset:2048 sc1
    v_exp_f32 v65, v65
    v_exp_f32 v66, v66
    v_exp_f32 v67, v67
    v_exp_f32 v68, v68
    v_exp_f32 v69, v69
    v_smfmac_f32_32x32x32_bf16 v[120:135], a[120:123], v[60:67], v9
    v_exp_f32 v70, v70
    v_exp_f32 v71, v71
    v_exp_f32 v72, v72
    v_exp_f32 v73, v73
    v_exp_f32 v74, v74
    v_exp_f32 v75, v75
    v_exp_f32 v76, v76
    v_exp_f32 v77, v77
    v_smfmac_f32_32x32x32_bf16 v[120:135], a[124:127], v[68:75], v9
    v_exp_f32 v78, v78
    v_exp_f32 v79, v79
    v_exp_f32 v80, v80
    v_mfma_f32_32x32x16_bf16 v[60:75], a[32:35], v[24:27], 0
    s_mov_b64 exec, s[20:21]
    buffer_load_dwordx4 a[144:147], v248, s[12:15], s86 offen offset:2048 sc1
    buffer_load_dwordx4 a[148:151], v248, s[12:15], s86 offen offset:2560 sc1
    s_mov_b64 exec, -1
    v_exp_f32 v81, v81
    v_exp_f32 v82, v82
    v_exp_f32 v83, v83
    v_exp_f32 v84, v84
    v_exp_f32 v85, v85
    v_smfmac_f32_32x32x32_bf16 v[136:151], a[120:123], v[76:83], v9
    v_exp_f32 v86, v86
    v_exp_f32 v87, v87
    v_exp_f32 v88, v88
    v_exp_f32 v89, v89
    v_exp_f32 v90, v90
    v_exp_f32 v91, v91
    v_exp_f32 v92, v92
    v_exp_f32 v93, v93
    v_smfmac_f32_32x32x32_bf16 v[136:151], a[124:127], v[84:91], v9
    v_exp_f32 v94, v94
    v_exp_f32 v95, v95
    v_exp_f32 v96, v96
    v_mfma_f32_32x32x16_bf16 v[76:91], a[32:35], v[172:175], 0
    buffer_load_dwordx4 a[44:47], v0, s[12:15], s82 offen offset:3072 sc1
    v_exp_f32 v97, v97
    v_exp_f32 v98, v98
    v_exp_f32 v99, v99
    v_exp_f32 v100, v100
    v_exp_f32 v101, v101
    s_waitcnt vmcnt(7)
    v_smfmac_f32_32x32x32_bf16 v[28:43], a[128:131], v[92:99], v9
    v_exp_f32 v102, v102
    v_exp_f32 v103, v103
    v_exp_f32 v104, v104
    v_exp_f32 v105, v105
    v_exp_f32 v106, v106
    v_exp_f32 v107, v107
    v_exp_f32 v60, v60
    v_exp_f32 v61, v61
    v_smfmac_f32_32x32x32_bf16 v[28:43], a[132:135], v[100:107], v9
    v_exp_f32 v62, v62
    v_exp_f32 v63, v63
    v_exp_f32 v64, v64
    v_mfma_f32_32x32x16_bf16 v[92:107], a[32:35], v[176:179], 0
    s_mov_b64 exec, s[20:21]
    buffer_load_dwordx4 a[152:155], v248, s[12:15], s86 offen offset:3072 sc1
    buffer_load_dwordx4 a[156:159], v248, s[12:15], s86 offen offset:3584 sc1
    s_mov_b64 exec, -1
    v_exp_f32 v65, v65
    v_exp_f32 v66, v66
    v_exp_f32 v67, v67
    v_exp_f32 v68, v68
    v_exp_f32 v69, v69
    v_smfmac_f32_32x32x32_bf16 v[44:59], a[128:131], v[60:67], v9
    v_exp_f32 v70, v70
    v_exp_f32 v71, v71
    v_exp_f32 v72, v72
    v_exp_f32 v73, v73
    v_exp_f32 v74, v74
    v_exp_f32 v75, v75
    v_exp_f32 v76, v76
    v_exp_f32 v77, v77
    v_smfmac_f32_32x32x32_bf16 v[44:59], a[132:135], v[68:75], v9
    v_exp_f32 v78, v78
    v_exp_f32 v79, v79
    v_exp_f32 v80, v80
    s_waitcnt vmcnt(8)
    v_mfma_f32_32x32x16_bf16 v[60:75], a[36:39], v[20:23], 0
    buffer_load_dwordx4 a[48:51], v0, s[12:15], s83 offen offset:0 sc1
    v_exp_f32 v81, v81
    v_exp_f32 v82, v82
    v_exp_f32 v83, v83
    v_exp_f32 v84, v84
    v_exp_f32 v85, v85
    v_smfmac_f32_32x32x32_bf16 v[120:135], a[128:131], v[76:83], v9
    v_exp_f32 v86, v86
    v_exp_f32 v87, v87
    v_exp_f32 v88, v88
    v_exp_f32 v89, v89
    v_exp_f32 v90, v90
    v_exp_f32 v91, v91
    v_exp_f32 v92, v92
    v_exp_f32 v93, v93
    v_smfmac_f32_32x32x32_bf16 v[120:135], a[132:135], v[84:91], v9
    v_exp_f32 v94, v94
    v_exp_f32 v95, v95
    v_exp_f32 v96, v96
    v_mfma_f32_32x32x16_bf16 v[76:91], a[36:39], v[24:27], 0
    s_mov_b64 exec, s[20:21]
    buffer_load_dwordx4 a[160:163], v248, s[12:15], s87 offen offset:0 sc1
    buffer_load_dwordx4 a[164:167], v248, s[12:15], s87 offen offset:512 sc1
    s_mov_b64 exec, -1
    v_exp_f32 v97, v97
    v_exp_f32 v98, v98
    v_exp_f32 v99, v99
    v_exp_f32 v100, v100
    v_exp_f32 v101, v101
    v_smfmac_f32_32x32x32_bf16 v[136:151], a[128:131], v[92:99], v9
    v_exp_f32 v102, v102
    v_exp_f32 v103, v103
    v_exp_f32 v104, v104
    v_exp_f32 v105, v105
    v_exp_f32 v106, v106
    v_exp_f32 v107, v107
    v_exp_f32 v60, v60
    v_exp_f32 v61, v61
    v_smfmac_f32_32x32x32_bf16 v[136:151], a[132:135], v[100:107], v9
    v_exp_f32 v62, v62
    v_exp_f32 v63, v63
    v_exp_f32 v64, v64
    v_mfma_f32_32x32x16_bf16 v[92:107], a[36:39], v[172:175], 0
    buffer_load_dwordx4 a[52:55], v0, s[12:15], s83 offen offset:1024 sc1
    v_exp_f32 v65, v65
    v_exp_f32 v66, v66
    v_exp_f32 v67, v67
    v_exp_f32 v68, v68
    v_exp_f32 v69, v69
    s_waitcnt vmcnt(10)
    v_smfmac_f32_32x32x32_bf16 v[28:43], a[136:139], v[60:67], v9
    v_exp_f32 v70, v70
    v_exp_f32 v71, v71
    v_exp_f32 v72, v72
    v_exp_f32 v73, v73
    v_exp_f32 v74, v74
    v_exp_f32 v75, v75
    v_exp_f32 v76, v76
    v_exp_f32 v77, v77
    v_smfmac_f32_32x32x32_bf16 v[28:43], a[140:143], v[68:75], v9
    v_exp_f32 v78, v78
    v_exp_f32 v79, v79
    v_exp_f32 v80, v80
    v_mfma_f32_32x32x16_bf16 v[60:75], a[36:39], v[176:179], 0
    s_mov_b64 exec, s[20:21]
    buffer_load_dwordx4 a[168:171], v248, s[12:15], s87 offen offset:1024 sc1
    buffer_load_dwordx4 a[172:175], v248, s[12:15], s87 offen offset:1536 sc1
    s_mov_b64 exec, -1
    v_exp_f32 v81, v81
    v_exp_f32 v82, v82
    v_exp_f32 v83, v83
    v_exp_f32 v84, v84
    v_exp_f32 v85, v85
    v_smfmac_f32_32x32x32_bf16 v[44:59], a[136:139], v[76:83], v9
    v_exp_f32 v86, v86
    v_exp_f32 v87, v87
    v_exp_f32 v88, v88
    v_exp_f32 v89, v89
    v_exp_f32 v90, v90
    v_exp_f32 v91, v91
    v_exp_f32 v92, v92
    v_exp_f32 v93, v93
    v_smfmac_f32_32x32x32_bf16 v[44:59], a[140:143], v[84:91], v9
    v_exp_f32 v94, v94
    v_exp_f32 v95, v95
    v_exp_f32 v96, v96
    s_waitcnt vmcnt(11)
    v_mfma_f32_32x32x16_bf16 v[76:91], a[40:43], v[20:23], 0
    buffer_load_dwordx4 a[56:59], v0, s[12:15], s83 offen offset:2048 sc1
    v_exp_f32 v97, v97
    v_exp_f32 v98, v98
    v_exp_f32 v99, v99
    v_exp_f32 v100, v100
    v_exp_f32 v101, v101
    v_smfmac_f32_32x32x32_bf16 v[120:135], a[136:139], v[92:99], v9
    buffer_load_dword v5, v2, s[8:11], s32 offen sc1
    v_exp_f32 v102, v102
    v_exp_f32 v103, v103
    v_exp_f32 v104, v104
    v_exp_f32 v105, v105
    v_exp_f32 v106, v106
    v_exp_f32 v107, v107
    v_exp_f32 v60, v60
    v_exp_f32 v61, v61
    v_smfmac_f32_32x32x32_bf16 v[120:135], a[140:143], v[100:107], v9
    v_exp_f32 v62, v62
    v_exp_f32 v63, v63
    v_exp_f32 v64, v64
    v_mfma_f32_32x32x16_bf16 v[92:107], a[40:43], v[24:27], 0
    s_mov_b64 exec, s[20:21]
    buffer_load_dwordx4 a[176:179], v248, s[12:15], s87 offen offset:2048 sc1
    buffer_load_dwordx4 a[180:183], v248, s[12:15], s87 offen offset:2560 sc1
    s_mov_b64 exec, -1
    v_exp_f32 v65, v65
    v_exp_f32 v66, v66
    v_exp_f32 v67, v67
    v_exp_f32 v68, v68
    v_exp_f32 v69, v69
    v_smfmac_f32_32x32x32_bf16 v[136:151], a[136:139], v[60:67], v9
    v_exp_f32 v70, v70
    v_exp_f32 v71, v71
    v_exp_f32 v72, v72
    v_exp_f32 v73, v73
    v_exp_f32 v74, v74
    v_exp_f32 v75, v75
    v_exp_f32 v76, v76
    v_exp_f32 v77, v77
    v_smfmac_f32_32x32x32_bf16 v[136:151], a[140:143], v[68:75], v9
    v_exp_f32 v78, v78
    v_exp_f32 v79, v79
    v_exp_f32 v80, v80
    v_mfma_f32_32x32x16_bf16 v[60:75], a[40:43], v[172:175], 0
    buffer_load_dwordx4 a[60:63], v0, s[12:15], s83 offen offset:3072 sc1
    v_exp_f32 v81, v81
    v_exp_f32 v82, v82
    v_exp_f32 v83, v83
    v_exp_f32 v84, v84
    v_exp_f32 v85, v85
    s_waitcnt vmcnt(14)
    v_smfmac_f32_32x32x32_bf16 v[28:43], a[144:147], v[76:83], v9
    v_exp_f32 v86, v86
    v_exp_f32 v87, v87
    v_exp_f32 v88, v88
    v_exp_f32 v89, v89
    v_exp_f32 v90, v90
    v_exp_f32 v91, v91
    v_exp_f32 v92, v92
    v_exp_f32 v93, v93
    v_smfmac_f32_32x32x32_bf16 v[28:43], a[148:151], v[84:91], v9
    v_exp_f32 v94, v94
    v_exp_f32 v95, v95
    v_exp_f32 v96, v96
    v_mfma_f32_32x32x16_bf16 v[76:91], a[40:43], v[176:179], 0
    s_mov_b64 exec, s[20:21]
    buffer_load_dwordx4 a[184:187], v248, s[12:15], s87 offen offset:3072 sc1
    buffer_load_dwordx4 a[188:191], v248, s[12:15], s87 offen offset:3584 sc1
    s_mov_b64 exec, -1
    v_exp_f32 v97, v97
    v_exp_f32 v98, v98
    v_exp_f32 v99, v99
    v_exp_f32 v100, v100
    v_exp_f32 v101, v101
    v_smfmac_f32_32x32x32_bf16 v[44:59], a[144:147], v[92:99], v9
    v_exp_f32 v102, v102
    v_exp_f32 v103, v103
    v_exp_f32 v104, v104
    v_exp_f32 v105, v105
    v_exp_f32 v106, v106
    v_exp_f32 v107, v107
    v_exp_f32 v60, v60
    v_exp_f32 v61, v61
    v_smfmac_f32_32x32x32_bf16 v[44:59], a[148:151], v[100:107], v9
    v_exp_f32 v62, v62
    v_exp_f32 v63, v63
    v_exp_f32 v64, v64
    s_waitcnt vmcnt(15)
    v_mfma_f32_32x32x16_bf16 v[92:107], a[44:47], v[20:23], 0
    v_exp_f32 v65, v65
    v_exp_f32 v66, v66
    v_exp_f32 v67, v67
    v_exp_f32 v68, v68
    v_exp_f32 v69, v69
    v_smfmac_f32_32x32x32_bf16 v[120:135], a[144:147], v[60:67], v9
    v_exp_f32 v70, v70
    v_exp_f32 v71, v71
    v_exp_f32 v72, v72
    v_exp_f32 v73, v73
    v_exp_f32 v74, v74
    v_exp_f32 v75, v75
    v_exp_f32 v76, v76
    v_exp_f32 v77, v77
    v_smfmac_f32_32x32x32_bf16 v[120:135], a[148:151], v[68:75], v9
    v_exp_f32 v78, v78
    v_exp_f32 v79, v79
    v_exp_f32 v80, v80
    v_mfma_f32_32x32x16_bf16 v[60:75], a[44:47], v[24:27], 0
    v_exp_f32 v81, v81
    v_exp_f32 v82, v82
    v_exp_f32 v83, v83
    v_exp_f32 v84, v84
    v_exp_f32 v85, v85
    v_smfmac_f32_32x32x32_bf16 v[136:151], a[144:147], v[76:83], v9
    s_waitcnt vmcnt(5)
    v_cmp_gt_u32 vcc, s39, v5
    s_cbranch_vccnz tc_sp
tc_go:
    s_barrier
    v_exp_f32 v86, v86
    v_exp_f32 v87, v87
    v_exp_f32 v88, v88
    v_exp_f32 v89, v89
    v_exp_f32 v90, v90
    v_exp_f32 v91, v91
    v_exp_f32 v92, v92
    v_exp_f32 v93, v93
    v_smfmac_f32_32x32x32_bf16 v[136:151], a[148:151], v[84:91], v9
    v_exp_f32 v94, v94
    v_exp_f32 v95, v95
    v_exp_f32 v96, v96
    v_mfma_f32_32x32x16_bf16 v[76:91], a[44:47], v[172:175], 0
    buffer_load_dwordx4 v[116:119], v252, s[12:15], s78 offen offset:0 sc1
    v_exp_f32 v97, v97
    v_exp_f32 v98, v98
    v_exp_f32 v99, v99
    v_exp_f32 v100, v100
    v_exp_f32 v101, v101
    v_smfmac_f32_32x32x32_bf16 v[28:43], a[152:155], v[92:99], v9
    v_exp_f32 v102, v102
    v_exp_f32 v103, v103
    v_exp_f32 v104, v104
    v_exp_f32 v105, v105
    v_exp_f32 v106, v106
    v_exp_f32 v107, v107
    v_exp_f32 v60, v60
    v_exp_f32 v61, v61
    v_smfmac_f32_32x32x32_bf16 v[28:43], a[156:159], v[100:107], v9
    s_lshr_b32 s62, s5, 2
    s_lshl_b32 s62, s62, 16
    s_lshl_b32 s22, s3, 14
    s_add_u32 s62, s62, s22
    s_add_u32 s62, s62, 0
    v_exp_f32 v62, v62
    v_exp_f32 v63, v63
    v_exp_f32 v64, v64
    v_mfma_f32_32x32x16_bf16 v[92:107], a[44:47], v[176:179], 0
    v_exp_f32 v65, v65
    v_exp_f32 v66, v66
    v_exp_f32 v67, v67
    v_exp_f32 v68, v68
    v_exp_f32 v69, v69
    v_smfmac_f32_32x32x32_bf16 v[44:59], a[152:155], v[60:67], v9
    v_exp_f32 v70, v70
    v_exp_f32 v71, v71
    v_exp_f32 v72, v72
    v_exp_f32 v73, v73
    v_exp_f32 v74, v74
    v_exp_f32 v75, v75
    v_exp_f32 v76, v76
    v_exp_f32 v77, v77
    v_smfmac_f32_32x32x32_bf16 v[44:59], a[156:159], v[68:75], v9
    v_exp_f32 v78, v78
    v_exp_f32 v79, v79
    v_exp_f32 v80, v80
    v_mfma_f32_32x32x16_bf16 v[60:75], a[48:51], v[20:23], 0
    buffer_load_dwordx4 a[192:195], v0, s[8:11], s62 offen offset:0 sc1
    v_exp_f32 v81, v81
    v_exp_f32 v82, v82
    v_exp_f32 v83, v83
    v_exp_f32 v84, v84
    v_exp_f32 v85, v85
    v_smfmac_f32_32x32x32_bf16 v[120:135], a[152:155], v[76:83], v9
    v_exp_f32 v86, v86
    v_exp_f32 v87, v87
    v_exp_f32 v88, v88
    v_exp_f32 v89, v89
    v_exp_f32 v90, v90
    v_exp_f32 v91, v91
    v_exp_f32 v92, v92
    v_exp_f32 v93, v93
    v_smfmac_f32_32x32x32_bf16 v[120:135], a[156:159], v[84:91], v9
    v_exp_f32 v94, v94
    v_exp_f32 v95, v95
    v_exp_f32 v96, v96
    v_mfma_f32_32x32x16_bf16 v[76:91], a[48:51], v[24:27], 0
    buffer_load_dwordx4 a[196:199], v0, s[8:11], s62 offen offset:1024 sc1
    v_exp_f32 v97, v97
    v_exp_f32 v98, v98
    v_exp_f32 v99, v99
    v_exp_f32 v100, v100
    v_exp_f32 v101, v101
    v_smfmac_f32_32x32x32_bf16 v[136:151], a[152:155], v[92:99], v9
    v_exp_f32 v102, v102
    v_exp_f32 v103, v103
    v_exp_f32 v104, v104
    v_exp_f32 v105, v105
    v_exp_f32 v106, v106
    v_exp_f32 v107, v107
    v_exp_f32 v60, v60
    v_exp_f32 v61, v61
    v_smfmac_f32_32x32x32_bf16 v[136:151], a[156:159], v[100:107], v9
    v_exp_f32 v62, v62
    v_exp_f32 v63, v63
    v_exp_f32 v64, v64
    v_mfma_f32_32x32x16_bf16 v[92:107], a[48:51], v[172:175], 0
    buffer_load_dwordx4 a[200:203], v0, s[8:11], s62 offen offset:2048 sc1
    v_exp_f32 v65, v65
    v_exp_f32 v66, v66
    v_exp_f32 v67, v67
    v_exp_f32 v68, v68
    v_exp_f32 v69, v69
    v_smfmac_f32_32x32x32_bf16 v[28:43], a[160:163], v[60:67], v9
    v_exp_f32 v70, v70
    v_exp_f32 v71, v71
    v_exp_f32 v72, v72
    v_exp_f32 v73, v73
    v_exp_f32 v74, v74
    v_exp_f32 v75, v75
    v_exp_f32 v76, v76
    v_exp_f32 v77, v77
    v_smfmac_f32_32x32x32_bf16 v[28:43], a[164:167], v[68:75], v9
    v_exp_f32 v78, v78
    v_exp_f32 v79, v79
    v_exp_f32 v80, v80
    v_mfma_f32_32x32x16_bf16 v[60:75], a[48:51], v[176:179], 0
    buffer_load_dwordx4 a[204:207], v0, s[8:11], s62 offen offset:3072 sc1
    v_exp_f32 v81, v81
    v_exp_f32 v82, v82
    v_exp_f32 v83, v83
    v_exp_f32 v84, v84
    v_exp_f32 v85, v85
    v_smfmac_f32_32x32x32_bf16 v[44:59], a[160:163], v[76:83], v9
    v_exp_f32 v86, v86
    v_exp_f32 v87, v87
    v_exp_f32 v88, v88
    v_exp_f32 v89, v89
    v_exp_f32 v90, v90
    v_exp_f32 v91, v91
    v_exp_f32 v92, v92
    v_exp_f32 v93, v93
    v_smfmac_f32_32x32x32_bf16 v[44:59], a[164:167], v[84:91], v9
    v_exp_f32 v94, v94
    v_exp_f32 v95, v95
    v_exp_f32 v96, v96
    v_mfma_f32_32x32x16_bf16 v[76:91], a[52:55], v[20:23], 0
    buffer_load_dwordx4 a[208:211], v252, s[8:11], s62 offen offset:0 sc1
    v_exp_f32 v97, v97
    v_exp_f32 v98, v98
    v_exp_f32 v99, v99
    v_exp_f32 v100, v100
    v_exp_f32 v101, v101
    v_smfmac_f32_32x32x32_bf16 v[120:135], a[160:163], v[92:99], v9
    v_exp_f32 v102, v102
    v_exp_f32 v103, v103
    v_exp_f32 v104, v104
    v_exp_f32 v105, v105
    v_exp_f32 v106, v106
    v_exp_f32 v107, v107
    v_exp_f32 v60, v60
    v_exp_f32 v61, v61
    v_smfmac_f32_32x32x32_bf16 v[120:135], a[164:167], v[100:107], v9
    v_exp_f32 v62, v62
    v_exp_f32 v63, v63
    v_exp_f32 v64, v64
    v_mfma_f32_32x32x16_bf16 v[92:107], a[52:55], v[24:27], 0
    buffer_load_dwordx4 a[212:215], v252, s[8:11], s62 offen offset:1024 sc1
    v_exp_f32 v65, v65
    v_exp_f32 v66, v66
    v_exp_f32 v67, v67
    v_exp_f32 v68, v68
    v_exp_f32 v69, v69
    v_smfmac_f32_32x32x32_bf16 v[136:151], a[160:163], v[60:67], v9
    v_exp_f32 v70, v70
    v_exp_f32 v71, v71
    v_exp_f32 v72, v72
    v_exp_f32 v73, v73
    v_exp_f32 v74, v74
    v_exp_f32 v75, v75
    v_exp_f32 v76, v76
    v_exp_f32 v77, v77
    v_smfmac_f32_32x32x32_bf16 v[136:151], a[164:167], v[68:75], v9
    v_exp_f32 v78, v78
    v_exp_f32 v79, v79
    v_exp_f32 v80, v80
    v_mfma_f32_32x32x16_bf16 v[60:75], a[52:55], v[172:175], 0
    buffer_load_dwordx4 a[216:219], v252, s[8:11], s62 offen offset:2048 sc1
    v_exp_f32 v81, v81
    v_exp_f32 v82, v82
    v_exp_f32 v83, v83
    v_exp_f32 v84, v84
    v_exp_f32 v85, v85
    v_smfmac_f32_32x32x32_bf16 v[28:43], a[168:171], v[76:83], v9
    v_exp_f32 v86, v86
    v_exp_f32 v87, v87
    v_exp_f32 v88, v88
    v_exp_f32 v89, v89
    v_exp_f32 v90, v90
    v_exp_f32 v91, v91
    v_exp_f32 v92, v92
    v_exp_f32 v93, v93
    v_smfmac_f32_32x32x32_bf16 v[28:43], a[172:175], v[84:91], v9
    s_lshl_b32 s88, s77, 3
    v_exp_f32 v94, v94
    v_exp_f32 v95, v95
    v_exp_f32 v96, v96
    v_mfma_f32_32x32x16_bf16 v[76:91], a[52:55], v[176:179], 0
    buffer_load_dwordx4 a[220:223], v252, s[8:11], s62 offen offset:3072 sc1
    s_add_u32 s88, s88, s3
    v_exp_f32 v97, v97
    v_exp_f32 v98, v98
    v_exp_f32 v99, v99
    v_exp_f32 v100, v100
    v_exp_f32 v101, v101
    v_smfmac_f32_32x32x32_bf16 v[44:59], a[168:171], v[92:99], v9
    s_lshl_b32 s88, s88, 15
    v_exp_f32 v102, v102
    v_exp_f32 v103, v103
    v_exp_f32 v104, v104
    v_exp_f32 v105, v105
    v_exp_f32 v106, v106
    v_exp_f32 v107, v107
    v_exp_f32 v60, v60
    v_exp_f32 v61, v61
    v_smfmac_f32_32x32x32_bf16 v[44:59], a[172:175], v[100:107], v9
    s_lshl_b32 s22, s76, 10
    v_exp_f32 v62, v62
    v_exp_f32 v63, v63
    v_exp_f32 v64, v64
    v_mfma_f32_32x32x16_bf16 v[92:107], a[56:59], v[20:23], 0
    buffer_load_dwordx4 a[224:227], v253, s[8:11], s62 offen offset:0 sc1
    s_add_u32 s88, s88, s22
    v_exp_f32 v65, v65
    v_exp_f32 v66, v66
    v_exp_f32 v67, v67
    v_exp_f32 v68, v68
    v_exp_f32 v69, v69
    v_smfmac_f32_32x32x32_bf16 v[120:135], a[168:171], v[60:67], v9
    s_add_u32 s88, s88, 8519680
    v_exp_f32 v70, v70
    v_exp_f32 v71, v71
    v_exp_f32 v72, v72
    v_exp_f32 v73, v73
    v_exp_f32 v74, v74
    v_exp_f32 v75, v75
    v_exp_f32 v76, v76
    v_exp_f32 v77, v77
    v_smfmac_f32_32x32x32_bf16 v[120:135], a[172:175], v[68:75], v9
    s_add_u32 s89, s88, 131072
    v_exp_f32 v78, v78
    v_exp_f32 v79, v79
    v_exp_f32 v80, v80
    v_mfma_f32_32x32x16_bf16 v[60:75], a[56:59], v[24:27], 0
    buffer_load_dwordx4 a[228:231], v253, s[8:11], s62 offen offset:1024 sc1
    s_mov_b32 s94, 0x21800000
    v_exp_f32 v81, v81
    v_exp_f32 v82, v82
    v_exp_f32 v83, v83
    v_exp_f32 v84, v84
    v_exp_f32 v85, v85
    v_smfmac_f32_32x32x32_bf16 v[136:151], a[168:171], v[76:83], v9
    s_mov_b32 s95, 0x5d800000
    v_exp_f32 v86, v86
    v_exp_f32 v87, v87
    v_exp_f32 v88, v88
    v_exp_f32 v89, v89
    v_exp_f32 v90, v90
    v_exp_f32 v91, v91
    v_exp_f32 v92, v92
    v_exp_f32 v93, v93
    v_smfmac_f32_32x32x32_bf16 v[136:151], a[172:175], v[84:91], v9
    s_lshl_b32 s59, s77, 9
    v_exp_f32 v94, v94
    v_exp_f32 v95, v95
    v_exp_f32 v96, v96
    v_mfma_f32_32x32x16_bf16 v[76:91], a[56:59], v[172:175], 0
    buffer_load_dwordx4 a[232:235], v253, s[8:11], s62 offen offset:2048 sc1
    s_add_u32 s59, s59, s47
    v_exp_f32 v97, v97
    v_exp_f32 v98, v98
    v_exp_f32 v99, v99
    v_exp_f32 v100, v100
    v_exp_f32 v101, v101
    s_waitcnt vmcnt(15)
    v_smfmac_f32_32x32x32_bf16 v[28:43], a[176:179], v[92:99], v9
    s_add_u32 s59, s59, 65536
    v_exp_f32 v102, v102
    v_exp_f32 v103, v103
    v_exp_f32 v104, v104
    v_exp_f32 v105, v105
    v_exp_f32 v106, v106
    v_exp_f32 v107, v107
    v_exp_f32 v60, v60
    v_exp_f32 v61, v61
    v_smfmac_f32_32x32x32_bf16 v[28:43], a[180:183], v[100:107], v9
    v_exp_f32 v62, v62
    v_exp_f32 v63, v63
    v_exp_f32 v64, v64
    v_mfma_f32_32x32x16_bf16 v[92:107], a[56:59], v[176:179], 0
    buffer_load_dwordx4 a[236:239], v253, s[8:11], s62 offen offset:3072 sc1
    v_exp_f32 v65, v65
    v_exp_f32 v66, v66
    v_exp_f32 v67, v67
    v_exp_f32 v68, v68
    v_exp_f32 v69, v69
    v_smfmac_f32_32x32x32_bf16 v[44:59], a[176:179], v[60:67], v9
    v_exp_f32 v70, v70
    v_exp_f32 v71, v71
    v_exp_f32 v72, v72
    v_exp_f32 v73, v73
    v_exp_f32 v74, v74
    v_exp_f32 v75, v75
    v_exp_f32 v76, v76
    v_exp_f32 v77, v77
    v_smfmac_f32_32x32x32_bf16 v[44:59], a[180:183], v[68:75], v9
    v_exp_f32 v78, v78
    v_exp_f32 v79, v79
    v_exp_f32 v80, v80
    s_waitcnt vmcnt(15)
    v_mfma_f32_32x32x16_bf16 v[60:75], a[60:63], v[20:23], 0
    buffer_load_dwordx4 a[240:243], v254, s[8:11], s62 offen offset:0 sc1
    v_exp_f32 v81, v81
    v_exp_f32 v82, v82
    v_exp_f32 v83, v83
    v_exp_f32 v84, v84
    v_exp_f32 v85, v85
    v_smfmac_f32_32x32x32_bf16 v[120:135], a[176:179], v[76:83], v9
    v_exp_f32 v86, v86
    v_exp_f32 v87, v87
    v_exp_f32 v88, v88
    v_exp_f32 v89, v89
    v_exp_f32 v90, v90
    v_exp_f32 v91, v91
    v_exp_f32 v92, v92
    v_exp_f32 v93, v93
    v_smfmac_f32_32x32x32_bf16 v[120:135], a[180:183], v[84:91], v9
    v_exp_f32 v94, v94
    v_exp_f32 v95, v95
    v_exp_f32 v96, v96
    v_mfma_f32_32x32x16_bf16 v[76:91], a[60:63], v[24:27], 0
    buffer_load_dwordx4 a[244:247], v254, s[8:11], s62 offen offset:1024 sc1
    v_exp_f32 v97, v97
    v_exp_f32 v98, v98
    v_exp_f32 v99, v99
    v_exp_f32 v100, v100
    v_exp_f32 v101, v101
    v_smfmac_f32_32x32x32_bf16 v[136:151], a[176:179], v[92:99], v9
    v_exp_f32 v102, v102
    v_exp_f32 v103, v103
    v_exp_f32 v104, v104
    v_exp_f32 v105, v105
    v_exp_f32 v106, v106
    v_exp_f32 v107, v107
    v_exp_f32 v60, v60
    v_exp_f32 v61, v61
    v_smfmac_f32_32x32x32_bf16 v[136:151], a[180:183], v[100:107], v9
    v_exp_f32 v62, v62
    v_exp_f32 v63, v63
    v_exp_f32 v64, v64
    v_mfma_f32_32x32x16_bf16 v[92:107], a[60:63], v[172:175], 0
    buffer_load_dwordx4 a[248:251], v254, s[8:11], s62 offen offset:2048 sc1
    v_exp_f32 v65, v65
    v_exp_f32 v66, v66
    v_exp_f32 v67, v67
    v_exp_f32 v68, v68
    v_exp_f32 v69, v69
    s_waitcnt vmcnt(16)
    v_smfmac_f32_32x32x32_bf16 v[28:43], a[184:187], v[60:67], v9
    v_exp_f32 v70, v70
    v_exp_f32 v71, v71
    v_exp_f32 v72, v72
    v_exp_f32 v73, v73
    v_exp_f32 v74, v74
    v_exp_f32 v75, v75
    v_exp_f32 v76, v76
    v_exp_f32 v77, v77
    v_smfmac_f32_32x32x32_bf16 v[28:43], a[188:191], v[68:75], v9
    v_exp_f32 v78, v78
    v_exp_f32 v79, v79
    v_exp_f32 v80, v80
    v_mfma_f32_32x32x16_bf16 v[60:75], a[60:63], v[176:179], 0
    buffer_load_dwordx4 a[252:255], v254, s[8:11], s62 offen offset:3072 sc1
    v_exp_f32 v81, v81
    v_exp_f32 v82, v82
    v_exp_f32 v83, v83
    v_exp_f32 v84, v84
    v_exp_f32 v85, v85
    v_smfmac_f32_32x32x32_bf16 v[44:59], a[184:187], v[76:83], v9
    s_lshr_b32 s62, s5, 1
    s_lshl_b32 s62, s62, 2
    s_add_u32 s62, s62, s3
    s_lshl_b32 s62, s62, 15
    s_add_u32 s62, s62, 2359296
    s_add_u32 s63, s62, 16384
    s_mov_b64 s[28:29], s[8:9]
    s_cmp_lt_u32 s5, 28
    s_cselect_b32 s30, s10, 0
    v_exp_f32 v86, v86
    v_exp_f32 v87, v87
    v_exp_f32 v88, v88
    v_exp_f32 v89, v89
    v_exp_f32 v90, v90
    v_exp_f32 v91, v91
    v_exp_f32 v92, v92
    v_exp_f32 v93, v93
    v_smfmac_f32_32x32x32_bf16 v[44:59], a[188:191], v[84:91], v9
    ds_write_b128 v10, v[28:31] offset:0
    buffer_load_dwordx4 v[24:27], v252, s[12:15], s78 offen offset:1024 sc1
    v_exp_f32 v94, v94
    v_exp_f32 v95, v95
    v_exp_f32 v96, v96
    s_waitcnt vmcnt(17)
    v_mfma_f32_32x32x16_bf16 v[76:91], a[0:3], v[116:119], 0
    ds_write_b128 v10, v[32:35] offset:1024
    buffer_load_dwordx4 v[152:155], v253, s[28:31], s62 offen offset:0 sc1
    v_exp_f32 v97, v97
    v_exp_f32 v98, v98
    v_exp_f32 v99, v99
    v_exp_f32 v100, v100
    v_exp_f32 v101, v101
    v_smfmac_f32_32x32x32_bf16 v[120:135], a[184:187], v[92:99], v9
    ds_write_b32 v11, v36 offset:0
    v_exp_f32 v102, v102
    v_exp_f32 v103, v103
    v_exp_f32 v104, v104
    v_exp_f32 v105, v105
    v_exp_f32 v106, v106
    v_exp_f32 v107, v107
    v_exp_f32 v60, v60
    v_exp_f32 v61, v61
    v_smfmac_f32_32x32x32_bf16 v[120:135], a[188:191], v[100:107], v9
    ds_write_b128 v10, v[44:47] offset:8192
    buffer_load_dwordx4 v[20:23], v252, s[12:15], s78 offen offset:2048 sc1
    v_exp_f32 v62, v62
    v_exp_f32 v63, v63
    v_exp_f32 v64, v64
    v_mfma_f32_32x32x16_bf16 v[92:107], a[4:7], v[116:119], 0
    ds_write_b128 v10, v[48:51] offset:9216
    buffer_load_dwordx4 v[156:159], v253, s[28:31], s62 offen offset:1024 sc1
    v_exp_f32 v65, v65
    v_exp_f32 v66, v66
    v_exp_f32 v67, v67
    v_exp_f32 v68, v68
    v_exp_f32 v69, v69
    v_smfmac_f32_32x32x32_bf16 v[136:151], a[184:187], v[60:67], v9
    ds_write_b32 v11, v52 offset:1024
    v_exp_f32 v70, v70
    v_exp_f32 v71, v71
    v_exp_f32 v72, v72
    v_exp_f32 v73, v73
    v_mfma_f32_32x32x8_bf16 v[28:43], v[14:15], v[14:15], 0
    v_exp_f32 v74, v74
    v_exp_f32 v75, v75
    v_exp_f32 v76, v76
    v_exp_f32 v77, v77
    v_smfmac_f32_32x32x32_bf16 v[136:151], a[188:191], v[68:75], v9
    ds_write_b128 v10, v[120:123] offset:16384
    v_exp_f32 v78, v78
    v_exp_f32 v79, v79
    v_exp_f32 v80, v80
    v_mfma_f32_32x32x16_bf16 v[60:75], a[8:11], v[116:119], 0
    ds_write_b128 v10, v[124:127] offset:17408
    v_exp_f32 v81, v81
    v_exp_f32 v82, v82
    v_exp_f32 v83, v83
    v_exp_f32 v84, v84
    v_exp_f32 v85, v85
    v_smfmac_f32_32x32x32_bf16 v[28:43], a[64:67], v[76:83], v9
    ds_write_b32 v11, v128 offset:2048
    v_exp_f32 v86, v86
    v_exp_f32 v87, v87
    v_exp_f32 v88, v88
    v_exp_f32 v89, v89
    v_mfma_f32_32x32x8_bf16 v[44:59], v[14:15], v[14:15], 0
    v_exp_f32 v90, v90
    v_exp_f32 v91, v91
    v_exp_f32 v92, v92
    v_exp_f32 v93, v93
    v_smfmac_f32_32x32x32_bf16 v[28:43], a[68:71], v[84:91], v9
    ds_write_b128 v10, v[136:139] offset:24576
    v_exp_f32 v94, v94
    v_exp_f32 v95, v95
    v_exp_f32 v96, v96
    v_mfma_f32_32x32x16_bf16 v[76:91], a[12:15], v[116:119], 0
    ds_write_b128 v10, v[140:143] offset:25600
    buffer_load_dwordx4 v[160:163], v253, s[28:31], s62 offen offset:2048 sc1
    v_exp_f32 v97, v97
    v_exp_f32 v98, v98
    v_exp_f32 v99, v99
    v_exp_f32 v100, v100
    v_exp_f32 v101, v101
    v_smfmac_f32_32x32x32_bf16 v[28:43], a[72:75], v[92:99], v9
    ds_write_b32 v11, v144 offset:3072
    v_exp_f32 v102, v102
    v_exp_f32 v103, v103
    v_exp_f32 v104, v104
    v_exp_f32 v105, v105
    v_exp_f32 v106, v106
    v_exp_f32 v107, v107
    v_exp_f32 v60, v60
    v_exp_f32 v61, v61
    v_smfmac_f32_32x32x32_bf16 v[28:43], a[76:79], v[100:107], v9
    s_waitcnt lgkmcnt(0)
    s_barrier
    v_exp_f32 v62, v62
    v_exp_f32 v63, v63
    v_exp_f32 v64, v64
    v_mfma_f32_32x32x16_bf16 v[92:107], a[16:19], v[116:119], 0
    buffer_load_dwordx4 v[164:167], v253, s[28:31], s62 offen offset:3072 sc1
    v_and_b32 v16, 0x1f0, v0
    v_add_u32 v16, 131072, v16
    s_lshl_b32 s22, s3, 10
    v_add_u32 v13, s22, v16
    v_exp_f32 v65, v65
    v_exp_f32 v66, v66
    v_exp_f32 v67, v67
    v_exp_f32 v68, v68
    v_exp_f32 v69, v69
    v_smfmac_f32_32x32x32_bf16 v[28:43], a[80:83], v[60:67], v9
    ds_read_b128 v[180:183], v16 offset:0
    ds_read_b128 v[184:187], v16 offset:1024
    ds_read_b128 v[188:191], v16 offset:2048
    ds_read_b128 v[192:195], v16 offset:3072
    ds_read_b128 v[196:199], v13
    v_exp_f32 v70, v70
    v_exp_f32 v71, v71
    v_exp_f32 v72, v72
    v_exp_f32 v73, v73
    v_exp_f32 v74, v74
    v_exp_f32 v75, v75
    v_exp_f32 v76, v76
    v_exp_f32 v77, v77
    v_smfmac_f32_32x32x32_bf16 v[28:43], a[84:87], v[68:75], v9
    v_exp_f32 v78, v78
    v_exp_f32 v79, v79
    v_exp_f32 v80, v80
    v_mfma_f32_32x32x16_bf16 v[60:75], a[20:23], v[116:119], 0
    s_waitcnt lgkmcnt(0)
    v_add_f32 v196, v196, v197
    v_add_f32 v198, v198, v199
    v_add_f32 v196, v196, v198
    v_add_f32 v180, v180, v181
    v_add_f32 v182, v182, v183
    v_exp_f32 v81, v81
    v_exp_f32 v82, v82
    v_exp_f32 v83, v83
    v_exp_f32 v84, v84
    v_exp_f32 v85, v85
    v_smfmac_f32_32x32x32_bf16 v[28:43], a[88:91], v[76:83], v9
    v_add_f32 v180, v180, v182
    v_add_f32 v184, v184, v185
    v_add_f32 v186, v186, v187
    v_add_f32 v184, v184, v186
    v_add_f32 v188, v188, v189
    v_add_f32 v190, v190, v191
    v_exp_f32 v86, v86
    v_exp_f32 v87, v87
    v_exp_f32 v88, v88
    v_exp_f32 v89, v89
    v_exp_f32 v90, v90
    v_exp_f32 v91, v91
    v_exp_f32 v92, v92
    v_exp_f32 v93, v93
    v_smfmac_f32_32x32x32_bf16 v[28:43], a[92:95], v[84:91], v9
    v_add_f32 v188, v188, v190
    v_add_f32 v192, v192, v193
    v_add_f32 v194, v194, v195
    v_add_f32 v192, v192, v194
    v_rcp_f32 v12, v196
    v_exp_f32 v94, v94
    v_exp_f32 v95, v95
    v_exp_f32 v96, v96
    v_mfma_f32_32x32x16_bf16 v[76:91], a[24:27], v[116:119], 0
    buffer_load_dwordx4 v[168:171], v254, s[28:31], s62 offen offset:0 sc1
    v_min3_f32 v181, v180, v184, v188
    v_add_f32 v180, v180, v184
    v_min_f32 v181, v181, v192
    v_add_f32 v188, v188, v192
    v_cmp_le_f32 s[72:73], s94, v181
    v_exp_f32 v97, v97
    v_exp_f32 v98, v98
    v_exp_f32 v99, v99
    v_exp_f32 v100, v100
    v_exp_f32 v101, v101
    v_smfmac_f32_32x32x32_bf16 v[28:43], a[96:99], v[92:99], v9
    v_add_f32 v180, v180, v188
    v_cmp_ge_f32 vcc, s95, v180
    s_mov_b32 s79, 0
    s_and_b64 s[22:23], s[72:73], vcc
    s_cmp_eq_u64 s[22:23], -1
    s_cbranch_scc0 att_slow
att_ret0:
    v_exp_f32 v102, v102
    v_exp_f32 v103, v103
    v_exp_f32 v104, v104
    v_exp_f32 v105, v105
    v_exp_f32 v106, v106
    v_exp_f32 v107, v107
    v_exp_f32 v60, v60
    v_exp_f32 v61, v61
    v_smfmac_f32_32x32x32_bf16 v[28:43], a[100:103], v[100:107], v9
    s_lshl_b32 s22, s3, 13
    s_add_u32 s22, s22, 98304
    v_add_u32 v17, s22, v0
    v_exp_f32 v62, v62
    v_exp_f32 v63, v63
    v_exp_f32 v64, v64
    v_mfma_f32_32x32x16_bf16 v[92:107], a[28:31], v[116:119], 0
    buffer_load_dwordx4 v[212:215], v252, s[28:31], s63 offen offset:3072 sc1
    ds_read_b128 v[180:183], v17 offset:0
    ds_read_b128 v[184:187], v17 offset:1024
    ds_read_b128 v[188:191], v17 offset:2048
    ds_read_b128 v[192:195], v17 offset:3072
    ds_read_b128 v[196:199], v17 offset:4096
    ds_read_b128 v[200:203], v17 offset:5120
    ds_read_b128 v[204:207], v17 offset:6144
    ds_read_b128 v[208:211], v17 offset:7168
    v_exp_f32 v65, v65
    v_exp_f32 v66, v66
    v_exp_f32 v67, v67
    v_exp_f32 v68, v68
    v_exp_f32 v69, v69
    v_smfmac_f32_32x32x32_bf16 v[28:43], a[104:107], v[60:67], v9
    v_exp_f32 v70, v70
    v_exp_f32 v71, v71
    v_exp_f32 v72, v72
    v_exp_f32 v73, v73
    v_exp_f32 v74, v74
    v_exp_f32 v75, v75
    v_exp_f32 v76, v76
    v_exp_f32 v77, v77
    v_smfmac_f32_32x32x32_bf16 v[28:43], a[108:111], v[68:75], v9
    v_exp_f32 v78, v78
    v_exp_f32 v79, v79
    v_exp_f32 v80, v80
    v_mfma_f32_32x32x16_bf16 v[60:75], a[32:35], v[116:119], 0
    s_waitcnt lgkmcnt(0)
    v_add_f32 v180, v180, v188
    v_add_f32 v181, v181, v189
    v_add_f32 v182, v182, v190
    v_add_f32 v183, v183, v191
    v_exp_f32 v81, v81
    v_exp_f32 v82, v82
    v_exp_f32 v83, v83
    v_exp_f32 v84, v84
    v_exp_f32 v85, v85
    v_smfmac_f32_32x32x32_bf16 v[28:43], a[112:115], v[76:83], v9
    v_add_f32 v184, v184, v192
    v_add_f32 v185, v185, v193
    v_add_f32 v186, v186, v194
    v_add_f32 v187, v187, v195
    v_add_f32 v196, v196, v204
    v_exp_f32 v86, v86
    v_exp_f32 v87, v87
    v_exp_f32 v88, v88
    v_exp_f32 v89, v89
    v_exp_f32 v90, v90
    v_exp_f32 v91, v91
    v_exp_f32 v92, v92
    v_exp_f32 v93, v93
    v_smfmac_f32_32x32x32_bf16 v[28:43], a[116:119], v[84:91], v9
    v_add_f32 v197, v197, v205
    v_add_f32 v198, v198, v206
    v_add_f32 v199, v199, v207
    v_add_f32 v200, v200, v208
    v_add_f32 v201, v201, v209
    v_exp_f32 v94, v94
    v_exp_f32 v95, v95
    v_exp_f32 v96, v96
    v_mfma_f32_32x32x16_bf16 v[76:91], a[36:39], v[116:119], 0
    buffer_load_dwordx4 v[216:219], v253, s[28:31], s63 offen offset:0 sc1
    v_add_f32 v202, v202, v210
    v_add_f32 v203, v203, v211
    v_add_f32 v180, v180, v196
    v_add_f32 v181, v181, v197
    v_exp_f32 v97, v97
    v_exp_f32 v98, v98
    v_exp_f32 v99, v99
    v_exp_f32 v100, v100
    v_exp_f32 v101, v101
    v_smfmac_f32_32x32x32_bf16 v[28:43], a[120:123], v[92:99], v9
    v_add_f32 v182, v182, v198
    v_add_f32 v183, v183, v199
    v_add_f32 v184, v184, v200
    v_add_f32 v185, v185, v201
    v_add_f32 v186, v186, v202
    v_exp_f32 v102, v102
    v_exp_f32 v103, v103
    v_exp_f32 v104, v104
    v_exp_f32 v105, v105
    v_exp_f32 v106, v106
    v_exp_f32 v107, v107
    v_exp_f32 v60, v60
    v_exp_f32 v61, v61
    v_smfmac_f32_32x32x32_bf16 v[28:43], a[124:127], v[100:107], v9
    v_add_f32 v187, v187, v203
    v_mul_f32 v180, v180, v12
    v_mul_f32 v181, v181, v12
    v_mul_f32 v182, v182, v12
    v_mul_f32 v183, v183, v12
    v_exp_f32 v62, v62
    v_exp_f32 v63, v63
    v_exp_f32 v64, v64
    v_mfma_f32_32x32x16_bf16 v[92:107], a[40:43], v[116:119], 0
    buffer_load_dwordx4 v[220:223], v253, s[28:31], s63 offen offset:1024 sc1
    v_mul_f32 v184, v184, v12
    v_mul_f32 v185, v185, v12
    v_mul_f32 v186, v186, v12
    v_mul_f32 v187, v187, v12
    v_cvt_pk_bf16_f32 v180, v180, v181
    v_exp_f32 v65, v65
    v_exp_f32 v66, v66
    v_exp_f32 v67, v67
    v_exp_f32 v68, v68
    v_exp_f32 v69, v69
    v_smfmac_f32_32x32x32_bf16 v[28:43], a[128:131], v[60:67], v9
    v_cvt_pk_bf16_f32 v181, v182, v183
    v_cvt_pk_bf16_f32 v182, v184, v185
    v_cvt_pk_bf16_f32 v183, v186, v187
    v_exp_f32 v70, v70
    v_exp_f32 v71, v71
    v_exp_f32 v72, v72
    v_exp_f32 v73, v73
    v_exp_f32 v74, v74
    v_exp_f32 v75, v75
    v_exp_f32 v76, v76
    v_exp_f32 v77, v77
    v_smfmac_f32_32x32x32_bf16 v[28:43], a[132:135], v[68:75], v9
    buffer_store_dwordx4 v[180:183], v0, s[12:15], s88 offen offset:0 sc1
    v_exp_f32 v78, v78
    v_exp_f32 v79, v79
    v_exp_f32 v80, v80
    v_mfma_f32_32x32x16_bf16 v[60:75], a[44:47], v[116:119], 0
    v_exp_f32 v81, v81
    v_exp_f32 v82, v82
    v_exp_f32 v83, v83
    v_exp_f32 v84, v84
    v_exp_f32 v85, v85
    v_smfmac_f32_32x32x32_bf16 v[28:43], a[136:139], v[76:83], v9
    v_exp_f32 v86, v86
    v_exp_f32 v87, v87
    v_exp_f32 v88, v88
    v_exp_f32 v89, v89
    v_exp_f32 v90, v90
    v_exp_f32 v91, v91
    v_exp_f32 v92, v92
    v_exp_f32 v93, v93
    v_smfmac_f32_32x32x32_bf16 v[28:43], a[140:143], v[84:91], v9
    v_exp_f32 v94, v94
    v_exp_f32 v95, v95
    v_exp_f32 v96, v96
    v_mfma_f32_32x32x16_bf16 v[76:91], a[48:51], v[116:119], 0
    buffer_load_dwordx4 v[224:227], v253, s[28:31], s63 offen offset:2048 sc1
    v_exp_f32 v97, v97
    v_exp_f32 v98, v98
    v_exp_f32 v99, v99
    v_exp_f32 v100, v100
    v_exp_f32 v101, v101
    v_smfmac_f32_32x32x32_bf16 v[28:43], a[144:147], v[92:99], v9
    v_exp_f32 v102, v102
    v_exp_f32 v103, v103
    v_exp_f32 v104, v104
    v_exp_f32 v105, v105
    v_exp_f32 v106, v106
    v_exp_f32 v107, v107
    v_exp_f32 v60, v60
    v_exp_f32 v61, v61
    v_smfmac_f32_32x32x32_bf16 v[28:43], a[148:151], v[100:107], v9
    v_exp_f32 v62, v62
    v_exp_f32 v63, v63
    v_exp_f32 v64, v64
    v_mfma_f32_32x32x16_bf16 v[92:107], a[52:55], v[116:119], 0
    buffer_load_dwordx4 v[228:231], v253, s[28:31], s63 offen offset:3072 sc1
    v_exp_f32 v65, v65
    v_exp_f32 v66, v66
    v_exp_f32 v67, v67
    v_exp_f32 v68, v68
    v_exp_f32 v69, v69
    v_smfmac_f32_32x32x32_bf16 v[28:43], a[152:155], v[60:67], v9
    v_exp_f32 v70, v70
    v_exp_f32 v71, v71
    v_exp_f32 v72, v72
    v_exp_f32 v73, v73
    v_exp_f32 v74, v74
    v_exp_f32 v75, v75
    v_exp_f32 v76, v76
    v_exp_f32 v77, v77
    v_smfmac_f32_32x32x32_bf16 v[28:43], a[156:159], v[68:75], v9
    v_exp_f32 v78, v78
    v_exp_f32 v79, v79
    v_exp_f32 v80, v80
    v_mfma_f32_32x32x16_bf16 v[60:75], a[56:59], v[116:119], 0
    v_exp_f32 v81, v81
    v_exp_f32 v82, v82
    v_exp_f32 v83, v83
    v_exp_f32 v84, v84
    v_exp_f32 v85, v85
    v_smfmac_f32_32x32x32_bf16 v[28:43], a[160:163], v[76:83], v9
    v_exp_f32 v86, v86
    v_exp_f32 v87, v87
    v_exp_f32 v88, v88
    v_exp_f32 v89, v89
    v_exp_f32 v90, v90
    v_exp_f32 v91, v91
    v_exp_f32 v92, v92
    v_exp_f32 v93, v93
    v_smfmac_f32_32x32x32_bf16 v[28:43], a[164:167], v[84:91], v9
    v_exp_f32 v94, v94
    v_exp_f32 v95, v95
    v_exp_f32 v96, v96
    v_mfma_f32_32x32x16_bf16 v[76:91], a[60:63], v[116:119], 0
    buffer_load_dwordx4 v[232:235], v254, s[28:31], s63 offen offset:0 sc1
    v_exp_f32 v97, v97
    v_exp_f32 v98, v98
    v_exp_f32 v99, v99
    v_exp_f32 v100, v100
    v_exp_f32 v101, v101
    v_smfmac_f32_32x32x32_bf16 v[28:43], a[168:171], v[92:99], v9
    v_exp_f32 v102, v102
    v_exp_f32 v103, v103
    v_exp_f32 v104, v104
    v_exp_f32 v105, v105
    v_exp_f32 v106, v106
    v_exp_f32 v107, v107
    v_exp_f32 v60, v60
    v_exp_f32 v61, v61
    v_smfmac_f32_32x32x32_bf16 v[28:43], a[172:175], v[100:107], v9
    v_exp_f32 v62, v62
    v_exp_f32 v63, v63
    v_exp_f32 v64, v64
    s_waitcnt vmcnt(13)
    v_mfma_f32_32x32x16_bf16 v[92:107], a[0:3], v[24:27], 0
    buffer_load_dwordx4 v[236:239], v254, s[28:31], s63 offen offset:1024 sc1
    v_exp_f32 v65, v65
    v_exp_f32 v66, v66
    v_exp_f32 v67, v67
    v_exp_f32 v68, v68
    v_exp_f32 v69, v69
    v_smfmac_f32_32x32x32_bf16 v[28:43], a[176:179], v[60:67], v9
    v_exp_f32 v70, v70
    v_exp_f32 v71, v71
    v_exp_f32 v72, v72
    v_exp_f32 v73, v73
    v_exp_f32 v74, v74
    v_exp_f32 v75, v75
    v_exp_f32 v76, v76
    v_exp_f32 v77, v77
    v_smfmac_f32_32x32x32_bf16 v[28:43], a[180:183], v[68:75], v9
    s_waitcnt vmcnt(4)
    s_barrier
    s_cmp_lg_u32 s3, 0
    s_cbranch_scc1 sg5
    s_atomic_add s7, s[8:9], s59
    s_add_u32 s51, s59, 128
    s_atomic_add s7, s[8:9], s51
    s_add_u32 s51, s59, 256
    s_atomic_add s7, s[8:9], s51
    s_add_u32 s51, s59, 384
    s_atomic_add s7, s[8:9], s51
sg5:
    s_add_u32 s59, s59, 4096
    v_exp_f32 v78, v78
    v_exp_f32 v79, v79
    v_exp_f32 v80, v80
    v_mfma_f32_32x32x16_bf16 v[60:75], a[4:7], v[24:27], 0
    v_exp_f32 v81, v81
    v_exp_f32 v82, v82
    v_exp_f32 v83, v83
    v_exp_f32 v84, v84
    v_exp_f32 v85, v85
    v_smfmac_f32_32x32x32_bf16 v[28:43], a[184:187], v[76:83], v9
    v_exp_f32 v86, v86
    v_exp_f32 v87, v87
    v_exp_f32 v88, v88
    v_exp_f32 v89, v89
    v_exp_f32 v90, v90
    v_exp_f32 v91, v91
    v_exp_f32 v92, v92
    v_exp_f32 v93, v93
    v_smfmac_f32_32x32x32_bf16 v[28:43], a[188:191], v[84:91], v9
    v_exp_f32 v94, v94
    v_exp_f32 v95, v95
    v_exp_f32 v96, v96
    v_mfma_f32_32x32x16_bf16 v[76:91], a[8:11], v[24:27], 0
    buffer_load_dwordx4 v[240:243], v254, s[28:31], s63 offen offset:2048 sc1
    v_exp_f32 v97, v97
    v_exp_f32 v98, v98
    v_exp_f32 v99, v99
    v_exp_f32 v100, v100
    v_exp_f32 v101, v101
    v_smfmac_f32_32x32x32_bf16 v[44:59], a[64:67], v[92:99], v9
    v_exp_f32 v102, v102
    v_exp_f32 v103, v103
    v_exp_f32 v104, v104
    v_exp_f32 v105, v105
    v_exp_f32 v106, v106
    v_exp_f32 v107, v107
    v_exp_f32 v60, v60
    v_exp_f32 v61, v61
    v_smfmac_f32_32x32x32_bf16 v[44:59], a[68:71], v[100:107], v9
    ds_write_b128 v10, v[28:31] offset:0
    v_exp_f32 v62, v62
    v_exp_f32 v63, v63
    v_exp_f32 v64, v64
    v_mfma_f32_32x32x16_bf16 v[92:107], a[12:15], v[24:27], 0
    ds_write_b128 v10, v[32:35] offset:1024
    buffer_load_dwordx4 v[244:247], v254, s[28:31], s63 offen offset:3072 sc1
    v_exp_f32 v65, v65
    v_exp_f32 v66, v66
    v_exp_f32 v67, v67
    v_exp_f32 v68, v68
    v_exp_f32 v69, v69
    v_smfmac_f32_32x32x32_bf16 v[44:59], a[72:75], v[60:67], v9
    ds_write_b32 v11, v36 offset:0
    v_exp_f32 v70, v70
    v_exp_f32 v71, v71
    v_exp_f32 v72, v72
    v_exp_f32 v73, v73
    v_exp_f32 v74, v74
    v_exp_f32 v75, v75
    v_exp_f32 v76, v76
    v_exp_f32 v77, v77
    v_smfmac_f32_32x32x32_bf16 v[44:59], a[76:79], v[68:75], v9
    v_exp_f32 v78, v78
    v_exp_f32 v79, v79
    v_exp_f32 v80, v80
    v_mfma_f32_32x32x16_bf16 v[60:75], a[16:19], v[24:27], 0
    v_exp_f32 v81, v81
    v_exp_f32 v82, v82
    v_exp_f32 v83, v83
    v_exp_f32 v84, v84
    v_exp_f32 v85, v85
    v_smfmac_f32_32x32x32_bf16 v[44:59], a[80:83], v[76:83], v9
    v_exp_f32 v86, v86
    v_exp_f32 v87, v87
    v_exp_f32 v88, v88
    v_exp_f32 v89, v89
    v_mfma_f32_32x32x8_bf16 v[28:43], v[14:15], v[14:15], 0
    v_exp_f32 v90, v90
    v_exp_f32 v91, v91
    v_exp_f32 v92, v92
    v_exp_f32 v93, v93
    v_smfmac_f32_32x32x32_bf16 v[44:59], a[84:87], v[84:91], v9
    v_exp_f32 v94, v94
    v_exp_f32 v95, v95
    v_exp_f32 v96, v96
    v_mfma_f32_32x32x16_bf16 v[76:91], a[20:23], v[24:27], 0
    buffer_load_dwordx4 v[120:123], v0, s[28:31], s62 offen offset:0 sc1
    v_exp_f32 v97, v97
    v_exp_f32 v98, v98
    v_exp_f32 v99, v99
    v_exp_f32 v100, v100
    v_exp_f32 v101, v101
    v_smfmac_f32_32x32x32_bf16 v[44:59], a[88:91], v[92:99], v9
    v_exp_f32 v102, v102
    v_exp_f32 v103, v103
    v_exp_f32 v104, v104
    v_exp_f32 v105, v105
    v_exp_f32 v106, v106
    v_exp_f32 v107, v107
    v_exp_f32 v60, v60
    v_exp_f32 v61, v61
    v_smfmac_f32_32x32x32_bf16 v[44:59], a[92:95], v[100:107], v9
    v_exp_f32 v62, v62
    v_exp_f32 v63, v63
    v_exp_f32 v64, v64
    v_mfma_f32_32x32x16_bf16 v[92:107], a[24:27], v[24:27], 0
    buffer_load_dwordx4 v[124:127], v0, s[28:31], s62 offen offset:1024 sc1
    v_exp_f32 v65, v65
    v_exp_f32 v66, v66
    v_exp_f32 v67, v67
    v_exp_f32 v68, v68
    v_exp_f32 v69, v69
    v_smfmac_f32_32x32x32_bf16 v[44:59], a[96:99], v[60:67], v9
    v_exp_f32 v70, v70
    v_exp_f32 v71, v71
    v_exp_f32 v72, v72
    v_exp_f32 v73, v73
    v_exp_f32 v74, v74
    v_exp_f32 v75, v75
    v_exp_f32 v76, v76
    v_exp_f32 v77, v77
    v_smfmac_f32_32x32x32_bf16 v[44:59], a[100:103], v[68:75], v9
    v_exp_f32 v78, v78
    v_exp_f32 v79, v79
    v_exp_f32 v80, v80
    v_mfma_f32_32x32x16_bf16 v[60:75], a[28:31], v[24:27], 0
    v_exp_f32 v81, v81
    v_exp_f32 v82, v82
    v_exp_f32 v83, v83
    v_exp_f32 v84, v84
    v_exp_f32 v85, v85
    v_smfmac_f32_32x32x32_bf16 v[44:59], a[104:107], v[76:83], v9
    v_exp_f32 v86, v86
    v_exp_f32 v87, v87
    v_exp_f32 v88, v88
    v_exp_f32 v89, v89
    v_exp_f32 v90, v90
    v_exp_f32 v91, v91
    v_exp_f32 v92, v92
    v_exp_f32 v93, v93
    v_smfmac_f32_32x32x32_bf16 v[44:59], a[108:111], v[84:91], v9
    v_exp_f32 v94, v94
    v_exp_f32 v95, v95
    v_exp_f32 v96, v96
    v_mfma_f32_32x32x16_bf16 v[76:91], a[32:35], v[24:27], 0
    buffer_load_dwordx4 v[128:131], v0, s[28:31], s62 offen offset:2048 sc1
    v_exp_f32 v97, v97
    v_exp_f32 v98, v98
    v_exp_f32 v99, v99
    v_exp_f32 v100, v100
    v_exp_f32 v101, v101
    v_smfmac_f32_32x32x32_bf16 v[44:59], a[112:115], v[92:99], v9
    v_exp_f32 v102, v102
    v_exp_f32 v103, v103
    v_exp_f32 v104, v104
    v_exp_f32 v105, v105
    v_exp_f32 v106, v106
    v_exp_f32 v107, v107
    v_exp_f32 v60, v60
    v_exp_f32 v61, v61
    v_smfmac_f32_32x32x32_bf16 v[44:59], a[116:119], v[100:107], v9
    v_exp_f32 v62, v62
    v_exp_f32 v63, v63
    v_exp_f32 v64, v64
    v_mfma_f32_32x32x16_bf16 v[92:107], a[36:39], v[24:27], 0
    buffer_load_dwordx4 v[132:135], v0, s[28:31], s62 offen offset:3072 sc1
    v_exp_f32 v65, v65
    v_exp_f32 v66, v66
    v_exp_f32 v67, v67
    v_exp_f32 v68, v68
    v_exp_f32 v69, v69
    v_smfmac_f32_32x32x32_bf16 v[44:59], a[120:123], v[60:67], v9
    v_exp_f32 v70, v70
    v_exp_f32 v71, v71
    v_exp_f32 v72, v72
    v_exp_f32 v73, v73
    v_exp_f32 v74, v74
    v_exp_f32 v75, v75
    v_exp_f32 v76, v76
    v_exp_f32 v77, v77
    v_smfmac_f32_32x32x32_bf16 v[44:59], a[124:127], v[68:75], v9
    v_exp_f32 v78, v78
    v_exp_f32 v79, v79
    v_exp_f32 v80, v80
    v_mfma_f32_32x32x16_bf16 v[60:75], a[40:43], v[24:27], 0
    v_exp_f32 v81, v81
    v_exp_f32 v82, v82
    v_exp_f32 v83, v83
    v_exp_f32 v84, v84
    v_exp_f32 v85, v85
    v_smfmac_f32_32x32x32_bf16 v[44:59], a[128:131], v[76:83], v9
    v_exp_f32 v86, v86
    v_exp_f32 v87, v87
    v_exp_f32 v88, v88
    v_exp_f32 v89, v89
    v_exp_f32 v90, v90
    v_exp_f32 v91, v91
    v_exp_f32 v92, v92
    v_exp_f32 v93, v93
    v_smfmac_f32_32x32x32_bf16 v[44:59], a[132:135], v[84:91], v9
    v_exp_f32 v94, v94
    v_exp_f32 v95, v95
    v_exp_f32 v96, v96
    v_mfma_f32_32x32x16_bf16 v[76:91], a[44:47], v[24:27], 0
    buffer_load_dwordx4 v[136:139], v252, s[28:31], s62 offen offset:0 sc1
    v_exp_f32 v97, v97
    v_exp_f32 v98, v98
    v_exp_f32 v99, v99
    v_exp_f32 v100, v100
    v_exp_f32 v101, v101
    v_smfmac_f32_32x32x32_bf16 v[44:59], a[136:139], v[92:99], v9
    v_exp_f32 v102, v102
    v_exp_f32 v103, v103
    v_exp_f32 v104, v104
    v_exp_f32 v105, v105
    v_exp_f32 v106, v106
    v_exp_f32 v107, v107
    v_exp_f32 v60, v60
    v_exp_f32 v61, v61
    v_smfmac_f32_32x32x32_bf16 v[44:59], a[140:143], v[100:107], v9
    v_exp_f32 v62, v62
    v_exp_f32 v63, v63
    v_exp_f32 v64, v64
    v_mfma_f32_32x32x16_bf16 v[92:107], a[48:51], v[24:27], 0
    buffer_load_dwordx4 v[140:143], v252, s[28:31], s62 offen offset:1024 sc1
    v_exp_f32 v65, v65
    v_exp_f32 v66, v66
    v_exp_f32 v67, v67
    v_exp_f32 v68, v68
    v_exp_f32 v69, v69
    v_smfmac_f32_32x32x32_bf16 v[44:59], a[144:147], v[60:67], v9
    v_exp_f32 v70, v70
    v_exp_f32 v71, v71
    v_exp_f32 v72, v72
    v_exp_f32 v73, v73
    v_exp_f32 v74, v74
    v_exp_f32 v75, v75
    v_exp_f32 v76, v76
    v_exp_f32 v77, v77
    v_smfmac_f32_32x32x32_bf16 v[44:59], a[148:151], v[68:75], v9
    v_exp_f32 v78, v78
    v_exp_f32 v79, v79
    v_exp_f32 v80, v80
    v_mfma_f32_32x32x16_bf16 v[60:75], a[52:55], v[24:27], 0
    v_exp_f32 v81, v81
    v_exp_f32 v82, v82
    v_exp_f32 v83, v83
    v_exp_f32 v84, v84
    v_exp_f32 v85, v85
    v_smfmac_f32_32x32x32_bf16 v[44:59], a[152:155], v[76:83], v9
    v_exp_f32 v86, v86
    v_exp_f32 v87, v87
    v_exp_f32 v88, v88
    v_exp_f32 v89, v89
    v_exp_f32 v90, v90
    v_exp_f32 v91, v91
    v_exp_f32 v92, v92
    v_exp_f32 v93, v93
    v_smfmac_f32_32x32x32_bf16 v[44:59], a[156:159], v[84:91], v9
    v_exp_f32 v94, v94
    v_exp_f32 v95, v95
    v_exp_f32 v96, v96
    v_mfma_f32_32x32x16_bf16 v[76:91], a[56:59], v[24:27], 0
    buffer_load_dwordx4 v[144:147], v252, s[28:31], s62 offen offset:2048 sc1
    v_exp_f32 v97, v97
    v_exp_f32 v98, v98
    v_exp_f32 v99, v99
    v_exp_f32 v100, v100
    v_exp_f32 v101, v101
    v_smfmac_f32_32x32x32_bf16 v[44:59], a[160:163], v[92:99], v9
    v_exp_f32 v102, v102
    v_exp_f32 v103, v103
    v_exp_f32 v104, v104
    v_exp_f32 v105, v105
    v_exp_f32 v106, v106
    v_exp_f32 v107, v107
    v_exp_f32 v60, v60
    v_exp_f32 v61, v61
    v_smfmac_f32_32x32x32_bf16 v[44:59], a[164:167], v[100:107], v9
    v_exp_f32 v62, v62
    v_exp_f32 v63, v63
    v_exp_f32 v64, v64
    v_mfma_f32_32x32x16_bf16 v[92:107], a[60:63], v[24:27], 0
    buffer_load_dwordx4 v[148:151], v252, s[28:31], s62 offen offset:3072 sc1
    v_exp_f32 v65, v65
    v_exp_f32 v66, v66
    v_exp_f32 v67, v67
    v_exp_f32 v68, v68
    v_exp_f32 v69, v69
    v_smfmac_f32_32x32x32_bf16 v[44:59], a[168:171], v[60:67], v9
    v_exp_f32 v70, v70
    v_exp_f32 v71, v71
    v_exp_f32 v72, v72
    v_exp_f32 v73, v73
    v_exp_f32 v74, v74
    v_exp_f32 v75, v75
    v_exp_f32 v76, v76
    v_exp_f32 v77, v77
    v_smfmac_f32_32x32x32_bf16 v[44:59], a[172:175], v[68:75], v9
    buffer_load_dwordx4 v[24:27], v252, s[12:15], s78 offen offset:3072 sc1
    v_exp_f32 v78, v78
    v_exp_f32 v79, v79
    v_exp_f32 v80, v80
    v_mfma_f32_32x32x16_bf16 v[60:75], a[0:3], v[20:23], 0
    v_exp_f32 v81, v81
    v_exp_f32 v82, v82
    v_exp_f32 v83, v83
    v_exp_f32 v84, v84
    v_exp_f32 v85, v85
    v_smfmac_f32_32x32x32_bf16 v[44:59], a[176:179], v[76:83], v9
    v_exp_f32 v86, v86
    v_exp_f32 v87, v87
    v_exp_f32 v88, v88
    v_exp_f32 v89, v89
    v_exp_f32 v90, v90
    v_exp_f32 v91, v91
    v_exp_f32 v92, v92
    v_exp_f32 v93, v93
    v_smfmac_f32_32x32x32_bf16 v[44:59], a[180:183], v[84:91], v9
    v_exp_f32 v94, v94
    v_exp_f32 v95, v95
    v_exp_f32 v96, v96
    v_mfma_f32_32x32x16_bf16 v[76:91], a[4:7], v[20:23], 0
    buffer_load_dwordx4 v[172:175], v254, s[28:31], s62 offen offset:1024 sc1
    v_exp_f32 v97, v97
    v_exp_f32 v98, v98
    v_exp_f32 v99, v99
    v_exp_f32 v100, v100
    v_exp_f32 v101, v101
    v_smfmac_f32_32x32x32_bf16 v[44:59], a[184:187], v[92:99], v9
    v_exp_f32 v102, v102
    v_exp_f32 v103, v103
    v_exp_f32 v104, v104
    v_exp_f32 v105, v105
    v_exp_f32 v106, v106
    v_exp_f32 v107, v107
    v_exp_f32 v60, v60
    v_exp_f32 v61, v61
    v_smfmac_f32_32x32x32_bf16 v[44:59], a[188:191], v[100:107], v9
    v_exp_f32 v62, v62
    v_exp_f32 v63, v63
    v_exp_f32 v64, v64
    v_mfma_f32_32x32x16_bf16 v[92:107], a[8:11], v[20:23], 0
    buffer_load_dwordx4 v[176:179], v254, s[28:31], s62 offen offset:2048 sc1
    v_exp_f32 v65, v65
    v_exp_f32 v66, v66
    v_exp_f32 v67, v67
    v_exp_f32 v68, v68
    v_exp_f32 v69, v69
    v_smfmac_f32_32x32x32_bf16 v[28:43], a[64:67], v[60:67], v9
    v_exp_f32 v70, v70
    v_exp_f32 v71, v71
    v_exp_f32 v72, v72
    v_exp_f32 v73, v73
    v_exp_f32 v74, v74
    v_exp_f32 v75, v75
    v_exp_f32 v76, v76
    v_exp_f32 v77, v77
    v_smfmac_f32_32x32x32_bf16 v[28:43], a[68:71], v[68:75], v9
    ds_write_b128 v10, v[44:47] offset:8192
    v_exp_f32 v78, v78
    v_exp_f32 v79, v79
    v_exp_f32 v80, v80
    v_mfma_f32_32x32x16_bf16 v[60:75], a[12:15], v[20:23], 0
    ds_write_b128 v10, v[48:51] offset:9216
    v_exp_f32 v81, v81
    v_exp_f32 v82, v82
    v_exp_f32 v83, v83
    v_exp_f32 v84, v84
    v_exp_f32 v85, v85
    v_smfmac_f32_32x32x32_bf16 v[28:43], a[72:75], v[76:83], v9
    ds_write_b32 v11, v52 offset:1024
    v_exp_f32 v86, v86
    v_exp_f32 v87, v87
    v_exp_f32 v88, v88
    v_exp_f32 v89, v89
    v_exp_f32 v90, v90
    v_exp_f32 v91, v91
    v_exp_f32 v92, v92
    v_exp_f32 v93, v93
    v_smfmac_f32_32x32x32_bf16 v[28:43], a[76:79], v[84:91], v9
    s_lshl_b32 s32, s4, 9
    s_add_u32 s32, s32, s47
    s_add_u32 s32, s32, 65536
    s_bfe_u32 s33, s5, 131074
    s_lshl_b32 s33, s33, 7
    s_add_u32 s32, s32, s33
    s_cmp_lg_u32 s3, 1
    s_cbranch_scc1 pl6
    s_mov_b32 s36, 0
    s_atomic_add s36, s[8:9], s32 glc
pl6:
    v_exp_f32 v94, v94
    v_exp_f32 v95, v95
    v_exp_f32 v96, v96
    v_mfma_f32_32x32x16_bf16 v[76:91], a[16:19], v[20:23], 0
    buffer_load_dwordx4 v[180:183], v254, s[28:31], s62 offen offset:3072 sc1
    v_exp_f32 v97, v97
    v_exp_f32 v98, v98
    v_exp_f32 v99, v99
    v_exp_f32 v100, v100
    v_exp_f32 v101, v101
    v_smfmac_f32_32x32x32_bf16 v[28:43], a[80:83], v[92:99], v9
    v_exp_f32 v102, v102
    v_exp_f32 v103, v103
    v_exp_f32 v104, v104
    v_exp_f32 v105, v105
    v_mfma_f32_32x32x8_bf16 v[44:59], v[14:15], v[14:15], 0
    v_exp_f32 v106, v106
    v_exp_f32 v107, v107
    v_exp_f32 v60, v60
    v_exp_f32 v61, v61
    v_smfmac_f32_32x32x32_bf16 v[28:43], a[84:87], v[100:107], v9
    v_exp_f32 v62, v62
    v_exp_f32 v63, v63
    v_exp_f32 v64, v64
    v_mfma_f32_32x32x16_bf16 v[92:107], a[20:23], v[20:23], 0
    buffer_load_dwordx4 v[184:187], v0, s[28:31], s63 offen offset:0 sc1
    v_exp_f32 v65, v65
    v_exp_f32 v66, v66
    v_exp_f32 v67, v67
    v_exp_f32 v68, v68
    v_exp_f32 v69, v69
    v_smfmac_f32_32x32x32_bf16 v[28:43], a[88:91], v[60:67], v9
    v_exp_f32 v70, v70
    v_exp_f32 v71, v71
    v_exp_f32 v72, v72
    v_exp_f32 v73, v73
    v_exp_f32 v74, v74
    v_exp_f32 v75, v75
    v_exp_f32 v76, v76
    v_exp_f32 v77, v77
    v_smfmac_f32_32x32x32_bf16 v[28:43], a[92:95], v[68:75], v9
    v_exp_f32 v78, v78
    v_exp_f32 v79, v79
    v_exp_f32 v80, v80
    v_mfma_f32_32x32x16_bf16 v[60:75], a[24:27], v[20:23], 0
    v_exp_f32 v81, v81
    v_exp_f32 v82, v82
    v_exp_f32 v83, v83
    v_exp_f32 v84, v84
    v_exp_f32 v85, v85
    v_smfmac_f32_32x32x32_bf16 v[28:43], a[96:99], v[76:83], v9
    v_exp_f32 v86, v86
    v_exp_f32 v87, v87
    v_exp_f32 v88, v88
    v_exp_f32 v89, v89
    v_exp_f32 v90, v90
    v_exp_f32 v91, v91
    v_exp_f32 v92, v92
    v_exp_f32 v93, v93
    v_smfmac_f32_32x32x32_bf16 v[28:43], a[100:103], v[84:91], v9
    v_exp_f32 v94, v94
    v_exp_f32 v95, v95
    v_exp_f32 v96, v96
    v_mfma_f32_32x32x16_bf16 v[76:91], a[28:31], v[20:23], 0
    buffer_load_dwordx4 v[188:191], v0, s[28:31], s63 offen offset:1024 sc1
    v_exp_f32 v97, v97
    v_exp_f32 v98, v98
    v_exp_f32 v99, v99
    v_exp_f32 v100, v100
    v_exp_f32 v101, v101
    v_smfmac_f32_32x32x32_bf16 v[28:43], a[104:107], v[92:99], v9
    v_exp_f32 v102, v102
    v_exp_f32 v103, v103
    v_exp_f32 v104, v104
    v_exp_f32 v105, v105
    v_exp_f32 v106, v106
    v_exp_f32 v107, v107
    v_exp_f32 v60, v60
    v_exp_f32 v61, v61
    v_smfmac_f32_32x32x32_bf16 v[28:43], a[108:111], v[100:107], v9
    v_exp_f32 v62, v62
    v_exp_f32 v63, v63
    v_exp_f32 v64, v64
    v_mfma_f32_32x32x16_bf16 v[92:107], a[32:35], v[20:23], 0
    buffer_load_dwordx4 v[192:195], v0, s[28:31], s63 offen offset:2048 sc1
    v_exp_f32 v65, v65
    v_exp_f32 v66, v66
    v_exp_f32 v67, v67
    v_exp_f32 v68, v68
    v_exp_f32 v69, v69
    v_smfmac_f32_32x32x32_bf16 v[28:43], a[112:115], v[60:67], v9
    v_exp_f32 v70, v70
    v_exp_f32 v71, v71
    v_exp_f32 v72, v72
    v_exp_f32 v73, v73
    v_exp_f32 v74, v74
    v_exp_f32 v75, v75
    v_exp_f32 v76, v76
    v_exp_f32 v77, v77
    v_smfmac_f32_32x32x32_bf16 v[28:43], a[116:119], v[68:75], v9
    v_exp_f32 v78, v78
    v_exp_f32 v79, v79
    v_exp_f32 v80, v80
    v_mfma_f32_32x32x16_bf16 v[60:75], a[36:39], v[20:23], 0
    v_exp_f32 v81, v81
    v_exp_f32 v82, v82
    v_exp_f32 v83, v83
    v_exp_f32 v84, v84
    v_exp_f32 v85, v85
    v_smfmac_f32_32x32x32_bf16 v[28:43], a[120:123], v[76:83], v9
    v_exp_f32 v86, v86
    v_exp_f32 v87, v87
    v_exp_f32 v88, v88
    v_exp_f32 v89, v89
    v_exp_f32 v90, v90
    v_exp_f32 v91, v91
    v_exp_f32 v92, v92
    v_exp_f32 v93, v93
    v_smfmac_f32_32x32x32_bf16 v[28:43], a[124:127], v[84:91], v9
    s_waitcnt lgkmcnt(0)
    s_cmp_lt_u32 s36, s45
    s_cbranch_scc1 tw_sp
tw_go:
    s_barrier
    v_exp_f32 v94, v94
    v_exp_f32 v95, v95
    v_exp_f32 v96, v96
    v_mfma_f32_32x32x16_bf16 v[76:91], a[40:43], v[20:23], 0
    buffer_load_dwordx4 v[196:199], v0, s[28:31], s63 offen offset:3072 sc1
    v_exp_f32 v97, v97
    v_exp_f32 v98, v98
    v_exp_f32 v99, v99
    v_exp_f32 v100, v100
    v_exp_f32 v101, v101
    v_smfmac_f32_32x32x32_bf16 v[28:43], a[128:131], v[92:99], v9
    v_exp_f32 v102, v102
    v_exp_f32 v103, v103
    v_exp_f32 v104, v104
    v_exp_f32 v105, v105
    v_exp_f32 v106, v106
    v_exp_f32 v107, v107
    v_exp_f32 v60, v60
    v_exp_f32 v61, v61
    v_smfmac_f32_32x32x32_bf16 v[28:43], a[132:135], v[100:107], v9
    v_exp_f32 v62, v62
    v_exp_f32 v63, v63
    v_exp_f32 v64, v64
    v_mfma_f32_32x32x16_bf16 v[92:107], a[44:47], v[20:23], 0
    buffer_load_dwordx4 v[200:203], v252, s[28:31], s63 offen offset:0 sc1
    v_exp_f32 v65, v65
    v_exp_f32 v66, v66
    v_exp_f32 v67, v67
    v_exp_f32 v68, v68
    v_exp_f32 v69, v69
    v_smfmac_f32_32x32x32_bf16 v[28:43], a[136:139], v[60:67], v9
    v_exp_f32 v70, v70
    v_exp_f32 v71, v71
    v_exp_f32 v72, v72
    v_exp_f32 v73, v73
    v_exp_f32 v74, v74
    v_exp_f32 v75, v75
    v_exp_f32 v76, v76
    v_exp_f32 v77, v77
    v_smfmac_f32_32x32x32_bf16 v[28:43], a[140:143], v[68:75], v9
    v_exp_f32 v78, v78
    v_exp_f32 v79, v79
    v_exp_f32 v80, v80
    v_mfma_f32_32x32x16_bf16 v[60:75], a[48:51], v[20:23], 0
    v_exp_f32 v81, v81
    v_exp_f32 v82, v82
    v_exp_f32 v83, v83
    v_exp_f32 v84, v84
    v_exp_f32 v85, v85
    v_smfmac_f32_32x32x32_bf16 v[28:43], a[144:147], v[76:83], v9
    v_exp_f32 v86, v86
    v_exp_f32 v87, v87
    v_exp_f32 v88, v88
    v_exp_f32 v89, v89
    v_exp_f32 v90, v90
    v_exp_f32 v91, v91
    v_exp_f32 v92, v92
    v_exp_f32 v93, v93
    v_smfmac_f32_32x32x32_bf16 v[28:43], a[148:151], v[84:91], v9
    v_exp_f32 v94, v94
    v_exp_f32 v95, v95
    v_exp_f32 v96, v96
    v_mfma_f32_32x32x16_bf16 v[76:91], a[52:55], v[20:23], 0
    buffer_load_dwordx4 v[204:207], v252, s[28:31], s63 offen offset:1024 sc1
    v_exp_f32 v97, v97
    v_exp_f32 v98, v98
    v_exp_f32 v99, v99
    v_exp_f32 v100, v100
    v_exp_f32 v101, v101
    v_smfmac_f32_32x32x32_bf16 v[28:43], a[152:155], v[92:99], v9
    v_exp_f32 v102, v102
    v_exp_f32 v103, v103
    v_exp_f32 v104, v104
    v_exp_f32 v105, v105
    v_exp_f32 v106, v106
    v_exp_f32 v107, v107
    v_exp_f32 v60, v60
    v_exp_f32 v61, v61
    v_smfmac_f32_32x32x32_bf16 v[28:43], a[156:159], v[100:107], v9
    s_lshr_b32 s22, s5, 2
    v_exp_f32 v62, v62
    v_exp_f32 v63, v63
    v_exp_f32 v64, v64
    v_mfma_f32_32x32x16_bf16 v[92:107], a[56:59], v[20:23], 0
    buffer_load_dwordx4 v[208:211], v252, s[28:31], s63 offen offset:2048 sc1
    s_mul_i32 s66, s22, 229376
    v_exp_f32 v65, v65
    v_exp_f32 v66, v66
    v_exp_f32 v67, v67
    v_exp_f32 v68, v68
    v_exp_f32 v69, v69
    v_smfmac_f32_32x32x32_bf16 v[28:43], a[160:163], v[60:67], v9
    s_mul_i32 s22, s3, 57344
    v_exp_f32 v70, v70
    v_exp_f32 v71, v71
    v_exp_f32 v72, v72
    v_exp_f32 v73, v73
    v_exp_f32 v74, v74
    v_exp_f32 v75, v75
    v_exp_f32 v76, v76
    v_exp_f32 v77, v77
    v_smfmac_f32_32x32x32_bf16 v[28:43], a[164:167], v[68:75], v9
    s_add_u32 s66, s66, s22
    v_exp_f32 v78, v78
    v_exp_f32 v79, v79
    v_exp_f32 v80, v80
    v_mfma_f32_32x32x16_bf16 v[60:75], a[60:63], v[20:23], 0
    s_add_u32 s66, s66, 524288
    v_exp_f32 v81, v81
    v_exp_f32 v82, v82
    v_exp_f32 v83, v83
    v_exp_f32 v84, v84
    v_exp_f32 v85, v85
    v_smfmac_f32_32x32x32_bf16 v[28:43], a[168:171], v[76:83], v9
    s_add_u32 s67, s66, 16384
    v_exp_f32 v86, v86
    v_exp_f32 v87, v87
    v_exp_f32 v88, v88
    v_exp_f32 v89, v89
    v_exp_f32 v90, v90
    v_exp_f32 v91, v91
    v_exp_f32 v92, v92
    v_exp_f32 v93, v93
    v_smfmac_f32_32x32x32_bf16 v[28:43], a[172:175], v[84:91], v9
    s_getpc_b64 s[22:23]
    s_lshl_b32 s33, s5, 2
    s_add_u32 s33, s33, s3
    s_lshl_b32 s33, s33, 8
    v_lshl_add_u32 v18, v1, 2, s33
    v_min_u32 v18, CODE_END - CODE_RF2 - 8, v18
CODE_RF2:
    global_load_dword v19, v18, s[22:23]
    s_add_u32 s68, s66, 32768
    v_exp_f32 v94, v94
    v_exp_f32 v95, v95
    v_exp_f32 v96, v96
    s_waitcnt vmcnt(11)
    v_mfma_f32_32x32x16_bf16 v[76:91], a[0:3], v[24:27], 0
    s_add_u32 s69, s66, 49152
    v_exp_f32 v97, v97
    v_exp_f32 v98, v98
    v_exp_f32 v99, v99
    v_exp_f32 v100, v100
    v_exp_f32 v101, v101
    v_smfmac_f32_32x32x32_bf16 v[28:43], a[176:179], v[92:99], v9
    v_exp_f32 v102, v102
    v_exp_f32 v103, v103
    v_exp_f32 v104, v104
    v_exp_f32 v105, v105
    v_exp_f32 v106, v106
    v_exp_f32 v107, v107
    v_exp_f32 v60, v60
    v_exp_f32 v61, v61
    v_smfmac_f32_32x32x32_bf16 v[28:43], a[180:183], v[100:107], v9
    v_exp_f32 v62, v62
    v_exp_f32 v63, v63
    v_exp_f32 v64, v64
    v_mfma_f32_32x32x16_bf16 v[92:107], a[4:7], v[24:27], 0
    v_exp_f32 v65, v65
    v_exp_f32 v66, v66
    v_exp_f32 v67, v67
    v_exp_f32 v68, v68
    v_exp_f32 v69, v69
    v_smfmac_f32_32x32x32_bf16 v[28:43], a[184:187], v[60:67], v9
    v_exp_f32 v70, v70
    v_exp_f32 v71, v71
    v_exp_f32 v72, v72
    v_exp_f32 v73, v73
    v_exp_f32 v74, v74
    v_exp_f32 v75, v75
    v_exp_f32 v76, v76
    v_exp_f32 v77, v77
    v_smfmac_f32_32x32x32_bf16 v[28:43], a[188:191], v[68:75], v9
    v_exp_f32 v78, v78
    v_exp_f32 v79, v79
    v_exp_f32 v80, v80
    v_mfma_f32_32x32x16_bf16 v[60:75], a[8:11], v[24:27], 0
    v_exp_f32 v81, v81
    v_exp_f32 v82, v82
    v_exp_f32 v83, v83
    v_exp_f32 v84, v84
    v_exp_f32 v85, v85
    v_smfmac_f32_32x32x32_bf16 v[44:59], a[64:67], v[76:83], v9
    v_exp_f32 v86, v86
    v_exp_f32 v87, v87
    v_exp_f32 v88, v88
    v_exp_f32 v89, v89
    v_exp_f32 v90, v90
    v_exp_f32 v91, v91
    v_exp_f32 v92, v92
    v_exp_f32 v93, v93
    v_smfmac_f32_32x32x32_bf16 v[44:59], a[68:71], v[84:91], v9
    ds_write_b128 v10, v[28:31] offset:16384
    v_exp_f32 v94, v94
    v_exp_f32 v95, v95
    v_exp_f32 v96, v96
    v_mfma_f32_32x32x16_bf16 v[76:91], a[12:15], v[24:27], 0
    ds_write_b128 v10, v[32:35] offset:17408
    v_exp_f32 v97, v97
    v_exp_f32 v98, v98
    v_exp_f32 v99, v99
    v_exp_f32 v100, v100
    v_exp_f32 v101, v101
    v_smfmac_f32_32x32x32_bf16 v[44:59], a[72:75], v[92:99], v9
    ds_write_b32 v11, v36 offset:2048
    v_exp_f32 v102, v102
    v_exp_f32 v103, v103
    v_exp_f32 v104, v104
    v_exp_f32 v105, v105
    v_exp_f32 v106, v106
    v_exp_f32 v107, v107
    v_exp_f32 v60, v60
    v_exp_f32 v61, v61
    v_smfmac_f32_32x32x32_bf16 v[44:59], a[76:79], v[100:107], v9
    buffer_load_dwordx4 a[64:67], v0, s[8:11], s67 offen offset:0 sc1
    s_lshr_b32 s54, s5, 2
    s_and_b32 s55, s5, 3
    s_lshl_b32 s22, s4, 3
    s_add_u32 s55, s55, s22
    v_exp_f32 v62, v62
    v_exp_f32 v63, v63
    v_exp_f32 v64, v64
    v_mfma_f32_32x32x16_bf16 v[92:107], a[16:19], v[24:27], 0
    s_bfe_u32 s56, s5, 0x10001
    s_and_b32 s57, s5, 1
    s_lshl_b32 s22, s3, 13
    v_exp_f32 v65, v65
    v_exp_f32 v66, v66
    v_exp_f32 v67, v67
    v_exp_f32 v68, v68
    v_exp_f32 v69, v69
    v_smfmac_f32_32x32x32_bf16 v[44:59], a[80:83], v[60:67], v9
    buffer_load_dwordx4 a[68:71], v0, s[8:11], s67 offen offset:1024 sc1
    s_add_u32 s22, s22, 98304
    v_add_u32 v28, s22, v0
    v_xor_b32 v29, 128, v28
    v_exp_f32 v70, v70
    v_exp_f32 v71, v71
    v_exp_f32 v72, v72
    v_exp_f32 v73, v73
    v_exp_f32 v74, v74
    v_exp_f32 v75, v75
    v_exp_f32 v76, v76
    v_exp_f32 v77, v77
    v_smfmac_f32_32x32x32_bf16 v[44:59], a[84:87], v[68:75], v9
    buffer_load_dwordx4 a[72:75], v0, s[8:11], s67 offen offset:2048 sc1
    v_and_b32 v7, 7, v1
    v_lshrrev_b32 v34, 5, v1
    s_lshl_b32 s22, s3, 3
    v_exp_f32 v78, v78
    v_exp_f32 v79, v79
    v_exp_f32 v80, v80
    v_mfma_f32_32x32x16_bf16 v[60:75], a[20:23], v[24:27], 0
    v_add_u32 v7, s22, v7
    v_lshlrev_b32 v33, 2, v7
    v_lshl_add_u32 v33, v34, 7, v33
    v_exp_f32 v81, v81
    v_exp_f32 v82, v82
    v_exp_f32 v83, v83
    v_exp_f32 v84, v84
    v_exp_f32 v85, v85
    v_smfmac_f32_32x32x32_bf16 v[44:59], a[88:91], v[76:83], v9
    buffer_load_dwordx4 a[76:79], v0, s[8:11], s67 offen offset:3072 sc1
    v_bfe_u32 v8, v1, 3, 2
    v_lshlrev_b32 v32, 10, v7
    v_lshl_add_u32 v32, v8, 5, v32
    v_exp_f32 v86, v86
    v_exp_f32 v87, v87
    v_exp_f32 v88, v88
    v_exp_f32 v89, v89
    v_exp_f32 v90, v90
    v_exp_f32 v91, v91
    v_exp_f32 v92, v92
    v_exp_f32 v93, v93
    v_smfmac_f32_32x32x32_bf16 v[44:59], a[92:95], v[84:91], v9
    buffer_load_dwordx4 a[80:83], v252, s[8:11], s67 offen offset:0 sc1
    v_lshl_add_u32 v32, v34, 4, v32
    v_lshl_add_u32 v31, v34, 5, v7
    v_lshlrev_b32 v31, 4, v31
    v_exp_f32 v94, v94
    v_exp_f32 v95, v95
    v_exp_f32 v96, v96
    v_mfma_f32_32x32x16_bf16 v[76:91], a[24:27], v[24:27], 0
    v_and_b32 v7, 8, v1
    v_lshlrev_b32 v7, 4, v7
    v_xor_b32 v30, v7, v31
    v_exp_f32 v97, v97
    v_exp_f32 v98, v98
    v_exp_f32 v99, v99
    v_exp_f32 v100, v100
    v_exp_f32 v101, v101
    v_smfmac_f32_32x32x32_bf16 v[44:59], a[96:99], v[92:99], v9
    buffer_load_dwordx4 a[84:87], v252, s[8:11], s67 offen offset:1024 sc1
    v_lshl_add_u32 v30, v8, 11, v30
    v_add_u32 v30, 98304, v30
    v_lshl_add_u32 v31, v8, 10, v31
    v_exp_f32 v102, v102
    v_exp_f32 v103, v103
    v_exp_f32 v104, v104
    v_exp_f32 v105, v105
    v_exp_f32 v106, v106
    v_exp_f32 v107, v107
    v_exp_f32 v60, v60
    v_exp_f32 v61, v61
    v_smfmac_f32_32x32x32_bf16 v[44:59], a[100:103], v[100:107], v9
    buffer_load_dwordx4 a[88:91], v252, s[8:11], s67 offen offset:2048 sc1
    v_lshlrev_b32 v8, 30, v8
    v_or_b32 v33, v8, v33
    s_lshl_b32 s62, s55, 15
    v_exp_f32 v62, v62
    v_exp_f32 v63, v63
    v_exp_f32 v64, v64
    v_mfma_f32_32x32x16_bf16 v[92:107], a[28:31], v[24:27], 0
    s_lshl_b32 s22, s3, 13
    s_add_u32 s23, s62, s22
    s_add_u32 s63, s23, 8650752
    v_exp_f32 v65, v65
    v_exp_f32 v66, v66
    v_exp_f32 v67, v67
    v_exp_f32 v68, v68
    v_exp_f32 v69, v69
    v_smfmac_f32_32x32x32_bf16 v[44:59], a[104:107], v[60:67], v9
    buffer_load_dwordx4 a[92:95], v252, s[8:11], s67 offen offset:3072 sc1
    s_lshl_b32 s22, s54, 12
    s_add_u32 s70, s62, s22
    s_cmp_eq_u32 s6, 0
    s_cselect_b32 s22, 7, 12
    s_cselect_b32 s79, 0, 131072
    s_cselect_b64 vcc, -1, 0
    v_cndmask_b32 v35, v31, v32, vcc
    v_exp_f32 v70, v70
    v_exp_f32 v71, v71
    v_exp_f32 v72, v72
    v_exp_f32 v73, v73
    v_exp_f32 v74, v74
    v_exp_f32 v75, v75
    v_exp_f32 v76, v76
    v_exp_f32 v77, v77
    v_smfmac_f32_32x32x32_bf16 v[44:59], a[108:111], v[68:75], v9
    buffer_load_dwordx4 a[96:99], v253, s[8:11], s67 offen offset:0 sc1
    v_exp_f32 v78, v78
    v_exp_f32 v79, v79
    v_exp_f32 v80, v80
    v_mfma_f32_32x32x16_bf16 v[60:75], a[32:35], v[24:27], 0
    s_lshl_b32 s22, s54, s22
    s_add_u32 s64, s62, s22
    v_exp_f32 v81, v81
    v_exp_f32 v82, v82
    v_exp_f32 v83, v83
    v_exp_f32 v84, v84
    v_exp_f32 v85, v85
    v_smfmac_f32_32x32x32_bf16 v[44:59], a[112:115], v[76:83], v9
    buffer_load_dwordx4 a[100:103], v253, s[8:11], s67 offen offset:1024 sc1
    s_add_u32 s64, s64, s79
    s_add_u32 s65, s64, 131072
    s_add_u32 s62, s23, 8519680
    v_exp_f32 v86, v86
    v_exp_f32 v87, v87
    v_exp_f32 v88, v88
    v_exp_f32 v89, v89
    v_exp_f32 v90, v90
    v_exp_f32 v91, v91
    v_exp_f32 v92, v92
    v_exp_f32 v93, v93
    v_smfmac_f32_32x32x32_bf16 v[44:59], a[116:119], v[84:91], v9
    buffer_load_dwordx4 a[104:107], v253, s[8:11], s67 offen offset:2048 sc1
    v_exp_f32 v94, v94
    v_exp_f32 v95, v95
    v_exp_f32 v96, v96
    v_mfma_f32_32x32x16_bf16 v[76:91], a[36:39], v[24:27], 0
    v_exp_f32 v97, v97
    v_exp_f32 v98, v98
    v_exp_f32 v99, v99
    v_exp_f32 v100, v100
    v_exp_f32 v101, v101
    v_smfmac_f32_32x32x32_bf16 v[44:59], a[120:123], v[92:99], v9
    buffer_load_dwordx4 a[108:111], v253, s[8:11], s67 offen offset:3072 sc1
    v_exp_f32 v102, v102
    v_exp_f32 v103, v103
    v_exp_f32 v104, v104
    v_exp_f32 v105, v105
    v_exp_f32 v106, v106
    v_exp_f32 v107, v107
    v_exp_f32 v60, v60
    v_exp_f32 v61, v61
    v_smfmac_f32_32x32x32_bf16 v[44:59], a[124:127], v[100:107], v9
    buffer_load_dwordx4 a[0:3], v0, s[12:15], s62 offen offset:0 sc1
    v_exp_f32 v62, v62
    v_exp_f32 v63, v63
    v_exp_f32 v64, v64
    v_mfma_f32_32x32x16_bf16 v[92:107], a[40:43], v[24:27], 0
    v_exp_f32 v65, v65
    v_exp_f32 v66, v66
    v_exp_f32 v67, v67
    v_exp_f32 v68, v68
    v_exp_f32 v69, v69
    v_smfmac_f32_32x32x32_bf16 v[44:59], a[128:131], v[60:67], v9
    buffer_load_dwordx4 a[4:7], v0, s[12:15], s62 offen offset:1024 sc1
    v_exp_f32 v70, v70
    v_exp_f32 v71, v71
    v_exp_f32 v72, v72
    v_exp_f32 v73, v73
    v_exp_f32 v74, v74
    v_exp_f32 v75, v75
    v_exp_f32 v76, v76
    v_exp_f32 v77, v77
    v_smfmac_f32_32x32x32_bf16 v[44:59], a[132:135], v[68:75], v9
    buffer_load_dwordx4 a[8:11], v0, s[12:15], s62 offen offset:2048 sc1
    v_exp_f32 v78, v78
    v_exp_f32 v79, v79
    v_exp_f32 v80, v80
    v_mfma_f32_32x32x16_bf16 v[60:75], a[44:47], v[24:27], 0
    v_exp_f32 v81, v81
    v_exp_f32 v82, v82
    v_exp_f32 v83, v83
    v_exp_f32 v84, v84
    v_exp_f32 v85, v85
    v_smfmac_f32_32x32x32_bf16 v[44:59], a[136:139], v[76:83], v9
    buffer_load_dwordx4 a[12:15], v0, s[12:15], s62 offen offset:3072 sc1
    v_exp_f32 v86, v86
    v_exp_f32 v87, v87
    v_exp_f32 v88, v88
    v_exp_f32 v89, v89
    v_exp_f32 v90, v90
    v_exp_f32 v91, v91
    v_exp_f32 v92, v92
    v_exp_f32 v93, v93
    v_smfmac_f32_32x32x32_bf16 v[44:59], a[140:143], v[84:91], v9
    buffer_load_dwordx4 a[16:19], v252, s[12:15], s62 offen offset:0 sc1
    v_exp_f32 v94, v94
    v_exp_f32 v95, v95
    v_exp_f32 v96, v96
    v_mfma_f32_32x32x16_bf16 v[76:91], a[48:51], v[24:27], 0
    v_exp_f32 v97, v97
    v_exp_f32 v98, v98
    v_exp_f32 v99, v99
    v_exp_f32 v100, v100
    v_exp_f32 v101, v101
    v_smfmac_f32_32x32x32_bf16 v[44:59], a[144:147], v[92:99], v9
    buffer_load_dwordx4 a[20:23], v252, s[12:15], s62 offen offset:1024 sc1
    v_exp_f32 v102, v102
    v_exp_f32 v103, v103
    v_exp_f32 v104, v104
    v_exp_f32 v105, v105
    v_exp_f32 v106, v106
    v_exp_f32 v107, v107
    v_exp_f32 v60, v60
    v_exp_f32 v61, v61
    v_smfmac_f32_32x32x32_bf16 v[44:59], a[148:151], v[100:107], v9
    buffer_load_dwordx4 a[24:27], v252, s[12:15], s62 offen offset:2048 sc1
    v_exp_f32 v62, v62
    v_exp_f32 v63, v63
    v_exp_f32 v64, v64
    v_mfma_f32_32x32x16_bf16 v[92:107], a[52:55], v[24:27], 0
    v_exp_f32 v65, v65
    v_exp_f32 v66, v66
    v_exp_f32 v67, v67
    v_exp_f32 v68, v68
    v_exp_f32 v69, v69
    v_smfmac_f32_32x32x32_bf16 v[44:59], a[152:155], v[60:67], v9
    buffer_load_dwordx4 a[28:31], v252, s[12:15], s62 offen offset:3072 sc1
    v_exp_f32 v70, v70
    v_exp_f32 v71, v71
    v_exp_f32 v72, v72
    v_exp_f32 v73, v73
    v_exp_f32 v74, v74
    v_exp_f32 v75, v75
    v_exp_f32 v76, v76
    v_exp_f32 v77, v77
    v_smfmac_f32_32x32x32_bf16 v[44:59], a[156:159], v[68:75], v9
    buffer_load_dwordx4 v[20:23], v35, s[16:19], s64 offen offset:0 sc1
    v_exp_f32 v78, v78
    v_exp_f32 v79, v79
    v_exp_f32 v80, v80
    v_mfma_f32_32x32x16_bf16 v[60:75], a[56:59], v[24:27], 0
    v_exp_f32 v81, v81
    v_exp_f32 v82, v82
    v_exp_f32 v83, v83
    v_exp_f32 v84, v84
    v_exp_f32 v85, v85
    v_smfmac_f32_32x32x32_bf16 v[44:59], a[160:163], v[76:83], v9
    buffer_load_dwordx4 a[112:115], v254, s[8:11], s67 offen offset:0 sc1
    v_exp_f32 v86, v86
    v_exp_f32 v87, v87
    v_exp_f32 v88, v88
    v_exp_f32 v89, v89
    v_exp_f32 v90, v90
    v_exp_f32 v91, v91
    v_exp_f32 v92, v92
    v_exp_f32 v93, v93
    v_smfmac_f32_32x32x32_bf16 v[44:59], a[164:167], v[84:91], v9
    buffer_load_dwordx4 a[116:119], v254, s[8:11], s67 offen offset:1024 sc1
    v_exp_f32 v94, v94
    v_exp_f32 v95, v95
    v_exp_f32 v96, v96
    v_mfma_f32_32x32x16_bf16 v[76:91], a[60:63], v[24:27], 0
    v_exp_f32 v97, v97
    v_exp_f32 v98, v98
    v_exp_f32 v99, v99
    v_exp_f32 v100, v100
    v_exp_f32 v101, v101
    v_smfmac_f32_32x32x32_bf16 v[44:59], a[168:171], v[92:99], v9
    buffer_load_dwordx4 a[120:123], v254, s[8:11], s67 offen offset:2048 sc1
    v_exp_f32 v102, v102
    v_exp_f32 v103, v103
    v_exp_f32 v104, v104
    v_exp_f32 v105, v105
    v_exp_f32 v106, v106
    v_exp_f32 v107, v107
    v_exp_f32 v60, v60
    v_exp_f32 v61, v61
    v_smfmac_f32_32x32x32_bf16 v[44:59], a[172:175], v[100:107], v9
    buffer_load_dwordx4 a[124:127], v254, s[8:11], s67 offen offset:3072 sc1
    v_exp_f32 v62, v62
    v_exp_f32 v63, v63
    v_exp_f32 v64, v64
    v_exp_f32 v65, v65
    v_exp_f32 v66, v66
    v_exp_f32 v67, v67
    v_exp_f32 v68, v68
    v_exp_f32 v69, v69
    v_smfmac_f32_32x32x32_bf16 v[44:59], a[176:179], v[60:67], v9
    buffer_load_dwordx4 a[128:131], v0, s[8:11], s68 offen offset:0 sc1
    v_exp_f32 v70, v70
    v_exp_f32 v71, v71
    v_exp_f32 v72, v72
    v_exp_f32 v73, v73
    v_exp_f32 v74, v74
    v_exp_f32 v75, v75
    v_exp_f32 v76, v76
    v_exp_f32 v77, v77
    v_smfmac_f32_32x32x32_bf16 v[44:59], a[180:183], v[68:75], v9
    buffer_load_dwordx4 a[132:135], v0, s[8:11], s68 offen offset:1024 sc1
    v_exp_f32 v78, v78
    v_exp_f32 v79, v79
    v_exp_f32 v80, v80
    v_exp_f32 v81, v81
    v_exp_f32 v82, v82
    v_exp_f32 v83, v83
    v_exp_f32 v84, v84
    v_exp_f32 v85, v85
    v_smfmac_f32_32x32x32_bf16 v[44:59], a[184:187], v[76:83], v9
    buffer_load_dwordx4 a[136:139], v0, s[8:11], s68 offen offset:2048 sc1
    v_exp_f32 v86, v86
    v_exp_f32 v87, v87
    v_exp_f32 v88, v88
    v_exp_f32 v89, v89
    v_exp_f32 v90, v90
    v_exp_f32 v91, v91
    s_nop 1
    v_smfmac_f32_32x32x32_bf16 v[44:59], a[188:191], v[84:91], v9
    v_and_b32 v16, 0x1f0, v0
    v_add_u32 v16, 131072, v16
    s_lshl_b32 s22, s3, 10
    v_add_u32 v13, s22, v16
    s_lshl_b32 s22, s3, 13
    s_add_u32 s22, s22, 98304
    v_add_u32 v17, s22, v0
    buffer_load_dwordx4 a[32:35], v253, s[8:11], s66 offen offset:0 sc1
    buffer_load_dwordx4 a[36:39], v253, s[8:11], s66 offen offset:1024 sc1
    s_nop 2
    ds_write_b128 v10, v[44:47] offset:24576
    ds_write_b128 v10, v[48:51] offset:25600
    ds_write_b32 v11, v52 offset:3072
    buffer_load_dwordx4 a[40:43], v253, s[8:11], s66 offen offset:2048 sc1
    buffer_load_dwordx4 a[44:47], v253, s[8:11], s66 offen offset:3072 sc1
    s_waitcnt lgkmcnt(0)
    s_barrier
    ds_read_b128 v[36:39], v16 offset:0
    ds_read_b128 v[40:43], v16 offset:1024
    ds_read_b128 v[44:47], v16 offset:2048
    ds_read_b128 v[48:51], v16 offset:3072
    ds_read_b128 v[52:55], v13
    ds_read_b128 v[88:91], v17 offset:0
    ds_read_b128 v[92:95], v17 offset:1024
    ds_read_b128 v[96:99], v17 offset:2048
    ds_read_b128 v[100:103], v17 offset:3072
    ds_read_b128 v[104:107], v17 offset:4096
    ds_read_b128 v[108:111], v17 offset:5120
    ds_read_b128 v[112:115], v17 offset:6144
    ds_read_b128 v[116:119], v17 offset:7168
    buffer_load_dwordx4 a[140:143], v0, s[8:11], s68 offen offset:3072 sc1
    s_waitcnt lgkmcnt(8)
    v_add_f32 v52, v52, v53
    v_add_f32 v54, v54, v55
    v_add_f32 v52, v52, v54
    v_add_f32 v36, v36, v37
    v_add_f32 v38, v38, v39
    buffer_load_dwordx4 a[144:147], v252, s[8:11], s68 offen offset:0 sc1
    v_add_f32 v36, v36, v38
    v_add_f32 v40, v40, v41
    v_add_f32 v42, v42, v43
    v_add_f32 v40, v40, v42
    v_add_f32 v44, v44, v45
    v_add_f32 v46, v46, v47
    buffer_load_dwordx4 a[148:151], v252, s[8:11], s68 offen offset:1024 sc1
    v_add_f32 v44, v44, v46
    v_add_f32 v48, v48, v49
    v_add_f32 v50, v50, v51
    v_add_f32 v48, v48, v50
    v_rcp_f32 v12, v52
    v_min3_f32 v37, v36, v40, v44
    v_add_f32 v36, v36, v40
    v_min_f32 v37, v37, v48
    v_add_f32 v44, v44, v48
    v_cmp_le_f32 s[72:73], s94, v37
    v_add_f32 v36, v36, v44
    v_cmp_ge_f32 vcc, s95, v36
    s_mov_b32 s79, 1
    s_and_b64 s[22:23], s[72:73], vcc
    s_cmp_eq_u64 s[22:23], -1
    s_cbranch_scc0 att_slow
att_ret1:
    buffer_load_dwordx4 a[152:155], v252, s[8:11], s68 offen offset:2048 sc1
    s_waitcnt lgkmcnt(0)
    v_add_f32 v88, v88, v96
    v_add_f32 v89, v89, v97
    v_add_f32 v90, v90, v98
    v_add_f32 v91, v91, v99
    v_add_f32 v92, v92, v100
    v_add_f32 v93, v93, v101
    v_add_f32 v94, v94, v102
    v_add_f32 v95, v95, v103
    v_add_f32 v104, v104, v112
    v_add_f32 v105, v105, v113
    v_add_f32 v106, v106, v114
    v_add_f32 v107, v107, v115
    buffer_load_dwordx4 a[156:159], v252, s[8:11], s68 offen offset:3072 sc1
    v_add_f32 v108, v108, v116
    v_add_f32 v109, v109, v117
    v_add_f32 v110, v110, v118
    v_add_f32 v111, v111, v119
    v_add_f32 v88, v88, v104
    v_add_f32 v89, v89, v105
    v_add_f32 v90, v90, v106
    v_add_f32 v91, v91, v107
    v_add_f32 v92, v92, v108
    v_add_f32 v93, v93, v109
    v_add_f32 v94, v94, v110
    v_add_f32 v95, v95, v111
    buffer_load_dwordx4 a[160:163], v253, s[8:11], s68 offen offset:0 sc1
    v_mul_f32 v88, v88, v12
    v_mul_f32 v89, v89, v12
    v_mul_f32 v90, v90, v12
    v_mul_f32 v91, v91, v12
    v_mul_f32 v92, v92, v12
    v_mul_f32 v93, v93, v12
    v_mul_f32 v94, v94, v12
    v_mul_f32 v95, v95, v12
    v_cvt_pk_bf16_f32 v88, v88, v89
    v_cvt_pk_bf16_f32 v89, v90, v91
    v_cvt_pk_bf16_f32 v90, v92, v93
    v_cvt_pk_bf16_f32 v91, v94, v95
    buffer_store_dwordx4 v[88:91], v0, s[12:15], s89 offen offset:0 sc1
    s_waitcnt vmcnt(26)
    v_mfma_f32_32x32x16_bf16 v[56:71], a[192:195], a[0:3], 0
    buffer_load_dwordx4 a[164:167], v253, s[8:11], s68 offen offset:1024 sc1
    s_waitcnt vmcnt(19)
    v_mfma_f32_32x32x16_bf16 v[56:71], a[200:203], a[4:7], v[56:71]
    s_cmp_lg_u32 s6, 0
    s_cbranch_scc1 wo_s0
    v_permlane32_swap_b32 v20, v22
    v_permlane32_swap_b32 v21, v23
wo_s0:
    v_mfma_f32_32x32x16_bf16 v[56:71], a[208:211], a[8:11], v[56:71]
    buffer_load_dwordx4 a[168:171], v253, s[8:11], s68 offen offset:2048 sc1
    v_mfma_f32_32x32x16_bf16 v[56:71], a[216:219], a[12:15], v[56:71]
    v_mfma_f32_32x32x16_bf16 v[56:71], a[224:227], a[16:19], v[56:71]
    buffer_load_dwordx4 a[172:175], v253, s[8:11], s68 offen offset:3072 sc1
    v_mfma_f32_32x32x16_bf16 v[56:71], a[232:235], a[20:23], v[56:71]
    v_lshlrev_b32 v36, 16, v20
    v_and_b32 v37, 0xffff0000, v20
    v_mfma_f32_32x32x16_bf16 v[56:71], a[240:243], a[24:27], v[56:71]
    buffer_load_dwordx4 a[176:179], v254, s[8:11], s68 offen offset:0 sc1
    v_lshlrev_b32 v38, 16, v21
    v_mfma_f32_32x32x16_bf16 v[56:71], a[248:251], a[28:31], v[56:71]
    v_and_b32 v39, 0xffff0000, v21
    v_lshlrev_b32 v40, 16, v22
    v_mfma_f32_32x32x16_bf16 v[72:87], a[196:199], a[0:3], 0
    buffer_load_dwordx4 a[180:183], v254, s[8:11], s68 offen offset:1024 sc1
    v_and_b32 v41, 0xffff0000, v22
    v_lshlrev_b32 v42, 16, v23
    v_mfma_f32_32x32x16_bf16 v[72:87], a[204:207], a[4:7], v[72:87]
    v_and_b32 v43, 0xffff0000, v23
    v_mfma_f32_32x32x16_bf16 v[72:87], a[212:215], a[8:11], v[72:87]
    buffer_load_dwordx4 a[184:187], v254, s[8:11], s68 offen offset:2048 sc1
    s_add_u32 s70, s70, 10616832
    s_add_u32 s71, s70, 131072
    v_mfma_f32_32x32x16_bf16 v[72:87], a[220:223], a[12:15], v[72:87]
    ds_write_b128 v28, v[56:59] offset:0
    s_lshl_b32 s72, s55, 8
    v_mfma_f32_32x32x16_bf16 v[72:87], a[228:231], a[16:19], v[72:87]
    buffer_load_dwordx4 a[188:191], v254, s[8:11], s68 offen offset:3072 sc1
    s_add_u32 s72, s72, 114688
    s_add_u32 s32, s32, 4096
    v_mfma_f32_32x32x16_bf16 v[72:87], a[236:239], a[20:23], v[72:87]
    ds_write_b128 v28, v[60:63] offset:1024
    v_mov_b32 v52, 0x3f803f80
    v_mfma_f32_32x32x16_bf16 v[72:87], a[244:247], a[24:27], v[72:87]
    buffer_load_dwordx4 a[48:51], v254, s[8:11], s66 offen offset:0 sc1
    ds_write_b128 v29, v[64:67] offset:2048
    v_mov_b32 v53, 0x3f803f80
    v_mfma_f32_32x32x16_bf16 v[72:87], a[252:255], a[28:31], v[72:87]
    ds_write_b128 v29, v[68:71] offset:3072
    v_mov_b32 v54, 0x3f803f80
    v_mov_b32 v55, 0x3f803f80
    s_nop 8
    ds_write_b128 v28, v[72:75] offset:4096
    ds_write_b128 v28, v[76:79] offset:5120
    ds_write_b128 v29, v[80:83] offset:6144
    ds_write_b128 v29, v[84:87] offset:7168
    s_waitcnt vmcnt(8)
    s_waitcnt lgkmcnt(0)
    s_barrier
    s_cmp_lg_u32 s3, 0
    s_cbranch_scc1 sg7
    s_atomic_add s7, s[8:9], s59
    s_add_u32 s51, s59, 128
    s_atomic_add s7, s[8:9], s51
    s_add_u32 s51, s59, 256
    s_atomic_add s7, s[8:9], s51
    s_add_u32 s51, s59, 384
    s_atomic_add s7, s[8:9], s51
sg7:
    ds_read_b128 v[56:59], v30 offset:0
    ds_read_b128 v[60:63], v30 offset:1024
    ds_read_b128 v[64:67], v30 offset:8192
    ds_read_b128 v[68:71], v30 offset:9216
    ds_read_b128 v[72:75], v30 offset:16384
    ds_read_b128 v[76:79], v30 offset:17408
    ds_read_b128 v[80:83], v30 offset:24576
    ds_read_b128 v[84:87], v30 offset:25600
    s_lshl_b32 s59, s4, 1
    s_add_u32 s59, s59, s56
    s_lshl_b32 s59, s59, 9
    s_add_u32 s59, s59, s47
    s_add_u32 s59, s59, 16384
    buffer_load_dwordx4 a[52:55], v254, s[8:11], s66 offen offset:1024 sc1
    s_waitcnt lgkmcnt(6)
    v_add_f32 v36, v36, v56
    v_add_f32 v37, v37, v57
    v_add_f32 v38, v38, v58
    v_add_f32 v39, v39, v59
    v_add_f32 v40, v40, v60
    v_add_f32 v41, v41, v61
    v_add_f32 v42, v42, v62
    v_add_f32 v43, v43, v63
    s_waitcnt lgkmcnt(4)
    v_add_f32 v36, v36, v64
    v_add_f32 v37, v37, v65
    v_add_f32 v38, v38, v66
    v_add_f32 v39, v39, v67
    v_add_f32 v40, v40, v68
    v_add_f32 v41, v41, v69
    v_add_f32 v42, v42, v70
    v_add_f32 v43, v43, v71
    ds_read_b32 v8, v0
    ds_read_b32 v8, v0
    s_waitcnt lgkmcnt(4)
    v_add_f32 v36, v36, v72
    v_add_f32 v37, v37, v73
    v_add_f32 v38, v38, v74
    v_add_f32 v39, v39, v75
    v_add_f32 v40, v40, v76
    v_add_f32 v41, v41, v77
    v_add_f32 v42, v42, v78
    v_add_f32 v43, v43, v79
    ds_read_b32 v8, v0
    ds_read_b32 v8, v0
    s_waitcnt lgkmcnt(4)
    v_add_f32 v36, v36, v80
    v_add_f32 v37, v37, v81
    v_add_f32 v38, v38, v82
    v_add_f32 v39, v39, v83
    buffer_load_dwordx4 a[56:59], v254, s[8:11], s66 offen offset:2048 sc1
    v_add_f32 v40, v40, v84
    v_add_f32 v41, v41, v85
    v_add_f32 v42, v42, v86
    v_add_f32 v43, v43, v87
    v_cvt_pk_bf16_f32 v20, v36, v37
    v_cvt_pk_bf16_f32 v21, v38, v39
    v_cvt_pk_bf16_f32 v22, v40, v41
    v_cvt_pk_bf16_f32 v23, v42, v43
    v_mul_f32 v44, v36, v36
    v_fmac_f32 v44, v37, v37
    v_fmac_f32 v44, v38, v38
    v_fmac_f32 v44, v39, v39
    v_fmac_f32 v44, v40, v40
    v_fmac_f32 v44, v41, v41
    v_fmac_f32 v44, v42, v42
    v_fmac_f32 v44, v43, v43
    v_add_f32 v36, v36, v40
    v_add_f32 v37, v37, v41
    v_add_f32 v38, v38, v42
    v_add_f32 v39, v39, v43
    v_add_f32 v36, v36, v38
    v_add_f32 v37, v37, v39
    v_add_f32 v36, v36, v37
    s_nop 1
    v_permlane32_swap_b32 v36, v44
    v_add_f32 v36, v36, v44
    v_mov_b32 v37, v36
    s_nop 1
    v_permlane16_swap_b32 v36, v37
    v_add_f32 v36, v36, v37
    s_nop 1
    v_add_f32_dpp v36, v36, v36 row_ror:8 row_mask:0xf bank_mask:0xf
    buffer_store_dwordx4 v[20:23], v31, s[12:15], s70 offen offset:0 sc1
    buffer_atomic_add_f32 v36, v33, s[12:15], s72 offen offset:0
    buffer_load_dwordx4 a[60:63], v254, s[8:11], s66 offen offset:3072 sc1
    buffer_load_dwordx4 a[0:3], v0, s[8:11], s66 offen offset:0 sc1
    v_mfma_f32_32x32x16_bf16 v[36:51], v[52:55], v[120:123], 0
    v_mfma_f32_32x32x16_bf16 v[36:51], v[52:55], v[124:127], v[36:51]
    s_cmp_lg_u32 s3, 1
    s_cbranch_scc1 pl8
    s_mov_b32 s36, 0
    s_atomic_add s36, s[8:9], s32 glc
pl8:
    v_mfma_f32_32x32x16_bf16 v[36:51], v[52:55], v[128:131], v[36:51]
    v_mfma_f32_32x32x16_bf16 v[36:51], v[52:55], v[132:135], v[36:51]
    v_mfma_f32_32x32x16_bf16 v[36:51], v[52:55], v[136:139], v[36:51]
    v_mfma_f32_32x32x16_bf16 v[36:51], v[52:55], v[140:143], v[36:51]
    v_mfma_f32_32x32x16_bf16 v[36:51], v[52:55], v[144:147], v[36:51]
    v_mfma_f32_32x32x16_bf16 v[36:51], v[52:55], v[148:151], v[36:51]
    v_mfma_f32_32x32x16_bf16 v[36:51], v[52:55], v[152:155], v[36:51]
    v_mfma_f32_32x32x16_bf16 v[36:51], v[52:55], v[156:159], v[36:51]
    v_mfma_f32_32x32x16_bf16 v[36:51], v[52:55], v[160:163], v[36:51]
    v_mfma_f32_32x32x16_bf16 v[36:51], v[52:55], v[164:167], v[36:51]
    v_mfma_f32_32x32x16_bf16 v[36:51], v[52:55], v[168:171], v[36:51]
    v_mfma_f32_32x32x16_bf16 v[36:51], v[52:55], v[172:175], v[36:51]
    v_mfma_f32_32x32x16_bf16 v[36:51], v[52:55], v[176:179], v[36:51]
    s_cmp_lg_u32 s3, 1
    s_cbranch_scc1 pl9
    s_mov_b32 s46, 0
    s_atomic_add s46, s[8:9], s32 glc
pl9:
    v_mfma_f32_32x32x16_bf16 v[36:51], v[52:55], v[180:183], v[36:51]
    v_mfma_f32_32x32x16_bf16 v[36:51], v[52:55], v[184:187], v[36:51]
    v_mfma_f32_32x32x16_bf16 v[36:51], v[52:55], v[188:191], v[36:51]
    v_mfma_f32_32x32x16_bf16 v[36:51], v[52:55], v[192:195], v[36:51]
    v_mfma_f32_32x32x16_bf16 v[36:51], v[52:55], v[196:199], v[36:51]
    v_mfma_f32_32x32x16_bf16 v[36:51], v[52:55], v[200:203], v[36:51]
    v_mfma_f32_32x32x16_bf16 v[36:51], v[52:55], v[204:207], v[36:51]
    v_mfma_f32_32x32x16_bf16 v[36:51], v[52:55], v[208:211], v[36:51]
    v_mfma_f32_32x32x16_bf16 v[36:51], v[52:55], v[212:215], v[36:51]
    v_mfma_f32_32x32x16_bf16 v[36:51], v[52:55], v[216:219], v[36:51]
    v_mfma_f32_32x32x16_bf16 v[36:51], v[52:55], v[220:223], v[36:51]
    s_waitcnt vmcnt(2)
    ds_read_b32 v8, v0
    s_waitcnt lgkmcnt(1)
    s_waitcnt lgkmcnt(1)
    s_mov_b32 s33, s36
    s_mov_b32 s51, s46
    s_max_u32 s33, s33, s51
    s_cmp_lt_u32 s33, s45
    s_cbranch_scc1 to_sp
to_go:
    s_barrier
    s_cmp_lg_u32 s3, 0
    s_cbranch_scc1 sg10
    s_atomic_add s7, s[8:9], s59
sg10:
    buffer_load_dwordx4 v[88:91], v0, s[12:15], s63 offen offset:0 sc1
    buffer_load_dwordx4 v[92:95], v0, s[12:15], s63 offen offset:1024 sc1
    buffer_load_dwordx4 v[96:99], v0, s[12:15], s63 offen offset:2048 sc1
    buffer_load_dwordx4 v[100:103], v0, s[12:15], s63 offen offset:3072 sc1
    buffer_load_dwordx4 v[104:107], v252, s[12:15], s63 offen offset:0 sc1
    buffer_load_dwordx4 v[108:111], v252, s[12:15], s63 offen offset:1024 sc1
    buffer_load_dwordx4 v[112:115], v252, s[12:15], s63 offen offset:2048 sc1
    buffer_load_dwordx4 v[116:119], v252, s[12:15], s63 offen offset:3072 sc1
    buffer_load_dwordx4 v[24:27], v35, s[16:19], s65 offen offset:0 sc1
    v_mfma_f32_32x32x16_bf16 v[36:51], v[52:55], v[224:227], v[36:51]
    v_mfma_f32_32x32x16_bf16 v[36:51], v[52:55], v[228:231], v[36:51]
    v_mfma_f32_32x32x16_bf16 v[36:51], v[52:55], v[232:235], v[36:51]
    v_mfma_f32_32x32x16_bf16 v[36:51], v[52:55], v[236:239], v[36:51]
    v_mfma_f32_32x32x16_bf16 v[36:51], v[52:55], v[240:243], v[36:51]
    v_mfma_f32_32x32x16_bf16 v[36:51], v[52:55], v[244:247], v[36:51]
    s_waitcnt vmcnt(8)
    v_mfma_f32_32x32x16_bf16 v[56:71], a[192:195], v[88:91], 0
    s_lshl_b32 s32, s4, 1
    s_add_u32 s32, s32, s57
    s_lshl_b32 s32, s32, 9
    s_add_u32 s32, s32, s47
    s_add_u32 s32, s32, 16384
    s_lshl_b32 s79, s4, 3
    s_waitcnt vmcnt(7)
    v_mfma_f32_32x32x16_bf16 v[56:71], a[200:203], v[92:95], v[56:71]
    s_lshl_b32 s22, s57, 1
    s_add_u32 s79, s79, s22
    s_lshl_b32 s22, s3, 10
    s_add_u32 s75, s22, 98304
    s_lshl_b32 s74, s79, 15
    s_add_u32 s74, s74, s22
    s_waitcnt vmcnt(6)
    v_mfma_f32_32x32x16_bf16 v[56:71], a[208:211], v[96:99], v[56:71]
    s_cmp_lg_u32 s3, 1
    s_cbranch_scc1 pl11
    s_mov_b32 s38, 0
    s_atomic_add s38, s[8:9], s32 glc
pl11:
    s_add_u32 s74, s74, 10616832
    s_add_u32 s74, s74, s47
    s_waitcnt vmcnt(5)
    v_mfma_f32_32x32x16_bf16 v[56:71], a[216:219], v[100:103], v[56:71]
    s_lshl_b32 s76, s79, 8
    s_add_u32 s76, s76, 114688
    s_mul_i32 s77, s79, 114688
    s_lshr_b32 s22, s5, 1
    s_lshl_b32 s22, s22, 2
    s_add_u32 s22, s22, s3
    s_waitcnt vmcnt(4)
    v_mfma_f32_32x32x16_bf16 v[56:71], a[224:227], v[104:107], v[56:71]
    s_lshl_b32 s22, s22, 11
    s_add_u32 s77, s77, s22
    s_add_u32 s77, s77, 12713984
    s_cmp_lt_u32 s5, 28
    s_cselect_b32 s22, 0, 4026531840
    s_waitcnt vmcnt(3)
    v_mfma_f32_32x32x16_bf16 v[56:71], a[232:235], v[108:111], v[56:71]
    v_or_b32 v19, s22, v0
    s_or_b32 s78, s22, s3
    v_add_u32 v17, 98304, v0
    s_waitcnt vmcnt(2)
    v_mfma_f32_32x32x16_bf16 v[56:71], a[240:243], v[112:115], v[56:71]
    v_lshlrev_b32 v18, 2, v1
    v_mov_b32 v250, 0
    v_mov_b32 v251, 0
    s_waitcnt vmcnt(1)
    v_mfma_f32_32x32x16_bf16 v[56:71], a[248:251], v[116:119], v[56:71]
    v_cvt_pk_bf16_f32 v249, v36, v250
    v_lshlrev_b32 v7, 16, v249
    v_sub_f32 v7, v36, v7
    v_cvt_pk_bf16_f32 v248, v36, v7
    v_mfma_f32_32x32x16_bf16 v[72:87], a[196:199], v[88:91], 0
    v_cndmask_b32 v248, 0, v248, s[34:35]
    v_cndmask_b32 v249, 0, v249, s[34:35]
    s_waitcnt vmcnt(0)
    v_mfma_f32_32x32x16_bf16 v[72:87], a[204:207], v[92:95], v[72:87]
    s_cmp_lg_u32 s6, 0
    s_cbranch_scc1 wo_s1
    v_permlane32_swap_b32 v24, v26
    v_permlane32_swap_b32 v25, v27
wo_s1:
    v_mfma_f32_32x32x16_bf16 v[72:87], a[212:215], v[96:99], v[72:87]
    v_lshlrev_b32 v36, 16, v24
    v_mfma_f32_32x32x16_bf16 v[72:87], a[220:223], v[100:103], v[72:87]
    v_and_b32 v37, 0xffff0000, v24
    v_lshlrev_b32 v38, 16, v25
    v_and_b32 v39, 0xffff0000, v25
    v_lshlrev_b32 v40, 16, v26
    v_mfma_f32_32x32x16_bf16 v[72:87], a[228:231], v[104:107], v[72:87]
    ds_write_b128 v28, v[56:59] offset:32768
    v_and_b32 v41, 0xffff0000, v26
    v_lshlrev_b32 v42, 16, v27
    v_mfma_f32_32x32x16_bf16 v[72:87], a[236:239], v[108:111], v[72:87]
    ds_write_b128 v28, v[60:63] offset:33792
    v_and_b32 v43, 0xffff0000, v27
    v_mfma_f32_32x32x16_bf16 v[72:87], a[244:247], v[112:115], v[72:87]
    ds_write_b128 v29, v[64:67] offset:34816
    v_mfma_f32_32x32x16_bf16 v[72:87], a[252:255], v[116:119], v[72:87]
    ds_write_b128 v29, v[68:71] offset:35840
    s_nop 10
    ds_write_b128 v28, v[72:75] offset:36864
    ds_write_b128 v28, v[76:79] offset:37888
    ds_write_b128 v29, v[80:83] offset:38912
    ds_write_b128 v29, v[84:87] offset:39936
    s_waitcnt lgkmcnt(0)
    s_mov_b32 s36, s38
    s_waitcnt lgkmcnt(0)
    s_cmp_lt_u32 s36, s44
    s_cbranch_scc1 t1_sp
t1_go:
    s_barrier
    s_add_u32 m0, s75, 0
    s_nop 0
    buffer_load_dwordx4 v0, s[28:31], s74 offen offset:0 sc1 lds
    ds_read_b128 v[56:59], v30 offset:32768
    ds_read_b128 v[60:63], v30 offset:33792
    ds_read_b128 v[64:67], v30 offset:40960
    ds_read_b128 v[68:71], v30 offset:41984
    ds_read_b128 v[72:75], v30 offset:49152
    ds_read_b128 v[76:79], v30 offset:50176
    ds_read_b128 v[80:83], v30 offset:57344
    ds_read_b128 v[84:87], v30 offset:58368
    s_waitcnt lgkmcnt(6)
    s_add_u32 m0, s75, 4096
    s_nop 0
    buffer_load_dwordx4 v252, s[28:31], s74 offen offset:0 sc1 lds
    v_add_f32 v36, v36, v56
    v_add_f32 v37, v37, v57
    v_add_f32 v38, v38, v58
    v_add_f32 v39, v39, v59
    v_add_f32 v40, v40, v60
    v_add_f32 v41, v41, v61
    v_add_f32 v42, v42, v62
    v_add_f32 v43, v43, v63
    s_add_u32 m0, s75, 8192
    s_nop 0
    buffer_load_dwordx4 v253, s[28:31], s74 offen offset:0 sc1 lds
    s_waitcnt lgkmcnt(4)
    v_add_f32 v36, v36, v64
    v_add_f32 v37, v37, v65
    v_add_f32 v38, v38, v66
    v_add_f32 v39, v39, v67
    v_add_f32 v40, v40, v68
    v_add_f32 v41, v41, v69
    v_add_f32 v42, v42, v70
    s_add_u32 m0, s75, 12288
    s_nop 0
    buffer_load_dwordx4 v254, s[28:31], s74 offen offset:0 sc1 lds
    v_add_f32 v43, v43, v71
    s_waitcnt lgkmcnt(2)
    v_add_f32 v36, v36, v72
    v_add_f32 v37, v37, v73
    v_add_f32 v38, v38, v74
    v_add_f32 v39, v39, v75
    v_add_f32 v40, v40, v76
    v_add_f32 v41, v41, v77
    s_add_u32 m0, s75, 16384
    s_add_u32 s74, s74, 16384
    buffer_load_dwordx4 v0, s[28:31], s74 offen offset:0 sc1 lds
    v_add_f32 v42, v42, v78
    v_add_f32 v43, v43, v79
    s_waitcnt lgkmcnt(0)
    v_add_f32 v36, v36, v80
    v_add_f32 v37, v37, v81
    v_add_f32 v38, v38, v82
    v_add_f32 v39, v39, v83
    v_add_f32 v40, v40, v84
    s_add_u32 m0, s75, 20480
    s_nop 0
    buffer_load_dwordx4 v252, s[28:31], s74 offen offset:0 sc1 lds
    v_add_f32 v41, v41, v85
    v_add_f32 v42, v42, v86
    v_add_f32 v43, v43, v87
    v_cvt_pk_bf16_f32 v24, v36, v37
    v_cvt_pk_bf16_f32 v25, v38, v39
    v_cvt_pk_bf16_f32 v26, v40, v41
    v_cvt_pk_bf16_f32 v27, v42, v43
    v_mul_f32 v44, v36, v36
    v_fmac_f32 v44, v37, v37
    s_add_u32 m0, s75, 24576
    s_nop 0
    buffer_load_dwordx4 v253, s[28:31], s74 offen offset:0 sc1 lds
    v_fmac_f32 v44, v38, v38
    v_fmac_f32 v44, v39, v39
    v_fmac_f32 v44, v40, v40
    v_fmac_f32 v44, v41, v41
    v_fmac_f32 v44, v42, v42
    v_fmac_f32 v44, v43, v43
    v_add_f32 v36, v36, v40
    v_add_f32 v37, v37, v41
    s_add_u32 m0, s75, 28672
    s_nop 0
    buffer_load_dwordx4 v254, s[28:31], s74 offen offset:0 sc1 lds
    s_add_u32 s74, s74, 16384
    v_add_f32 v38, v38, v42
    v_add_f32 v39, v39, v43
    v_add_f32 v36, v36, v38
    v_add_f32 v37, v37, v39
    v_add_f32 v36, v36, v37
    s_nop 1
    v_permlane32_swap_b32 v36, v44
    v_add_f32 v36, v36, v44
    v_mov_b32 v37, v36
    s_nop 1
    v_permlane16_swap_b32 v36, v37
    buffer_load_dword v9, v18, s[12:15], s76 offen offset:0 sc1
    v_add_f32 v36, v36, v37
    s_nop 1
    v_add_f32_dpp v36, v36, v36 row_ror:8 row_mask:0xf bank_mask:0xf
    buffer_store_dwordx4 v[24:27], v31, s[12:15], s71 offen offset:0 sc1
    buffer_atomic_add_f32 v36, v33, s[12:15], s72 offen offset:1024
    s_waitcnt vmcnt(7)
    s_waitcnt lgkmcnt(0)
    s_barrier
    ds_read_b128 v[88:91], v17 offset:0
    ds_read_b128 v[92:95], v17 offset:1024
    ds_read_b128 v[96:99], v17 offset:2048
    ds_read_b128 v[100:103], v17 offset:3072
    ds_read_b128 v[104:107], v17 offset:4096
    ds_read_b128 v[108:111], v17 offset:5120
    s_waitcnt lgkmcnt(4)
    v_mfma_f32_32x32x16_bf16 v[56:71], v[120:123], v[88:91], 0
    ds_read_b128 v[112:115], v17 offset:6144
    s_add_u32 m0, s75, 32768
    s_nop 0
    buffer_load_dwordx4 v0, s[28:31], s74 offen offset:0 sc1 lds
    v_mfma_f32_32x32x16_bf16 v[56:71], v[124:127], v[92:95], v[56:71]
    ds_read_b128 v[116:119], v17 offset:7168
    s_add_u32 m0, s75, 36864
    s_nop 0
    buffer_load_dwordx4 v252, s[28:31], s74 offen offset:0 sc1 lds
    s_waitcnt lgkmcnt(4)
    v_mfma_f32_32x32x16_bf16 v[56:71], v[128:131], v[96:99], v[56:71]
    ds_read_b128 v[88:91], v17 offset:8192
    s_waitcnt vmcnt(4)
    v_mov_b32 v10, v9
    v_mfma_f32_32x32x16_bf16 v[56:71], v[132:135], v[100:103], v[56:71]
    ds_read_b128 v[92:95], v17 offset:9216
    s_add_u32 m0, s75, 40960
    s_nop 0
    buffer_load_dwordx4 v253, s[28:31], s74 offen offset:0 sc1 lds
    s_waitcnt lgkmcnt(4)
    v_mfma_f32_32x32x16_bf16 v[56:71], v[136:139], v[104:107], v[56:71]
    ds_read_b128 v[96:99], v17 offset:10240
    v_permlane32_swap_b32 v9, v10
    v_mul_f32 v9, 0.001953125, v9
    v_mfma_f32_32x32x16_bf16 v[56:71], v[140:143], v[108:111], v[56:71]
    ds_read_b128 v[100:103], v17 offset:11264
    s_add_u32 m0, s75, 45056
    s_nop 0
    buffer_load_dwordx4 v254, s[28:31], s74 offen offset:0 sc1 lds
    v_mul_f32 v10, 0.001953125, v10
    s_waitcnt lgkmcnt(4)
    v_mfma_f32_32x32x16_bf16 v[56:71], v[144:147], v[112:115], v[56:71]
    ds_read_b128 v[104:107], v17 offset:12288
    v_fma_f32 v10, -v9, v9, v10
    v_max_f32 v10, 0, v10
    v_mfma_f32_32x32x16_bf16 v[56:71], v[148:151], v[116:119], v[56:71]
    ds_read_b128 v[108:111], v17 offset:13312
    s_add_u32 m0, s75, 49152
    s_add_u32 s74, s74, 16384
    buffer_load_dwordx4 v0, s[28:31], s74 offen offset:0 sc1 lds
    v_add_f32 v10, 0x3727c5ac, v10
    s_waitcnt lgkmcnt(4)
    v_mfma_f32_32x32x16_bf16 v[56:71], v[152:155], v[88:91], v[56:71]
    ds_read_b128 v[112:115], v17 offset:14336
    v_rsq_f32 v20, v10
    v_mfma_f32_32x32x16_bf16 v[56:71], v[156:159], v[92:95], v[56:71]
    ds_read_b128 v[116:119], v17 offset:15360
    s_add_u32 m0, s75, 53248
    s_nop 0
    buffer_load_dwordx4 v252, s[28:31], s74 offen offset:0 sc1 lds
    s_waitcnt lgkmcnt(4)
    s_barrier
    v_mfma_f32_32x32x16_bf16 v[56:71], v[160:163], v[96:99], v[56:71]
    ds_read_b128 v[88:91], v17 offset:16384
    v_sqrt_f32 v21, v10
    v_mul_f32 v11, 0xbf800000, v9
    v_mfma_f32_32x32x16_bf16 v[56:71], v[164:167], v[100:103], v[56:71]
    ds_read_b128 v[92:95], v17 offset:17408
    s_add_u32 m0, s75, 57344
    s_nop 0
    buffer_load_dwordx4 v253, s[28:31], s74 offen offset:0 sc1 lds
    v_mov_b32 v54, 0
    s_waitcnt lgkmcnt(4)
    v_mfma_f32_32x32x16_bf16 v[56:71], v[168:171], v[104:107], v[56:71]
    ds_read_b128 v[96:99], v17 offset:18432
    v_mov_b32 v55, 0
    v_cvt_pk_bf16_f32 v52, v11, v11
    v_mfma_f32_32x32x16_bf16 v[56:71], v[172:175], v[108:111], v[56:71]
    ds_read_b128 v[100:103], v17 offset:19456
    s_add_u32 m0, s75, 61440
    s_nop 0
    buffer_load_dwordx4 v254, s[28:31], s74 offen offset:0 sc1 lds
    s_add_u32 s74, s74, 81920
    s_waitcnt lgkmcnt(4)
    v_mfma_f32_32x32x16_bf16 v[56:71], v[176:179], v[112:115], v[56:71]
    ds_read_b128 v[104:107], v17 offset:20480
    v_lshlrev_b32 v10, 16, v52
    v_sub_f32 v10, v11, v10
    v_cvt_pk_bf16_f32 v53, v10, v54
    v_mfma_f32_32x32x16_bf16 v[56:71], v[180:183], v[116:119], v[56:71]
    ds_read_b128 v[108:111], v17 offset:21504
    v_mul_f32 v20, 0xbfb8aa3b, v20
    s_waitcnt lgkmcnt(4)
    v_mfma_f32_32x32x16_bf16 v[56:71], v[184:187], v[88:91], v[56:71]
    ds_read_b128 v[112:115], v17 offset:22528
    v_mfma_f32_32x32x16_bf16 v[56:71], v[188:191], v[92:95], v[56:71]
    ds_read_b128 v[116:119], v17 offset:23552
    s_waitcnt lgkmcnt(4)
    v_mfma_f32_32x32x16_bf16 v[56:71], v[192:195], v[96:99], v[56:71]
    ds_read_b128 v[88:91], v17 offset:24576
    s_add_u32 s59, s59, 8192
    s_add_u32 s32, s32, 8192
    v_mfma_f32_32x32x16_bf16 v[56:71], v[196:199], v[100:103], v[56:71]
    ds_read_b128 v[92:95], v17 offset:25600
    s_waitcnt lgkmcnt(4)
    v_mfma_f32_32x32x16_bf16 v[56:71], v[200:203], v[104:107], v[56:71]
    ds_read_b128 v[96:99], v17 offset:26624
    s_waitcnt vmcnt(8)
    s_barrier
    s_cmp_lg_u32 s3, 0
    s_cbranch_scc1 sg12
    s_atomic_add s7, s[8:9], s59
sg12:
    v_mfma_f32_32x32x16_bf16 v[56:71], v[204:207], v[108:111], v[56:71]
    ds_read_b128 v[100:103], v17 offset:27648
    s_waitcnt lgkmcnt(4)
    v_mfma_f32_32x32x16_bf16 v[56:71], v[208:211], v[112:115], v[56:71]
    ds_read_b128 v[104:107], v17 offset:28672
    v_mfma_f32_32x32x16_bf16 v[56:71], v[212:215], v[116:119], v[56:71]
    ds_read_b128 v[108:111], v17 offset:29696
    s_waitcnt lgkmcnt(4)
    v_mfma_f32_32x32x16_bf16 v[56:71], v[216:219], v[88:91], v[56:71]
    ds_read_b128 v[112:115], v17 offset:30720
    v_mfma_f32_32x32x16_bf16 v[56:71], v[220:223], v[92:95], v[56:71]
    ds_read_b128 v[116:119], v17 offset:31744
    s_waitcnt lgkmcnt(4)
    v_mfma_f32_32x32x16_bf16 v[56:71], v[224:227], v[96:99], v[56:71]
    buffer_load_dword v9, v18, s[12:15], s76 offen offset:256 sc1
    v_mfma_f32_32x32x16_bf16 v[56:71], v[228:231], v[100:103], v[56:71]
    buffer_load_dwordx4 a[4:7], v0, s[8:11], s66 offen offset:1024 sc1
    s_cmp_lg_u32 s3, 1
    s_cbranch_scc1 pl13
    s_mov_b32 s36, 0
    s_atomic_add s36, s[8:9], s32 glc
pl13:
    s_waitcnt lgkmcnt(2)
    v_mfma_f32_32x32x16_bf16 v[56:71], v[232:235], v[104:107], v[56:71]
    buffer_load_dwordx4 a[8:11], v0, s[8:11], s66 offen offset:2048 sc1
    v_mfma_f32_32x32x16_bf16 v[56:71], v[236:239], v[108:111], v[56:71]
    buffer_load_dwordx4 a[12:15], v0, s[8:11], s66 offen offset:3072 sc1
    ds_read_b32 a255, v0
    ds_read_b32 a255, v0
    s_waitcnt lgkmcnt(2)
    v_mfma_f32_32x32x16_bf16 v[56:71], v[240:243], v[112:115], v[56:71]
    v_mfma_f32_32x32x16_bf16 v[56:71], v[244:247], v[116:119], v[56:71]
    v_mfma_f32_32x32x16_bf16 v[56:71], v[248:251], v[52:55], v[56:71]
    s_waitcnt vmcnt(4)
    s_barrier
    ds_read_b128 v[88:91], v17 offset:32768
    ds_read_b128 v[92:95], v17 offset:33792
    ds_read_b128 v[96:99], v17 offset:34816
    ds_read_b128 v[100:103], v17 offset:35840
    ds_read_b128 v[104:107], v17 offset:36864
    ds_read_b128 v[108:111], v17 offset:37888
    s_waitcnt lgkmcnt(4)
    v_mfma_f32_32x32x16_bf16 v[72:87], v[120:123], v[88:91], 0
    ds_read_b128 v[112:115], v17 offset:38912
    buffer_load_dwordx4 a[16:19], v252, s[8:11], s66 offen offset:0 sc1
    v_mfma_f32_32x32x16_bf16 v[72:87], v[124:127], v[92:95], v[72:87]
    ds_read_b128 v[116:119], v17 offset:39936
    v_mul_f32 v36, v56, v20
    v_mul_f32 v37, v57, v20
    v_mul_f32 v38, v58, v20
    v_mul_f32 v39, v59, v20
    v_mul_f32 v40, v60, v20
    s_waitcnt lgkmcnt(4)
    v_mfma_f32_32x32x16_bf16 v[72:87], v[128:131], v[96:99], v[72:87]
    ds_read_b128 v[88:91], v17 offset:40960
    buffer_load_dwordx4 a[20:23], v252, s[8:11], s66 offen offset:1024 sc1
    s_cmp_lg_u32 s3, 1
    s_cbranch_scc1 pl14
    s_mov_b32 s46, 0
    s_atomic_add s46, s[8:9], s32 glc
pl14:
    v_mul_f32 v41, v61, v20
    v_mfma_f32_32x32x16_bf16 v[72:87], v[132:135], v[100:103], v[72:87]
    ds_read_b128 v[92:95], v17 offset:41984
    v_mul_f32 v42, v62, v20
    v_mul_f32 v43, v63, v20
    v_exp_f32 v36, v36
    s_waitcnt lgkmcnt(4)
    v_mfma_f32_32x32x16_bf16 v[72:87], v[136:139], v[104:107], v[72:87]
    ds_read_b128 v[96:99], v17 offset:43008
    buffer_load_dwordx4 a[24:27], v252, s[8:11], s66 offen offset:2048 sc1
    v_exp_f32 v37, v37
    v_exp_f32 v38, v38
    s_waitcnt vmcnt(6)
    v_mfma_f32_32x32x16_bf16 v[72:87], v[140:143], v[108:111], v[72:87]
    ds_read_b128 v[100:103], v17 offset:44032
    v_exp_f32 v39, v39
    v_exp_f32 v40, v40
    v_mov_b32 v10, v9
    s_waitcnt lgkmcnt(4)
    v_mfma_f32_32x32x16_bf16 v[72:87], v[144:147], v[112:115], v[72:87]
    ds_read_b128 v[104:107], v17 offset:45056
    v_exp_f32 v41, v41
    v_exp_f32 v42, v42
    v_exp_f32 v43, v43
    v_mfma_f32_32x32x16_bf16 v[72:87], v[148:151], v[116:119], v[72:87]
    ds_read_b128 v[108:111], v17 offset:46080
    buffer_load_dwordx4 a[28:31], v252, s[8:11], s66 offen offset:3072 sc1
    v_fma_f32 v36, v36, v21, v21
    v_fma_f32 v37, v37, v21, v21
    v_fma_f32 v38, v38, v21, v21
    v_fma_f32 v39, v39, v21, v21
    s_waitcnt lgkmcnt(4)
    v_mfma_f32_32x32x16_bf16 v[72:87], v[152:155], v[88:91], v[72:87]
    ds_read_b128 v[112:115], v17 offset:47104
    v_permlane32_swap_b32 v9, v10
    v_fma_f32 v40, v40, v21, v21
    v_fma_f32 v41, v41, v21, v21
    v_fma_f32 v42, v42, v21, v21
    v_fma_f32 v43, v43, v21, v21
    v_mfma_f32_32x32x16_bf16 v[72:87], v[156:159], v[92:95], v[72:87]
    ds_read_b128 v[116:119], v17 offset:48128
    buffer_load_dwordx4 a[192:195], v0, s[8:11], s69 offen offset:0 sc1
    v_rcp_f32 v36, v36
    v_rcp_f32 v37, v37
    s_waitcnt lgkmcnt(4)
    v_mfma_f32_32x32x16_bf16 v[72:87], v[160:163], v[96:99], v[72:87]
    ds_read_b128 v[88:91], v17 offset:49152
    v_rcp_f32 v38, v38
    v_mul_f32 v9, 0.001953125, v9
    v_rcp_f32 v39, v39
    v_mul_f32 v10, 0.001953125, v10
    v_mfma_f32_32x32x16_bf16 v[72:87], v[164:167], v[100:103], v[72:87]
    ds_read_b128 v[92:95], v17 offset:50176
    v_rcp_f32 v40, v40
    v_rcp_f32 v41, v41
    v_fma_f32 v10, -v9, v9, v10
    s_waitcnt lgkmcnt(4)
    v_mfma_f32_32x32x16_bf16 v[72:87], v[168:171], v[104:107], v[72:87]
    ds_read_b128 v[96:99], v17 offset:51200
    v_rcp_f32 v42, v42
    v_rcp_f32 v43, v43
    v_mul_f32 v36, v56, v36
    v_mul_f32 v37, v57, v37
    v_mfma_f32_32x32x16_bf16 v[72:87], v[172:175], v[108:111], v[72:87]
    ds_read_b128 v[100:103], v17 offset:52224
    v_mul_f32 v38, v58, v38
    ds_read_b32 a255, v0
    s_waitcnt lgkmcnt(1)
    s_waitcnt lgkmcnt(1)
    s_mov_b32 s33, s36
    s_mov_b32 s51, s46
    s_max_u32 s33, s33, s51
    s_cmp_lt_u32 s33, s44
    s_cbranch_scc1 t2_sp
t2_go:
    s_barrier
    v_mfma_f32_32x32x16_bf16 v[72:87], v[176:179], v[112:115], v[72:87]
    ds_read_b128 v[104:107], v17 offset:53248
    v_mul_f32 v39, v59, v39
    v_mul_f32 v40, v60, v40
    v_mul_f32 v41, v61, v41
    v_mul_f32 v42, v62, v42
    v_mul_f32 v43, v63, v43
    v_max_f32 v10, 0, v10
    v_mfma_f32_32x32x16_bf16 v[72:87], v[180:183], v[116:119], v[72:87]
    ds_read_b128 v[108:111], v17 offset:54272
    s_add_u32 m0, s75, 0
    s_nop 0
    buffer_load_dwordx4 v0, s[28:31], s74 offen offset:0 sc1 lds
    v_cvt_pk_bf16_f32 v36, v36, v37
    v_cvt_pk_bf16_f32 v37, v38, v39
    v_mfma_f32_32x32x16_bf16 v[72:87], v[184:187], v[88:91], v[72:87]
    ds_read_b128 v[112:115], v17 offset:55296
    s_add_u32 m0, s75, 4096
    s_nop 0
    buffer_load_dwordx4 v252, s[28:31], s74 offen offset:0 sc1 lds
    v_cvt_pk_bf16_f32 v38, v40, v41
    v_cvt_pk_bf16_f32 v39, v42, v43
    v_add_f32 v10, 0x3727c5ac, v10
    v_mfma_f32_32x32x16_bf16 v[72:87], v[188:191], v[92:95], v[72:87]
    ds_read_b128 v[116:119], v17 offset:56320
    s_add_u32 m0, s75, 8192
    s_nop 0
    buffer_load_dwordx4 v253, s[28:31], s74 offen offset:0 sc1 lds
    v_mul_f32 v44, v64, v20
    v_mul_f32 v45, v65, v20
    v_mfma_f32_32x32x16_bf16 v[72:87], v[192:195], v[96:99], v[72:87]
    ds_read_b128 v[88:91], v17 offset:57344
    v_mul_f32 v46, v66, v20
    v_mul_f32 v47, v67, v20
    v_mul_f32 v48, v68, v20
    v_mul_f32 v49, v69, v20
    v_mul_f32 v50, v70, v20
    v_mul_f32 v51, v71, v20
    v_mfma_f32_32x32x16_bf16 v[72:87], v[196:199], v[100:103], v[72:87]
    ds_read_b128 v[92:95], v17 offset:58368
    s_add_u32 m0, s75, 12288
    s_nop 0
    buffer_load_dwordx4 v254, s[28:31], s74 offen offset:0 sc1 lds
    v_exp_f32 v44, v44
    s_waitcnt lgkmcnt(4)
    v_mfma_f32_32x32x16_bf16 v[72:87], v[200:203], v[104:107], v[72:87]
    ds_read_b128 v[96:99], v17 offset:59392
    s_add_u32 m0, s75, 16384
    s_add_u32 s74, s74, 16384
    buffer_load_dwordx4 v0, s[28:31], s74 offen offset:0 sc1 lds
    v_rsq_f32 v22, v10
    v_mfma_f32_32x32x16_bf16 v[72:87], v[204:207], v[108:111], v[72:87]
    ds_read_b128 v[100:103], v17 offset:60416
    s_add_u32 m0, s75, 20480
    s_nop 0
    buffer_load_dwordx4 v252, s[28:31], s74 offen offset:0 sc1 lds
    v_exp_f32 v45, v45
    s_waitcnt lgkmcnt(4)
    v_mfma_f32_32x32x16_bf16 v[72:87], v[208:211], v[112:115], v[72:87]
    ds_read_b128 v[104:107], v17 offset:61440
    s_add_u32 m0, s75, 24576
    s_nop 0
    buffer_load_dwordx4 v253, s[28:31], s74 offen offset:0 sc1 lds
    v_exp_f32 v46, v46
    v_mfma_f32_32x32x16_bf16 v[72:87], v[212:215], v[116:119], v[72:87]
    ds_read_b128 v[108:111], v17 offset:62464
    s_add_u32 m0, s75, 28672
    s_nop 0
    buffer_load_dwordx4 v254, s[28:31], s74 offen offset:0 sc1 lds
    s_add_u32 s74, s74, 16384
    s_waitcnt lgkmcnt(4)
    v_mfma_f32_32x32x16_bf16 v[72:87], v[216:219], v[88:91], v[72:87]
    ds_read_b128 v[112:115], v17 offset:63488
    v_exp_f32 v47, v47
    v_exp_f32 v48, v48
    v_exp_f32 v49, v49
    v_mfma_f32_32x32x16_bf16 v[72:87], v[220:223], v[92:95], v[72:87]
    ds_read_b128 v[116:119], v17 offset:64512
    v_sqrt_f32 v23, v10
    v_exp_f32 v50, v50
    v_mul_f32 v11, 0xbf800000, v9
    s_waitcnt lgkmcnt(4)
    v_mfma_f32_32x32x16_bf16 v[72:87], v[224:227], v[96:99], v[72:87]
    v_exp_f32 v51, v51
    v_fma_f32 v44, v44, v21, v21
    v_fma_f32 v45, v45, v21, v21
    v_fma_f32 v46, v46, v21, v21
    v_fma_f32 v47, v47, v21, v21
    v_fma_f32 v48, v48, v21, v21
    v_mfma_f32_32x32x16_bf16 v[72:87], v[228:231], v[100:103], v[72:87]
    v_fma_f32 v49, v49, v21, v21
    v_fma_f32 v50, v50, v21, v21
    v_fma_f32 v51, v51, v21, v21
    v_rcp_f32 v44, v44
    v_rcp_f32 v45, v45
    v_rcp_f32 v46, v46
    v_rcp_f32 v47, v47
    v_rcp_f32 v48, v48
    v_rcp_f32 v49, v49
    v_rcp_f32 v50, v50
    v_rcp_f32 v51, v51
    v_mul_f32 v44, v64, v44
    v_mul_f32 v45, v65, v45
    v_mul_f32 v46, v66, v46
    v_mul_f32 v47, v67, v47
    v_mul_f32 v48, v68, v48
    v_mul_f32 v49, v69, v49
    v_mul_f32 v50, v70, v50
    v_mul_f32 v51, v71, v51
    v_cvt_pk_bf16_f32 v44, v44, v45
    v_cvt_pk_bf16_f32 v45, v46, v47
    v_cvt_pk_bf16_f32 v46, v48, v49
    v_cvt_pk_bf16_f32 v47, v50, v51
    s_waitcnt lgkmcnt(2)
    v_mfma_f32_32x32x16_bf16 v[72:87], v[232:235], v[104:107], v[72:87]
    buffer_load_dword v12, v18, s[12:15], s76 offen offset:1024 sc1
    v_mov_b32 v54, 0
    v_mov_b32 v55, 0
    v_cvt_pk_bf16_f32 v52, v11, v11
    v_lshlrev_b32 v10, 16, v52
    v_sub_f32 v10, v11, v10
    v_cvt_pk_bf16_f32 v53, v10, v54
    v_mfma_f32_32x32x16_bf16 v[72:87], v[236:239], v[108:111], v[72:87]
    buffer_load_dword v16, v18, s[12:15], s76 offen offset:1280 sc1
    v_mul_f32 v22, 0xbfb8aa3b, v22
    ds_read_b32 a255, v0
    s_waitcnt lgkmcnt(1)
    v_mfma_f32_32x32x16_bf16 v[72:87], v[240:243], v[112:115], v[72:87]
    buffer_load_dwordx4 a[196:199], v0, s[8:11], s69 offen offset:1024 sc1
    v_mfma_f32_32x32x16_bf16 v[72:87], v[244:247], v[116:119], v[72:87]
    buffer_load_dwordx4 a[200:203], v0, s[8:11], s69 offen offset:2048 sc1
    buffer_load_dwordx4 a[204:207], v0, s[8:11], s69 offen offset:3072 sc1
    buffer_load_dwordx4 a[208:211], v252, s[8:11], s69 offen offset:0 sc1
    buffer_store_dwordx4 v[36:39], v19, s[12:15], s77 offen offset:0 sc1
    buffer_store_dwordx4 v[44:47], v19, s[12:15], s77 offen offset:1024 sc1
    s_add_u32 s77, s77, 114688
    v_mfma_f32_32x32x16_bf16 v[72:87], v[248:251], v[52:55], v[72:87]
    s_waitcnt vmcnt(12)
    s_waitcnt lgkmcnt(0)
    s_barrier
    ds_read_b128 v[88:91], v17 offset:0
    ds_read_b128 v[92:95], v17 offset:1024
    ds_read_b128 v[96:99], v17 offset:2048
    ds_read_b128 v[100:103], v17 offset:3072
    ds_read_b128 v[104:107], v17 offset:4096
    ds_read_b128 v[108:111], v17 offset:5120
    s_waitcnt lgkmcnt(4)
    v_mfma_f32_32x32x16_bf16 v[56:71], v[120:123], v[88:91], 0
    ds_read_b128 v[112:115], v17 offset:6144
    s_add_u32 m0, s75, 32768
    s_nop 0
    buffer_load_dwordx4 v0, s[28:31], s74 offen offset:0 sc1 lds
    v_mfma_f32_32x32x16_bf16 v[56:71], v[124:127], v[92:95], v[56:71]
    ds_read_b128 v[116:119], v17 offset:7168
    v_mul_f32 v36, v72, v22
    v_mul_f32 v37, v73, v22
    v_mul_f32 v38, v74, v22
    v_mul_f32 v39, v75, v22
    s_waitcnt lgkmcnt(4)
    v_mfma_f32_32x32x16_bf16 v[56:71], v[128:131], v[96:99], v[56:71]
    ds_read_b128 v[88:91], v17 offset:8192
    s_add_u32 m0, s75, 36864
    s_nop 0
    buffer_load_dwordx4 v252, s[28:31], s74 offen offset:0 sc1 lds
    v_mul_f32 v40, v76, v22
    v_mul_f32 v41, v77, v22
    v_mfma_f32_32x32x16_bf16 v[56:71], v[132:135], v[100:103], v[56:71]
    ds_read_b128 v[92:95], v17 offset:9216
    v_mul_f32 v42, v78, v22
    v_mul_f32 v43, v79, v22
    v_exp_f32 v36, v36
    s_waitcnt lgkmcnt(4)
    v_mfma_f32_32x32x16_bf16 v[56:71], v[136:139], v[104:107], v[56:71]
    ds_read_b128 v[96:99], v17 offset:10240
    v_exp_f32 v37, v37
    v_exp_f32 v38, v38
    s_waitcnt vmcnt(9)
    v_mfma_f32_32x32x16_bf16 v[56:71], v[140:143], v[108:111], v[56:71]
    ds_read_b128 v[100:103], v17 offset:11264
    s_add_u32 m0, s75, 40960
    s_nop 0
    buffer_load_dwordx4 v253, s[28:31], s74 offen offset:0 sc1 lds
    v_mov_b32 v10, v12
    s_waitcnt lgkmcnt(4)
    v_mfma_f32_32x32x16_bf16 v[56:71], v[144:147], v[112:115], v[56:71]
    ds_read_b128 v[104:107], v17 offset:12288
    v_exp_f32 v39, v39
    v_exp_f32 v40, v40
    v_mfma_f32_32x32x16_bf16 v[56:71], v[148:151], v[116:119], v[56:71]
    ds_read_b128 v[108:111], v17 offset:13312
    v_exp_f32 v41, v41
    v_exp_f32 v42, v42
    s_waitcnt lgkmcnt(4)
    v_mfma_f32_32x32x16_bf16 v[56:71], v[152:155], v[88:91], v[56:71]
    ds_read_b128 v[112:115], v17 offset:14336
    s_add_u32 m0, s75, 45056
    s_nop 0
    buffer_load_dwordx4 v254, s[28:31], s74 offen offset:0 sc1 lds
    v_exp_f32 v43, v43
    v_mfma_f32_32x32x16_bf16 v[56:71], v[156:159], v[92:95], v[56:71]
    ds_read_b128 v[116:119], v17 offset:15360
    v_fma_f32 v36, v36, v23, v23
    v_fma_f32 v37, v37, v23, v23
    v_fma_f32 v38, v38, v23, v23
    v_fma_f32 v39, v39, v23, v23
    s_waitcnt lgkmcnt(4)
    s_barrier
    v_mfma_f32_32x32x16_bf16 v[56:71], v[160:163], v[96:99], v[56:71]
    ds_read_b128 v[88:91], v17 offset:16384
    v_permlane32_swap_b32 v12, v10
    v_fma_f32 v40, v40, v23, v23
    v_fma_f32 v41, v41, v23, v23
    v_fma_f32 v42, v42, v23, v23
    v_mfma_f32_32x32x16_bf16 v[56:71], v[164:167], v[100:103], v[56:71]
    ds_read_b128 v[92:95], v17 offset:17408
    v_fma_f32 v43, v43, v23, v23
    v_rcp_f32 v36, v36
    v_mul_f32 v12, 0.001953125, v12
    s_waitcnt lgkmcnt(4)
    v_mfma_f32_32x32x16_bf16 v[56:71], v[168:171], v[104:107], v[56:71]
    ds_read_b128 v[96:99], v17 offset:18432
    s_add_u32 m0, s75, 49152
    s_add_u32 s74, s74, 16384
    buffer_load_dwordx4 v0, s[28:31], s74 offen offset:0 sc1 lds
    v_rcp_f32 v37, v37
    v_mfma_f32_32x32x16_bf16 v[56:71], v[172:175], v[108:111], v[56:71]
    ds_read_b128 v[100:103], v17 offset:19456
    v_rcp_f32 v38, v38
    v_rcp_f32 v39, v39
    s_waitcnt lgkmcnt(4)
    v_mfma_f32_32x32x16_bf16 v[56:71], v[176:179], v[112:115], v[56:71]
    ds_read_b128 v[104:107], v17 offset:20480
    s_add_u32 m0, s75, 53248
    s_nop 0
    buffer_load_dwordx4 v252, s[28:31], s74 offen offset:0 sc1 lds
    v_rcp_f32 v40, v40
    v_mfma_f32_32x32x16_bf16 v[56:71], v[180:183], v[116:119], v[56:71]
    ds_read_b128 v[108:111], v17 offset:21504
    v_rcp_f32 v41, v41
    v_rcp_f32 v42, v42
    s_waitcnt lgkmcnt(4)
    v_mfma_f32_32x32x16_bf16 v[56:71], v[184:187], v[88:91], v[56:71]
    ds_read_b128 v[112:115], v17 offset:22528
    s_add_u32 m0, s75, 57344
    s_nop 0
    buffer_load_dwordx4 v253, s[28:31], s74 offen offset:0 sc1 lds
    v_rcp_f32 v43, v43
    v_mfma_f32_32x32x16_bf16 v[56:71], v[188:191], v[92:95], v[56:71]
    ds_read_b128 v[116:119], v17 offset:23552
    s_add_u32 m0, s75, 61440
    s_nop 0
    buffer_load_dwordx4 v254, s[28:31], s74 offen offset:0 sc1 lds
    v_mul_f32 v10, 0.001953125, v10
    s_waitcnt lgkmcnt(4)
    v_mfma_f32_32x32x16_bf16 v[56:71], v[192:195], v[96:99], v[56:71]
    ds_read_b128 v[88:91], v17 offset:24576
    v_mul_f32 v36, v72, v36
    v_mul_f32 v37, v73, v37
    v_mul_f32 v38, v74, v38
    v_fma_f32 v10, -v12, v12, v10
    v_mul_f32 v39, v75, v39
    v_mfma_f32_32x32x16_bf16 v[56:71], v[196:199], v[100:103], v[56:71]
    ds_read_b128 v[92:95], v17 offset:25600
    v_mul_f32 v40, v76, v40
    v_mul_f32 v41, v77, v41
    v_mul_f32 v42, v78, v42
    v_mul_f32 v43, v79, v43
    s_waitcnt lgkmcnt(4)
    v_mfma_f32_32x32x16_bf16 v[56:71], v[200:203], v[104:107], v[56:71]
    ds_read_b128 v[96:99], v17 offset:26624
    v_max_f32 v10, 0, v10
    v_cvt_pk_bf16_f32 v36, v36, v37
    v_cvt_pk_bf16_f32 v37, v38, v39
    v_cvt_pk_bf16_f32 v38, v40, v41
    v_cvt_pk_bf16_f32 v39, v42, v43
    v_mfma_f32_32x32x16_bf16 v[56:71], v[204:207], v[108:111], v[56:71]
    ds_read_b128 v[100:103], v17 offset:27648
    v_add_f32 v10, 0x3727c5ac, v10
    v_mul_f32 v44, v80, v22
    v_mul_f32 v45, v81, v22
    v_mul_f32 v46, v82, v22
    s_waitcnt lgkmcnt(4)
    v_mfma_f32_32x32x16_bf16 v[56:71], v[208:211], v[112:115], v[56:71]
    ds_read_b128 v[104:107], v17 offset:28672
    v_mul_f32 v47, v83, v22
    v_mul_f32 v48, v84, v22
    v_mul_f32 v49, v85, v22
    v_mul_f32 v50, v86, v22
    v_mul_f32 v51, v87, v22
    v_mfma_f32_32x32x16_bf16 v[56:71], v[212:215], v[116:119], v[56:71]
    ds_read_b128 v[108:111], v17 offset:29696
    v_exp_f32 v44, v44
    v_rsq_f32 v20, v10
    s_waitcnt lgkmcnt(4)
    v_mfma_f32_32x32x16_bf16 v[56:71], v[216:219], v[88:91], v[56:71]
    ds_read_b128 v[112:115], v17 offset:30720
    buffer_load_dwordx4 a[212:215], v252, s[8:11], s69 offen offset:1024 sc1
    v_exp_f32 v45, v45
    v_exp_f32 v46, v46
    v_mfma_f32_32x32x16_bf16 v[56:71], v[220:223], v[92:95], v[56:71]
    ds_read_b128 v[116:119], v17 offset:31744
    v_exp_f32 v47, v47
    v_exp_f32 v48, v48
    s_waitcnt lgkmcnt(4)
    v_mfma_f32_32x32x16_bf16 v[56:71], v[224:227], v[96:99], v[56:71]
    v_exp_f32 v49, v49
    v_sqrt_f32 v21, v10
    v_exp_f32 v50, v50
    v_mfma_f32_32x32x16_bf16 v[56:71], v[228:231], v[100:103], v[56:71]
    buffer_load_dwordx4 a[216:219], v252, s[8:11], s69 offen offset:2048 sc1
    v_exp_f32 v51, v51
    v_fma_f32 v44, v44, v23, v23
    v_fma_f32 v45, v45, v23, v23
    v_fma_f32 v46, v46, v23, v23
    v_fma_f32 v47, v47, v23, v23
    v_fma_f32 v48, v48, v23, v23
    v_fma_f32 v49, v49, v23, v23
    v_fma_f32 v50, v50, v23, v23
    v_fma_f32 v51, v51, v23, v23
    v_rcp_f32 v44, v44
    v_rcp_f32 v45, v45
    v_rcp_f32 v46, v46
    v_rcp_f32 v47, v47
    v_rcp_f32 v48, v48
    v_rcp_f32 v49, v49
    v_rcp_f32 v50, v50
    v_rcp_f32 v51, v51
    v_mul_f32 v44, v80, v44
    v_mul_f32 v45, v81, v45
    v_mul_f32 v46, v82, v46
    v_mul_f32 v47, v83, v47
    v_mul_f32 v48, v84, v48
    v_mul_f32 v49, v85, v49
    v_mul_f32 v50, v86, v50
    v_mul_f32 v51, v87, v51
    v_cvt_pk_bf16_f32 v44, v44, v45
    v_cvt_pk_bf16_f32 v45, v46, v47
    v_cvt_pk_bf16_f32 v46, v48, v49
    v_cvt_pk_bf16_f32 v47, v50, v51
    s_waitcnt lgkmcnt(2)
    v_mfma_f32_32x32x16_bf16 v[56:71], v[232:235], v[104:107], v[56:71]
    buffer_load_dwordx4 a[220:223], v252, s[8:11], s69 offen offset:3072 sc1
    v_mul_f32 v11, 0xbf800000, v12
    v_mov_b32 v54, 0
    v_mov_b32 v55, 0
    v_cvt_pk_bf16_f32 v52, v11, v11
    v_lshlrev_b32 v10, 16, v52
    v_mfma_f32_32x32x16_bf16 v[56:71], v[236:239], v[108:111], v[56:71]
    buffer_store_dwordx4 v[36:39], v19, s[12:15], s77 offen offset:0 sc1
    buffer_store_dwordx4 v[44:47], v19, s[12:15], s77 offen offset:1024 sc1
    s_add_u32 s77, s77, 344064
    v_sub_f32 v10, v11, v10
    v_cvt_pk_bf16_f32 v53, v10, v54
    s_waitcnt lgkmcnt(0)
    v_mfma_f32_32x32x16_bf16 v[56:71], v[240:243], v[112:115], v[56:71]
    v_mul_f32 v20, 0xbfb8aa3b, v20
    v_mfma_f32_32x32x16_bf16 v[56:71], v[244:247], v[116:119], v[56:71]
    v_mfma_f32_32x32x16_bf16 v[56:71], v[248:251], v[52:55], v[56:71]
    s_waitcnt vmcnt(5)
    s_waitcnt lgkmcnt(0)
    s_barrier
    ds_read_b128 v[88:91], v17 offset:32768
    ds_read_b128 v[92:95], v17 offset:33792
    ds_read_b128 v[96:99], v17 offset:34816
    ds_read_b128 v[100:103], v17 offset:35840
    ds_read_b128 v[104:107], v17 offset:36864
    ds_read_b128 v[108:111], v17 offset:37888
    s_waitcnt lgkmcnt(4)
    v_mfma_f32_32x32x16_bf16 v[72:87], v[120:123], v[88:91], 0
    ds_read_b128 v[112:115], v17 offset:38912
    v_mfma_f32_32x32x16_bf16 v[72:87], v[124:127], v[92:95], v[72:87]
    ds_read_b128 v[116:119], v17 offset:39936
    v_mul_f32 v36, v56, v20
    v_mul_f32 v37, v57, v20
    v_mul_f32 v38, v58, v20
    v_mul_f32 v39, v59, v20
    s_waitcnt lgkmcnt(4)
    v_mfma_f32_32x32x16_bf16 v[72:87], v[128:131], v[96:99], v[72:87]
    ds_read_b128 v[88:91], v17 offset:40960
    v_mul_f32 v40, v60, v20
    s_lshl_b32 s59, s4, 1
    s_add_u32 s59, s59, s57
    v_mul_f32 v41, v61, v20
    v_mul_f32 v42, v62, v20
    v_mfma_f32_32x32x16_bf16 v[72:87], v[132:135], v[100:103], v[72:87]
    ds_read_b128 v[92:95], v17 offset:41984
    v_mul_f32 v43, v63, v20
    v_exp_f32 v36, v36
    s_lshl_b32 s59, s59, 9
    s_waitcnt lgkmcnt(4)
    v_mfma_f32_32x32x16_bf16 v[72:87], v[136:139], v[104:107], v[72:87]
    ds_read_b128 v[96:99], v17 offset:43008
    v_exp_f32 v37, v37
    v_exp_f32 v38, v38
    s_add_u32 s59, s59, s47
    v_mfma_f32_32x32x16_bf16 v[72:87], v[140:143], v[108:111], v[72:87]
    ds_read_b128 v[100:103], v17 offset:44032
    v_exp_f32 v39, v39
    v_exp_f32 v40, v40
    s_waitcnt lgkmcnt(4)
    v_mfma_f32_32x32x16_bf16 v[72:87], v[144:147], v[112:115], v[72:87]
    ds_read_b128 v[104:107], v17 offset:45056
    v_exp_f32 v41, v41
    s_add_u32 s59, s59, 32768
    v_mov_b32 v10, v16
    v_mfma_f32_32x32x16_bf16 v[72:87], v[148:151], v[116:119], v[72:87]
    ds_read_b128 v[108:111], v17 offset:46080
    v_exp_f32 v42, v42
    v_exp_f32 v43, v43
    s_waitcnt lgkmcnt(4)
    v_mfma_f32_32x32x16_bf16 v[72:87], v[152:155], v[88:91], v[72:87]
    ds_read_b128 v[112:115], v17 offset:47104
    s_lshl_b32 s32, s4, 1
    s_add_u32 s32, s32, s56
    s_lshl_b32 s32, s32, 9
    s_add_u32 s32, s32, s47
    s_add_u32 s32, s32, 32768
    v_mfma_f32_32x32x16_bf16 v[72:87], v[156:159], v[92:95], v[72:87]
    ds_read_b128 v[116:119], v17 offset:48128
    v_fma_f32 v36, v36, v21, v21
    v_fma_f32 v37, v37, v21, v21
    v_fma_f32 v38, v38, v21, v21
    v_fma_f32 v39, v39, v21, v21
    s_waitcnt lgkmcnt(4)
    v_mfma_f32_32x32x16_bf16 v[72:87], v[160:163], v[96:99], v[72:87]
    ds_read_b128 v[88:91], v17 offset:49152
    v_permlane32_swap_b32 v16, v10
    v_fma_f32 v40, v40, v21, v21
    v_fma_f32 v41, v41, v21, v21
    v_fma_f32 v42, v42, v21, v21
    v_mfma_f32_32x32x16_bf16 v[72:87], v[164:167], v[100:103], v[72:87]
    ds_read_b128 v[92:95], v17 offset:50176
    v_fma_f32 v43, v43, v21, v21
    v_rcp_f32 v36, v36
    v_mul_f32 v16, 0.001953125, v16
    s_waitcnt lgkmcnt(4)
    v_mfma_f32_32x32x16_bf16 v[72:87], v[168:171], v[104:107], v[72:87]
    ds_read_b128 v[96:99], v17 offset:51200
    v_rcp_f32 v37, v37
    v_rcp_f32 v38, v38
    s_mul_i32 s62, s55, 114688
    v_mfma_f32_32x32x16_bf16 v[72:87], v[172:175], v[108:111], v[72:87]
    ds_read_b128 v[100:103], v17 offset:52224
    v_rcp_f32 v39, v39
    v_rcp_f32 v40, v40
    s_waitcnt lgkmcnt(4)
    v_mfma_f32_32x32x16_bf16 v[72:87], v[176:179], v[112:115], v[72:87]
    ds_read_b128 v[104:107], v17 offset:53248
    v_rcp_f32 v41, v41
    v_rcp_f32 v42, v42
    v_mul_f32 v10, 0.001953125, v10
    v_mfma_f32_32x32x16_bf16 v[72:87], v[180:183], v[116:119], v[72:87]
    ds_read_b128 v[108:111], v17 offset:54272
    v_rcp_f32 v43, v43
    s_mul_i32 s22, s3, 28672
    s_add_u32 s62, s62, s22
    s_waitcnt lgkmcnt(4)
    v_mfma_f32_32x32x16_bf16 v[72:87], v[184:187], v[88:91], v[72:87]
    ds_read_b128 v[112:115], v17 offset:55296
    s_add_u32 s62, s62, 12713984
    s_add_u32 s63, s62, 16384
    s_mov_b32 s64, s70
    s_mov_b32 s65, s71
    v_mul_f32 v36, v56, v36
    v_mfma_f32_32x32x16_bf16 v[72:87], v[188:191], v[92:95], v[72:87]
    ds_read_b128 v[116:119], v17 offset:56320
    v_mul_f32 v37, v57, v37
    v_mul_f32 v38, v58, v38
    v_fma_f32 v10, -v16, v16, v10
    v_mul_f32 v39, v59, v39
    s_waitcnt lgkmcnt(4)
    v_mfma_f32_32x32x16_bf16 v[72:87], v[192:195], v[96:99], v[72:87]
    ds_read_b128 v[88:91], v17 offset:57344
    v_mul_f32 v40, v60, v40
    v_mul_f32 v41, v61, v41
    v_mul_f32 v42, v62, v42
    v_mul_f32 v43, v63, v43
    v_max_f32 v10, 0, v10
    v_mfma_f32_32x32x16_bf16 v[72:87], v[196:199], v[100:103], v[72:87]
    ds_read_b128 v[92:95], v17 offset:58368
    s_waitcnt vmcnt(0)
    s_barrier
    s_cmp_lg_u32 s78, 0
    s_cbranch_scc1 sg15
    s_atomic_add s7, s[8:9], s59
sg15:
    s_waitcnt lgkmcnt(4)
    v_mfma_f32_32x32x16_bf16 v[72:87], v[200:203], v[104:107], v[72:87]
    ds_read_b128 v[96:99], v17 offset:59392
    v_cvt_pk_bf16_f32 v36, v36, v37
    v_cvt_pk_bf16_f32 v37, v38, v39
    v_cvt_pk_bf16_f32 v38, v40, v41
    v_cvt_pk_bf16_f32 v39, v42, v43
    v_add_f32 v10, 0x3727c5ac, v10
    v_mfma_f32_32x32x16_bf16 v[72:87], v[204:207], v[108:111], v[72:87]
    ds_read_b128 v[100:103], v17 offset:60416
    v_mul_f32 v44, v64, v20
    v_mul_f32 v45, v65, v20
    v_mul_f32 v46, v66, v20
    v_mul_f32 v47, v67, v20
    s_waitcnt lgkmcnt(4)
    v_mfma_f32_32x32x16_bf16 v[72:87], v[208:211], v[112:115], v[72:87]
    ds_read_b128 v[104:107], v17 offset:61440
    v_mul_f32 v48, v68, v20
    v_mul_f32 v49, v69, v20
    v_mul_f32 v50, v70, v20
    v_mul_f32 v51, v71, v20
    v_mfma_f32_32x32x16_bf16 v[72:87], v[212:215], v[116:119], v[72:87]
    ds_read_b128 v[108:111], v17 offset:62464
    v_exp_f32 v44, v44
    v_rsq_f32 v22, v10
    s_waitcnt lgkmcnt(4)
    v_mfma_f32_32x32x16_bf16 v[72:87], v[216:219], v[88:91], v[72:87]
    ds_read_b128 v[112:115], v17 offset:63488
    s_cmp_lg_u32 s3, 1
    s_cbranch_scc1 pl16
    s_mov_b32 s36, 0
    s_atomic_add s36, s[8:9], s32 glc
pl16:
    v_mfma_f32_32x32x16_bf16 v[72:87], v[220:223], v[92:95], v[72:87]
    ds_read_b128 v[116:119], v17 offset:64512
    v_exp_f32 v45, v45
    v_exp_f32 v46, v46
    s_waitcnt lgkmcnt(4)
    v_mfma_f32_32x32x16_bf16 v[72:87], v[224:227], v[96:99], v[72:87]
    v_exp_f32 v47, v47
    v_exp_f32 v48, v48
    v_exp_f32 v49, v49
    v_mfma_f32_32x32x16_bf16 v[72:87], v[228:231], v[100:103], v[72:87]
    v_exp_f32 v50, v50
    v_exp_f32 v51, v51
    v_fma_f32 v44, v44, v21, v21
    v_fma_f32 v45, v45, v21, v21
    v_fma_f32 v46, v46, v21, v21
    v_fma_f32 v47, v47, v21, v21
    v_fma_f32 v48, v48, v21, v21
    v_fma_f32 v49, v49, v21, v21
    v_fma_f32 v50, v50, v21, v21
    v_fma_f32 v51, v51, v21, v21
    v_rcp_f32 v44, v44
    v_rcp_f32 v45, v45
    v_rcp_f32 v46, v46
    v_rcp_f32 v47, v47
    v_rcp_f32 v48, v48
    v_rcp_f32 v49, v49
    v_rcp_f32 v50, v50
    v_rcp_f32 v51, v51
    v_mul_f32 v44, v64, v44
    v_mul_f32 v45, v65, v45
    v_mul_f32 v46, v66, v46
    v_mul_f32 v47, v67, v47
    v_mul_f32 v48, v68, v48
    v_mul_f32 v49, v69, v49
    v_mul_f32 v50, v70, v50
    v_mul_f32 v51, v71, v51
    v_cvt_pk_bf16_f32 v44, v44, v45
    v_cvt_pk_bf16_f32 v45, v46, v47
    v_cvt_pk_bf16_f32 v46, v48, v49
    v_cvt_pk_bf16_f32 v47, v50, v51
    s_waitcnt lgkmcnt(2)
    v_mfma_f32_32x32x16_bf16 v[72:87], v[232:235], v[104:107], v[72:87]
    v_sqrt_f32 v23, v10
    v_mul_f32 v11, 0xbf800000, v16
    v_mov_b32 v54, 0
    v_mov_b32 v55, 0
    v_cvt_pk_bf16_f32 v52, v11, v11
    v_mfma_f32_32x32x16_bf16 v[72:87], v[236:239], v[108:111], v[72:87]
    buffer_store_dwordx4 v[36:39], v19, s[12:15], s77 offen offset:0 sc1
    buffer_store_dwordx4 v[44:47], v19, s[12:15], s77 offen offset:1024 sc1
    s_add_u32 s77, s77, 114688
    v_lshlrev_b32 v10, 16, v52
    v_sub_f32 v10, v11, v10
    ds_read_b32 a255, v0
    ds_read_b32 a255, v0
    s_waitcnt lgkmcnt(2)
    v_mfma_f32_32x32x16_bf16 v[72:87], v[240:243], v[112:115], v[72:87]
    v_cvt_pk_bf16_f32 v53, v10, v54
    v_mul_f32 v22, 0xbfb8aa3b, v22
    v_mfma_f32_32x32x16_bf16 v[72:87], v[244:247], v[116:119], v[72:87]
    v_mfma_f32_32x32x16_bf16 v[72:87], v[248:251], v[52:55], v[72:87]
    s_nop 11
    v_mul_f32 v36, v72, v22
    v_mul_f32 v37, v73, v22
    v_mul_f32 v38, v74, v22
    v_mul_f32 v39, v75, v22
    v_mul_f32 v40, v76, v22
    v_mul_f32 v41, v77, v22
    v_mul_f32 v42, v78, v22
    v_mul_f32 v43, v79, v22
    v_exp_f32 v36, v36
    v_exp_f32 v37, v37
    v_exp_f32 v38, v38
    v_exp_f32 v39, v39
    v_exp_f32 v40, v40
    v_exp_f32 v41, v41
    v_exp_f32 v42, v42
    v_exp_f32 v43, v43
    v_fma_f32 v36, v36, v23, v23
    v_fma_f32 v37, v37, v23, v23
    v_fma_f32 v38, v38, v23, v23
    v_fma_f32 v39, v39, v23, v23
    v_fma_f32 v40, v40, v23, v23
    v_fma_f32 v41, v41, v23, v23
    v_fma_f32 v42, v42, v23, v23
    v_fma_f32 v43, v43, v23, v23
    v_rcp_f32 v36, v36
    v_rcp_f32 v37, v37
    v_rcp_f32 v38, v38
    v_rcp_f32 v39, v39
    v_rcp_f32 v40, v40
    v_rcp_f32 v41, v41
    v_rcp_f32 v42, v42
    v_rcp_f32 v43, v43
    v_mul_f32 v36, v72, v36
    s_waitcnt lgkmcnt(0)
    s_cmp_lt_u32 s36, s43
    s_cbranch_scc1 t3_sp
t3_go:
    s_barrier
    buffer_load_dwordx4 v[120:123], v0, s[12:15], s62 offen offset:0 sc1
    v_mul_f32 v37, v73, v37
    v_mul_f32 v38, v74, v38
    v_mul_f32 v39, v75, v39
    v_mul_f32 v40, v76, v40
    v_mul_f32 v41, v77, v41
    v_mul_f32 v42, v78, v42
    v_mul_f32 v43, v79, v43
    v_cvt_pk_bf16_f32 v36, v36, v37
    buffer_load_dwordx4 v[124:127], v0, s[12:15], s62 offen offset:1024 sc1
    v_cvt_pk_bf16_f32 v37, v38, v39
    v_cvt_pk_bf16_f32 v38, v40, v41
    v_cvt_pk_bf16_f32 v39, v42, v43
    v_mul_f32 v44, v80, v22
    v_mul_f32 v45, v81, v22
    v_mul_f32 v46, v82, v22
    v_mul_f32 v47, v83, v22
    buffer_load_dwordx4 v[128:131], v0, s[12:15], s62 offen offset:2048 sc1
    v_mul_f32 v48, v84, v22
    v_mul_f32 v49, v85, v22
    v_mul_f32 v50, v86, v22
    v_mul_f32 v51, v87, v22
    v_exp_f32 v44, v44
    v_exp_f32 v45, v45
    buffer_load_dwordx4 v[132:135], v0, s[12:15], s62 offen offset:3072 sc1
    v_exp_f32 v46, v46
    v_exp_f32 v47, v47
    v_exp_f32 v48, v48
    buffer_load_dwordx4 v[136:139], v252, s[12:15], s62 offen offset:0 sc1
    v_exp_f32 v49, v49
    v_exp_f32 v50, v50
    v_exp_f32 v51, v51
    v_fma_f32 v44, v44, v23, v23
    buffer_load_dwordx4 v[140:143], v252, s[12:15], s62 offen offset:1024 sc1
    v_fma_f32 v45, v45, v23, v23
    v_fma_f32 v46, v46, v23, v23
    v_fma_f32 v47, v47, v23, v23
    v_fma_f32 v48, v48, v23, v23
    v_fma_f32 v49, v49, v23, v23
    v_fma_f32 v50, v50, v23, v23
    v_fma_f32 v51, v51, v23, v23
    buffer_load_dwordx4 v[144:147], v252, s[12:15], s62 offen offset:2048 sc1
    v_rcp_f32 v44, v44
    v_rcp_f32 v45, v45
    v_rcp_f32 v46, v46
    v_rcp_f32 v47, v47
    buffer_load_dwordx4 v[148:151], v252, s[12:15], s62 offen offset:3072 sc1
    v_rcp_f32 v48, v48
    v_rcp_f32 v49, v49
    v_rcp_f32 v50, v50
    buffer_load_dwordx4 v[152:155], v253, s[12:15], s62 offen offset:0 sc1
    v_rcp_f32 v51, v51
    v_mul_f32 v44, v80, v44
    v_mul_f32 v45, v81, v45
    v_mul_f32 v46, v82, v46
    v_mul_f32 v47, v83, v47
    v_mul_f32 v48, v84, v48
    buffer_load_dwordx4 v[156:159], v253, s[12:15], s62 offen offset:1024 sc1
    v_mul_f32 v49, v85, v49
    v_mul_f32 v50, v86, v50
    v_mul_f32 v51, v87, v51
    v_cvt_pk_bf16_f32 v44, v44, v45
    v_cvt_pk_bf16_f32 v45, v46, v47
    v_cvt_pk_bf16_f32 v46, v48, v49
    v_cvt_pk_bf16_f32 v47, v50, v51
    buffer_store_dwordx4 v[36:39], v19, s[12:15], s77 offen offset:0 sc1
    buffer_store_dwordx4 v[44:47], v19, s[12:15], s77 offen offset:1024 sc1
    s_add_u32 s77, s77, 0
    s_waitcnt vmcnt(11)
    v_mfma_f32_32x32x16_bf16 v[56:71], a[0:3], v[120:123], 0
    buffer_load_dwordx4 v[160:163], v253, s[12:15], s62 offen offset:2048 sc1
    v_mfma_f32_32x32x16_bf16 v[72:87], a[4:7], v[120:123], 0
    buffer_load_dwordx4 v[164:167], v253, s[12:15], s62 offen offset:3072 sc1
    s_waitcnt vmcnt(12)
    v_mfma_f32_32x32x16_bf16 v[56:71], a[8:11], v[124:127], v[56:71]
    v_mfma_f32_32x32x16_bf16 v[72:87], a[12:15], v[124:127], v[72:87]
    buffer_load_dwordx4 v[168:171], v254, s[12:15], s62 offen offset:0 sc1
    s_waitcnt vmcnt(12)
    v_mfma_f32_32x32x16_bf16 v[56:71], a[16:19], v[128:131], v[56:71]
    v_mfma_f32_32x32x16_bf16 v[72:87], a[20:23], v[128:131], v[72:87]
    buffer_load_dwordx4 v[172:175], v254, s[12:15], s62 offen offset:1024 sc1
    s_waitcnt vmcnt(12)
    v_mfma_f32_32x32x16_bf16 v[56:71], a[24:27], v[132:135], v[56:71]
    buffer_load_dwordx4 v[176:179], v254, s[12:15], s62 offen offset:2048 sc1
    v_mfma_f32_32x32x16_bf16 v[72:87], a[28:31], v[132:135], v[72:87]
    s_waitcnt vmcnt(12)
    v_mfma_f32_32x32x16_bf16 v[56:71], a[32:35], v[136:139], v[56:71]
    v_mfma_f32_32x32x16_bf16 v[72:87], a[36:39], v[136:139], v[72:87]
    buffer_load_dwordx4 v[180:183], v254, s[12:15], s62 offen offset:3072 sc1
    s_waitcnt vmcnt(12)
    v_mfma_f32_32x32x16_bf16 v[56:71], a[40:43], v[140:143], v[56:71]
    v_mfma_f32_32x32x16_bf16 v[72:87], a[44:47], v[140:143], v[72:87]
    buffer_load_dwordx4 v[184:187], v0, s[12:15], s63 offen offset:0 sc1
    s_waitcnt vmcnt(12)
    v_mfma_f32_32x32x16_bf16 v[56:71], a[48:51], v[144:147], v[56:71]
    v_mfma_f32_32x32x16_bf16 v[72:87], a[52:55], v[144:147], v[72:87]
    buffer_load_dwordx4 v[188:191], v0, s[12:15], s63 offen offset:1024 sc1
    s_waitcnt vmcnt(12)
    v_mfma_f32_32x32x16_bf16 v[56:71], a[56:59], v[148:151], v[56:71]
    v_mfma_f32_32x32x16_bf16 v[72:87], a[60:63], v[148:151], v[72:87]
    s_add_u32 s59, s59, 8192
    s_add_u32 s32, s32, 8192
    s_waitcnt lgkmcnt(0)
    s_waitcnt vmcnt(8)
    s_barrier
    s_cmp_lg_u32 s78, 0
    s_cbranch_scc1 sg17
    s_atomic_add s7, s[8:9], s59
sg17:
    v_mfma_f32_32x32x16_bf16 v[56:71], a[64:67], v[152:155], v[56:71]
    buffer_load_dwordx4 v[192:195], v0, s[12:15], s63 offen offset:2048 sc1
    v_mfma_f32_32x32x16_bf16 v[72:87], a[68:71], v[152:155], v[72:87]
    buffer_load_dwordx4 v[196:199], v0, s[12:15], s63 offen offset:3072 sc1
    v_mfma_f32_32x32x16_bf16 v[56:71], a[72:75], v[156:159], v[56:71]
    v_mfma_f32_32x32x16_bf16 v[72:87], a[76:79], v[156:159], v[72:87]
    buffer_load_dwordx4 v[200:203], v252, s[12:15], s63 offen offset:0 sc1
    s_waitcnt vmcnt(10)
    v_mfma_f32_32x32x16_bf16 v[56:71], a[80:83], v[160:163], v[56:71]
    v_mfma_f32_32x32x16_bf16 v[72:87], a[84:87], v[160:163], v[72:87]
    s_waitcnt vmcnt(9)
    v_mfma_f32_32x32x16_bf16 v[56:71], a[88:91], v[164:167], v[56:71]
    buffer_load_dwordx4 v[204:207], v252, s[12:15], s63 offen offset:1024 sc1
    v_mfma_f32_32x32x16_bf16 v[72:87], a[92:95], v[164:167], v[72:87]
    s_waitcnt vmcnt(9)
    v_mfma_f32_32x32x16_bf16 v[56:71], a[96:99], v[168:171], v[56:71]
    buffer_load_dwordx4 v[208:211], v252, s[12:15], s63 offen offset:2048 sc1
    s_mov_b32 s28, s48
    s_and_b32 s29, s49, 0xffff
    s_mov_b32 s30, 0
    s_mov_b32 s31, 0x20000
    s_mul_i32 s30, s6, 2097152
    v_mfma_f32_32x32x16_bf16 v[72:87], a[100:103], v[168:171], v[72:87]
    s_waitcnt vmcnt(9)
    v_mfma_f32_32x32x16_bf16 v[56:71], a[104:107], v[172:175], v[56:71]
    buffer_load_dwordx4 v[212:215], v252, s[12:15], s63 offen offset:3072 sc1
    v_mfma_f32_32x32x16_bf16 v[72:87], a[108:111], v[172:175], v[72:87]
    s_cmp_lg_u32 s3, 1
    s_cbranch_scc1 pl18
    s_mov_b32 s36, 0
    s_atomic_add s36, s[8:9], s32 glc
pl18:
    s_waitcnt vmcnt(9)
    v_mfma_f32_32x32x16_bf16 v[56:71], a[112:115], v[176:179], v[56:71]
    buffer_load_dwordx4 v[216:219], v253, s[12:15], s63 offen offset:0 sc1
    v_mfma_f32_32x32x16_bf16 v[72:87], a[116:119], v[176:179], v[72:87]
    s_lshl_b32 s22, s55, 15
    s_lshl_b32 s23, s54, 7
    s_add_u32 s22, s22, s23
    s_add_u32 s23, s70, 9568256
    s_cmp_eq_u32 s6, 0
    s_cselect_b32 s70, s23, s22
    s_add_u32 s71, s70, 131072
    s_add_u32 s72, s72, 20037632
    s_waitcnt vmcnt(9)
    v_mfma_f32_32x32x16_bf16 v[56:71], a[120:123], v[180:183], v[56:71]
    buffer_load_dwordx4 v[220:223], v253, s[12:15], s63 offen offset:1024 sc1
    v_mfma_f32_32x32x16_bf16 v[72:87], a[124:127], v[180:183], v[72:87]
    s_waitcnt vmcnt(9)
    v_mfma_f32_32x32x16_bf16 v[56:71], a[128:131], v[184:187], v[56:71]
    v_mfma_f32_32x32x16_bf16 v[72:87], a[132:135], v[184:187], v[72:87]
    buffer_load_dwordx4 v[224:227], v253, s[12:15], s63 offen offset:2048 sc1
    s_waitcnt vmcnt(9)
    v_mfma_f32_32x32x16_bf16 v[56:71], a[136:139], v[188:191], v[56:71]
    v_mfma_f32_32x32x16_bf16 v[72:87], a[140:143], v[188:191], v[72:87]
    buffer_load_dwordx4 v[228:231], v253, s[12:15], s63 offen offset:3072 sc1
    s_add_u32 s62, s62, 458752
    s_add_u32 s63, s63, 458752
    s_waitcnt vmcnt(9)
    v_mfma_f32_32x32x16_bf16 v[56:71], a[144:147], v[192:195], v[56:71]
    v_mfma_f32_32x32x16_bf16 v[72:87], a[148:151], v[192:195], v[72:87]
    buffer_load_dwordx4 v[20:23], v31, s[12:15], s64 offen offset:0 sc1
    s_waitcnt vmcnt(9)
    v_mfma_f32_32x32x16_bf16 v[56:71], a[152:155], v[196:199], v[56:71]
    buffer_load_dwordx4 v[24:27], v31, s[12:15], s65 offen offset:0 sc1
    v_mfma_f32_32x32x16_bf16 v[72:87], a[156:159], v[196:199], v[72:87]
    s_waitcnt vmcnt(9)
    v_mfma_f32_32x32x16_bf16 v[56:71], a[160:163], v[200:203], v[56:71]
    v_mfma_f32_32x32x16_bf16 v[72:87], a[164:167], v[200:203], v[72:87]
    s_waitcnt vmcnt(8)
    v_mfma_f32_32x32x16_bf16 v[56:71], a[168:171], v[204:207], v[56:71]
    v_mfma_f32_32x32x16_bf16 v[72:87], a[172:175], v[204:207], v[72:87]
    s_waitcnt vmcnt(7)
    v_mfma_f32_32x32x16_bf16 v[56:71], a[176:179], v[208:211], v[56:71]
    s_waitcnt vmcnt(1)
    v_lshlrev_b32 v36, 16, v20
    v_mfma_f32_32x32x16_bf16 v[72:87], a[180:183], v[208:211], v[72:87]
    v_and_b32 v37, 0xffff0000, v20
    v_lshlrev_b32 v38, 16, v21
    v_mfma_f32_32x32x16_bf16 v[56:71], a[184:187], v[212:215], v[56:71]
    v_and_b32 v39, 0xffff0000, v21
    v_lshlrev_b32 v40, 16, v22
    v_mfma_f32_32x32x16_bf16 v[72:87], a[188:191], v[212:215], v[72:87]
    v_and_b32 v41, 0xffff0000, v22
    v_lshlrev_b32 v42, 16, v23
    v_mfma_f32_32x32x16_bf16 v[56:71], a[192:195], v[216:219], v[56:71]
    v_and_b32 v43, 0xffff0000, v23
    v_mfma_f32_32x32x16_bf16 v[72:87], a[196:199], v[216:219], v[72:87]
    v_mfma_f32_32x32x16_bf16 v[56:71], a[200:203], v[220:223], v[56:71]
    s_waitcnt lgkmcnt(0)
    s_cmp_lt_u32 s36, s43
    s_cbranch_scc1 t4_sp
t4_go:
    s_barrier
    v_mfma_f32_32x32x16_bf16 v[72:87], a[204:207], v[220:223], v[72:87]
    v_mfma_f32_32x32x16_bf16 v[56:71], a[208:211], v[224:227], v[56:71]
    buffer_load_dwordx4 v[120:123], v0, s[12:15], s62 offen offset:0 sc1
    v_mfma_f32_32x32x16_bf16 v[72:87], a[212:215], v[224:227], v[72:87]
    buffer_load_dwordx4 v[124:127], v0, s[12:15], s62 offen offset:1024 sc1
    v_mfma_f32_32x32x16_bf16 v[56:71], a[216:219], v[228:231], v[56:71]
    buffer_load_dwordx4 v[128:131], v0, s[12:15], s62 offen offset:2048 sc1
    v_mfma_f32_32x32x16_bf16 v[72:87], a[220:223], v[228:231], v[72:87]
    buffer_load_dwordx4 v[132:135], v0, s[12:15], s62 offen offset:3072 sc1
    s_nop 8
    ds_write_b128 v28, v[56:59] offset:0
    ds_write_b128 v28, v[60:63] offset:1024
    buffer_load_dwordx4 v[136:139], v252, s[12:15], s62 offen offset:0 sc1
    ds_write_b128 v29, v[64:67] offset:2048
    buffer_load_dwordx4 v[140:143], v252, s[12:15], s62 offen offset:1024 sc1
    ds_write_b128 v29, v[68:71] offset:3072
    buffer_load_dwordx4 v[144:147], v252, s[12:15], s62 offen offset:2048 sc1
    ds_write_b128 v28, v[72:75] offset:4096
    ds_write_b128 v28, v[76:79] offset:5120
    buffer_load_dwordx4 v[148:151], v252, s[12:15], s62 offen offset:3072 sc1
    ds_write_b128 v29, v[80:83] offset:6144
    buffer_load_dwordx4 v[152:155], v253, s[12:15], s62 offen offset:0 sc1
    ds_write_b128 v29, v[84:87] offset:7168
    s_waitcnt lgkmcnt(0)
    s_barrier
    s_waitcnt vmcnt(8)
    v_mfma_f32_32x32x16_bf16 v[88:103], a[0:3], v[120:123], 0
    ds_read_b128 v[56:59], v30 offset:0
    ds_read_b128 v[60:63], v30 offset:1024
    ds_read_b128 v[64:67], v30 offset:8192
    ds_read_b128 v[68:71], v30 offset:9216
    buffer_load_dwordx4 v[156:159], v253, s[12:15], s62 offen offset:1024 sc1
    v_mfma_f32_32x32x16_bf16 v[104:119], a[4:7], v[120:123], 0
    ds_read_b128 v[72:75], v30 offset:16384
    ds_read_b128 v[76:79], v30 offset:17408
    ds_read_b128 v[80:83], v30 offset:24576
    buffer_load_dwordx4 v[160:163], v253, s[12:15], s62 offen offset:2048 sc1
    s_waitcnt vmcnt(9)
    v_mfma_f32_32x32x16_bf16 v[88:103], a[8:11], v[124:127], v[88:103]
    ds_read_b128 v[84:87], v30 offset:25600
    s_waitcnt lgkmcnt(6)
    v_add_f32 v36, v36, v56
    v_add_f32 v37, v37, v57
    v_mfma_f32_32x32x16_bf16 v[104:119], a[12:15], v[124:127], v[104:119]
    buffer_load_dwordx4 v[164:167], v253, s[12:15], s62 offen offset:3072 sc1
    v_add_f32 v38, v38, v58
    v_add_f32 v39, v39, v59
    v_add_f32 v40, v40, v60
    s_waitcnt vmcnt(9)
    v_mfma_f32_32x32x16_bf16 v[88:103], a[16:19], v[128:131], v[88:103]
    buffer_load_dwordx4 v[168:171], v254, s[12:15], s62 offen offset:0 sc1
    v_add_f32 v41, v41, v61
    v_add_f32 v42, v42, v62
    v_add_f32 v43, v43, v63
    s_waitcnt lgkmcnt(4)
    v_mfma_f32_32x32x16_bf16 v[104:119], a[20:23], v[128:131], v[104:119]
    v_add_f32 v36, v36, v64
    v_add_f32 v37, v37, v65
    v_add_f32 v38, v38, v66
    s_waitcnt vmcnt(9)
    v_mfma_f32_32x32x16_bf16 v[88:103], a[24:27], v[132:135], v[88:103]
    buffer_load_dwordx4 v[172:175], v254, s[12:15], s62 offen offset:1024 sc1
    v_add_f32 v39, v39, v67
    v_add_f32 v40, v40, v68
    v_add_f32 v41, v41, v69
    v_mfma_f32_32x32x16_bf16 v[104:119], a[28:31], v[132:135], v[104:119]
    v_add_f32 v42, v42, v70
    v_add_f32 v43, v43, v71
    s_waitcnt lgkmcnt(2)
    v_add_f32 v36, v36, v72
    s_waitcnt vmcnt(9)
    v_mfma_f32_32x32x16_bf16 v[88:103], a[32:35], v[136:139], v[88:103]
    v_add_f32 v37, v37, v73
    v_add_f32 v38, v38, v74
    v_add_f32 v39, v39, v75
    s_lshl_b32 s59, s4, 1
    v_mfma_f32_32x32x16_bf16 v[104:119], a[36:39], v[136:139], v[104:119]
    buffer_load_dwordx4 v[176:179], v254, s[12:15], s62 offen offset:2048 sc1
    v_add_f32 v40, v40, v76
    v_add_f32 v41, v41, v77
    v_add_f32 v42, v42, v78
    v_add_f32 v43, v43, v79
    s_waitcnt vmcnt(9)
    v_mfma_f32_32x32x16_bf16 v[88:103], a[40:43], v[140:143], v[88:103]
    s_add_u32 s59, s59, s56
    s_waitcnt lgkmcnt(0)
    v_add_f32 v36, v36, v80
    v_add_f32 v37, v37, v81
    s_lshl_b32 s59, s59, 9
    v_mfma_f32_32x32x16_bf16 v[104:119], a[44:47], v[140:143], v[104:119]
    buffer_load_dwordx4 v[180:183], v254, s[12:15], s62 offen offset:3072 sc1
    v_add_f32 v38, v38, v82
    v_add_f32 v39, v39, v83
    v_add_f32 v40, v40, v84
    v_add_f32 v41, v41, v85
    s_waitcnt vmcnt(9)
    v_mfma_f32_32x32x16_bf16 v[88:103], a[48:51], v[144:147], v[88:103]
    s_add_u32 s59, s59, s47
    v_add_f32 v42, v42, v86
    v_add_f32 v43, v43, v87
    v_cvt_pk_bf16_f32 v20, v36, v37
    s_add_u32 s59, s59, 49152
    v_mfma_f32_32x32x16_bf16 v[104:119], a[52:55], v[144:147], v[104:119]
    buffer_load_dwordx4 v[184:187], v0, s[12:15], s63 offen offset:0 sc1
    v_cvt_pk_bf16_f32 v21, v38, v39
    v_cvt_pk_bf16_f32 v22, v40, v41
    v_cvt_pk_bf16_f32 v23, v42, v43
    s_and_b32 s74, s4, 6
    s_waitcnt vmcnt(9)
    v_mfma_f32_32x32x16_bf16 v[88:103], a[56:59], v[148:151], v[88:103]
    s_lshl_b32 s74, s74, 1
    v_mfma_f32_32x32x16_bf16 v[104:119], a[60:63], v[148:151], v[104:119]
    buffer_load_dwordx4 v[188:191], v0, s[12:15], s63 offen offset:1024 sc1
    s_lshr_b32 s22, s5, 4
    s_waitcnt vmcnt(9)
    v_mfma_f32_32x32x16_bf16 v[88:103], a[64:67], v[152:155], v[88:103]
    s_lshl_b32 s22, s22, 1
    v_mfma_f32_32x32x16_bf16 v[104:119], a[68:71], v[152:155], v[104:119]
    s_cmp_lg_u32 s6, 0
    s_cbranch_scc1 w2_f0
    buffer_store_dwordx4 v[20:23], v31, s[12:15], s70 offen offset:0 sc1
    v_mul_f32 v44, v36, v36
    v_fmac_f32 v44, v37, v37
    v_fmac_f32 v44, v38, v38
    v_fmac_f32 v44, v39, v39
    v_fmac_f32 v44, v40, v40
    v_fmac_f32 v44, v41, v41
    v_fmac_f32 v44, v42, v42
    v_fmac_f32 v44, v43, v43
    v_add_f32 v36, v36, v40
    v_add_f32 v37, v37, v41
    v_add_f32 v38, v38, v42
    v_add_f32 v39, v39, v43
    v_add_f32 v36, v36, v38
    v_add_f32 v37, v37, v39
    v_add_f32 v36, v36, v37
    s_nop 1
    v_permlane32_swap_b32 v36, v44
    v_add_f32 v36, v36, v44
    v_mov_b32 v37, v36
    s_nop 1
    v_permlane16_swap_b32 v36, v37
    v_add_f32 v36, v36, v37
    s_nop 1
    v_add_f32_dpp v36, v36, v36 row_ror:8 row_mask:0xf bank_mask:0xf
    buffer_atomic_add_f32 v36, v33, s[12:15], s72 offen offset:0
w2_f0:
    v_permlane32_swap_b32 v20, v22
    v_permlane32_swap_b32 v21, v23
    buffer_store_dwordx4 v[20:23], v32, s[28:31], s70 offen offset:0
    s_waitcnt vmcnt(9)
    v_mfma_f32_32x32x16_bf16 v[88:103], a[72:75], v[156:159], v[88:103]
    buffer_load_dwordx4 v[192:195], v0, s[12:15], s63 offen offset:2048 sc1
    s_add_u32 s74, s74, s22
    s_bfe_u32 s22, s5, 0x10003
    v_mfma_f32_32x32x16_bf16 v[104:119], a[76:79], v[156:159], v[104:119]
    s_add_u32 s74, s74, s22
    s_waitcnt vmcnt(9)
    v_mfma_f32_32x32x16_bf16 v[88:103], a[80:83], v[160:163], v[88:103]
    buffer_load_dwordx4 v[196:199], v0, s[12:15], s63 offen offset:3072 sc1
    s_lshl_b32 s74, s74, 9
    v_mfma_f32_32x32x16_bf16 v[104:119], a[84:87], v[160:163], v[104:119]
    s_add_u32 s74, s74, s47
    s_waitcnt vmcnt(9)
    v_mfma_f32_32x32x16_bf16 v[88:103], a[88:91], v[164:167], v[88:103]
    buffer_load_dwordx4 v[200:203], v252, s[12:15], s63 offen offset:0 sc1
    s_add_u32 s74, s74, 49152
    v_mfma_f32_32x32x16_bf16 v[104:119], a[92:95], v[164:167], v[104:119]
    s_nop 0
    s_waitcnt vmcnt(9)
    v_mfma_f32_32x32x16_bf16 v[88:103], a[96:99], v[168:171], v[88:103]
    buffer_load_dwordx4 v[204:207], v252, s[12:15], s63 offen offset:1024 sc1
    v_mfma_f32_32x32x16_bf16 v[104:119], a[100:103], v[168:171], v[104:119]
    s_waitcnt vmcnt(9)
    v_mfma_f32_32x32x16_bf16 v[88:103], a[104:107], v[172:175], v[88:103]
    buffer_load_dwordx4 v[208:211], v252, s[12:15], s63 offen offset:2048 sc1
    v_mfma_f32_32x32x16_bf16 v[104:119], a[108:111], v[172:175], v[104:119]
    s_waitcnt vmcnt(9)
    v_mfma_f32_32x32x16_bf16 v[88:103], a[112:115], v[176:179], v[88:103]
    v_mfma_f32_32x32x16_bf16 v[104:119], a[116:119], v[176:179], v[104:119]
    buffer_load_dwordx4 v[212:215], v252, s[12:15], s63 offen offset:3072 sc1
    s_waitcnt vmcnt(9)
    v_mfma_f32_32x32x16_bf16 v[88:103], a[120:123], v[180:183], v[88:103]
    buffer_load_dwordx4 v[216:219], v253, s[12:15], s63 offen offset:0 sc1
    v_mfma_f32_32x32x16_bf16 v[104:119], a[124:127], v[180:183], v[104:119]
    buffer_load_dwordx4 v[220:223], v253, s[12:15], s63 offen offset:1024 sc1
    s_waitcnt vmcnt(10)
    v_mfma_f32_32x32x16_bf16 v[88:103], a[128:131], v[184:187], v[88:103]
    buffer_load_dwordx4 v[224:227], v253, s[12:15], s63 offen offset:2048 sc1
    v_mfma_f32_32x32x16_bf16 v[104:119], a[132:135], v[184:187], v[104:119]
    buffer_load_dwordx4 v[228:231], v253, s[12:15], s63 offen offset:3072 sc1
    s_and_b32 s54, s4, 1
    s_lshl_b32 s54, s54, 3
    s_and_b32 s96, s5, 7
    s_add_u32 s54, s54, s96
    s_waitcnt vmcnt(11)
    v_mfma_f32_32x32x16_bf16 v[88:103], a[136:139], v[188:191], v[88:103]
    s_bfe_u32 s55, s5, 0x10003
    s_and_b32 s57, s4, 6
    s_lshr_b32 s96, s5, 4
    s_add_u32 s57, s57, s96
    s_lshl_b32 s57, s57, 3
    s_lshr_b32 s56, s3, 1
    v_mfma_f32_32x32x16_bf16 v[104:119], a[140:143], v[188:191], v[104:119]
    s_lshl_b32 s96, s55, 1
    s_add_u32 s57, s57, s96
    s_and_b32 s96, s3, 1
    s_add_u32 s57, s57, s96
    s_mul_i32 s96, s56, 49152
    s_waitcnt vmcnt(9)
    v_mfma_f32_32x32x16_bf16 v[88:103], a[144:147], v[192:195], v[88:103]
    s_lshl_b32 s97, s56, 5
    v_lshrrev_b32 v7, 5, v1
    v_bfe_u32 v8, v1, 2, 2
    v_lshl_add_u32 v7, v7, 2, v8
    v_and_b32 v11, 3, v1
    v_lshlrev_b32 v11, 3, v11
    v_mfma_f32_32x32x16_bf16 v[104:119], a[148:151], v[192:195], v[104:119]
    v_bfe_u32 v10, v1, 4, 1
    v_lshl_add_u32 v11, v10, 5, v11
    v_add_u32 v11, s96, v11
    v_xor_b32 v9, s97, v11
    v_lshl_add_u32 v9, v7, 7, v9
    s_waitcnt vmcnt(8)
    v_mfma_f32_32x32x16_bf16 v[88:103], a[152:155], v[196:199], v[88:103]
    s_barrier
    s_cmp_lg_u32 s3, 0
    s_cbranch_scc1 sg19
    s_atomic_add s7, s[8:9], s59
sg19:
    v_bfe_u32 v8, v1, 3, 1
    v_mfma_f32_32x32x16_bf16 v[104:119], a[156:159], v[196:199], v[104:119]
    v_lshl_add_u32 v9, v8, 6, v9
    v_xor_b32 v10, 64, v9
    v_lshl_add_u32 v11, v7, 6, v11
    v_add_u32 v11, 2048, v11
    s_lshl_b32 s97, s56, 8
    s_waitcnt vmcnt(7)
    v_mfma_f32_32x32x16_bf16 v[88:103], a[160:163], v[200:203], v[88:103]
    v_xor_b32 v12, s97, v0
    s_lshl_b32 s96, s3, 14
    s_add_u32 s96, s96, 98304
    v_add_u32 v13, s96, v0
    s_xor_b32 s97, s3, 2
    s_lshl_b32 s97, s97, 14
    v_mfma_f32_32x32x16_bf16 v[104:119], a[164:167], v[200:203], v[104:119]
    s_add_u32 s97, s97, 98304
    v_add_u32 v14, s97, v0
    v_lshrrev_b32 v7, 4, v12
    v_and_b32 v15, 0x33, v7
    v_bfe_u32 v8, v7, 2, 1
    s_waitcnt vmcnt(6)
    v_mfma_f32_32x32x16_bf16 v[88:103], a[168:171], v[204:207], v[88:103]
    v_lshl_or_b32 v15, v8, 3, v15
    v_bfe_u32 v8, v7, 3, 1
    v_lshl_or_b32 v15, v8, 2, v15
    v_lshlrev_b32 v15, 4, v15
    v_mfma_f32_32x32x16_bf16 v[104:119], a[172:175], v[204:207], v[104:119]
    s_cmp_lt_u32 s54, 8
    s_cselect_b64 s[98:99], -1, 0
    s_cselect_b32 s58, 0x3eb8aa3b, 1.0
    v_cndmask_b32 v15, v15, v12, s[98:99]
    v_bfe_u32 v7, v1, 4, 1
    s_waitcnt vmcnt(5)
    v_mfma_f32_32x32x16_bf16 v[88:103], a[176:179], v[208:211], v[88:103]
    v_lshlrev_b32 v16, 16, v7
    v_lshrrev_b32 v7, 5, v1
    v_lshl_add_u32 v16, v7, 8, v16
    v_and_b32 v7, 15, v1
    v_lshl_add_u32 v16, v7, 4, v16
    v_mov_b32 v19, 0x3f803f80
    s_waitcnt vmcnt(4)
    v_mfma_f32_32x32x16_bf16 v[88:103], a[184:187], v[212:215], v[88:103]
    s_lshl_b32 s66, s54, 18
    s_lshl_b32 s96, s56, 16
    s_add_u32 s66, s66, s96
    s_lshl_b32 s96, s57, 10
    s_add_u32 s66, s66, s96
    s_waitcnt vmcnt(3)
    v_mfma_f32_32x32x16_bf16 v[88:103], a[192:195], v[216:219], v[88:103]
    s_add_u32 s66, s66, 2228224
    s_add_u32 s67, s66, 131072
    s_lshl_b32 s68, s54, 17
    s_add_u32 s68, s68, s96
    s_lshl_b32 s96, s56, 9
    s_waitcnt vmcnt(2)
    v_mfma_f32_32x32x16_bf16 v[88:103], a[200:203], v[220:223], v[88:103]
    s_add_u32 s68, s68, s96
    s_add_u32 s68, s68, 6422528
    s_lshl_b32 s69, s54, 9
    s_add_u32 s69, s69, s47
    s_waitcnt vmcnt(1)
    v_mfma_f32_32x32x16_bf16 v[88:103], a[208:211], v[224:227], v[88:103]
    s_cmp_lg_u32 s3, 1
    s_cbranch_scc1 pl20
    s_mov_b32 s36, 0
    s_atomic_add s36, s[8:9], s74 glc
pl20:
    s_add_u32 s69, s69, 0
    s_and_b32 s96, s54, 7
    s_waitcnt vmcnt(0)
    v_mfma_f32_32x32x16_bf16 v[88:103], a[216:219], v[228:231], v[88:103]
    s_lshl_b32 s96, s96, 1
    s_lshl_b32 s41, s96, 9
    s_add_u32 s41, s41, s47
    s_add_u32 s41, s41, 0
    s_lshl_b32 s62, s57, 15
    v_mfma_f32_32x32x16_bf16 v[104:119], a[180:183], v[208:211], v[104:119]
    s_lshl_b32 s96, s56, 14
    s_add_u32 s62, s62, s96
    s_add_u32 s62, s62, 25362432
    s_lshl_b32 s64, s57, 8
    s_add_u32 s64, s64, 98304
    v_mfma_f32_32x32x16_bf16 v[104:119], a[188:191], v[212:215], v[104:119]
    v_lshlrev_b32 v36, 16, v24
    v_lshrrev_b32 v251, 2, v12
    s_add_u32 s69, s69, 20054016
    s_add_u32 s41, s41, 20054016
    v_and_b32 v37, 0xffff0000, v24
    v_mfma_f32_32x32x16_bf16 v[104:119], a[196:199], v[216:219], v[104:119]
    ds_write_b128 v28, v[88:91] offset:32768
    v_lshlrev_b32 v38, 16, v25
    v_and_b32 v39, 0xffff0000, v25
    v_lshlrev_b32 v40, 16, v26
    v_mfma_f32_32x32x16_bf16 v[104:119], a[204:207], v[220:223], v[104:119]
    ds_write_b128 v28, v[92:95] offset:33792
    v_and_b32 v41, 0xffff0000, v26
    v_lshlrev_b32 v42, 16, v27
    v_mfma_f32_32x32x16_bf16 v[104:119], a[212:215], v[224:227], v[104:119]
    ds_write_b128 v29, v[96:99] offset:34816
    v_and_b32 v43, 0xffff0000, v27
    v_mfma_f32_32x32x16_bf16 v[104:119], a[220:223], v[228:231], v[104:119]
    ds_write_b128 v29, v[100:103] offset:35840
    s_nop 10
    ds_write_b128 v28, v[104:107] offset:36864
    ds_write_b128 v28, v[108:111] offset:37888
    ds_write_b128 v29, v[112:115] offset:38912
    ds_write_b128 v29, v[116:119] offset:39936
    ds_read_b32 a255, v0
    ds_read_b32 a255, v0
    s_waitcnt lgkmcnt(2)
    s_add_u32 s59, s59, 8192
    s_waitcnt lgkmcnt(0)
    s_cmp_lt_u32 s36, s44
    s_cbranch_scc1 t5_sp
t5_go:
    s_barrier
    s_mul_i32 s22, s6, 4026531840
    v_or_b32 v12, s22, v12
    buffer_load_dwordx4 v[120:123], v12, s[8:11], s62 offen offset:0 sc1
    ds_read_b128 v[88:91], v30 offset:32768
    ds_read_b128 v[92:95], v30 offset:33792
    ds_read_b128 v[96:99], v30 offset:40960
    ds_read_b128 v[100:103], v30 offset:41984
    ds_read_b128 v[104:107], v30 offset:49152
    ds_read_b128 v[108:111], v30 offset:50176
    ds_read_b128 v[112:115], v30 offset:57344
    ds_read_b128 v[116:119], v30 offset:58368
    buffer_load_dwordx4 v[124:127], v12, s[8:11], s62 offen offset:1024 sc1
    s_waitcnt lgkmcnt(6)
    v_add_f32 v36, v36, v88
    v_add_f32 v37, v37, v89
    v_add_f32 v38, v38, v90
    v_add_f32 v39, v39, v91
    v_add_f32 v40, v40, v92
    v_add_f32 v41, v41, v93
    v_add_f32 v42, v42, v94
    buffer_load_dwordx4 v[128:131], v12, s[8:11], s62 offen offset:2048 sc1
    v_add_f32 v43, v43, v95
    s_waitcnt lgkmcnt(4)
    v_add_f32 v36, v36, v96
    v_add_f32 v37, v37, v97
    v_add_f32 v38, v38, v98
    v_add_f32 v39, v39, v99
    v_add_f32 v40, v40, v100
    v_add_f32 v41, v41, v101
    buffer_load_dwordx4 v[132:135], v12, s[8:11], s62 offen offset:3072 sc1
    s_add_u32 s62, s62, 4096
    v_add_f32 v42, v42, v102
    v_add_f32 v43, v43, v103
    s_waitcnt lgkmcnt(2)
    v_add_f32 v36, v36, v104
    v_add_f32 v37, v37, v105
    v_add_f32 v38, v38, v106
    v_add_f32 v39, v39, v107
    v_add_f32 v40, v40, v108
    v_add_f32 v41, v41, v109
    v_add_f32 v42, v42, v110
    v_add_f32 v43, v43, v111
    s_waitcnt lgkmcnt(0)
    v_add_f32 v36, v36, v112
    v_add_f32 v37, v37, v113
    v_add_f32 v38, v38, v114
    v_add_f32 v39, v39, v115
    buffer_load_dwordx4 v[136:139], v12, s[8:11], s62 offen offset:0 sc1
    v_add_f32 v40, v40, v116
    v_add_f32 v41, v41, v117
    v_add_f32 v42, v42, v118
    v_add_f32 v43, v43, v119
    v_cvt_pk_bf16_f32 v24, v36, v37
    v_cvt_pk_bf16_f32 v25, v38, v39
    v_cvt_pk_bf16_f32 v26, v40, v41
    v_cvt_pk_bf16_f32 v27, v42, v43
    v_mov_b32 v20, v24
    v_mov_b32 v21, v25
    v_mov_b32 v22, v26
    v_mov_b32 v23, v27
    s_nop 0
    v_permlane32_swap_b32 v20, v22
    v_permlane32_swap_b32 v21, v23
    buffer_store_dwordx4 v[20:23], v32, s[28:31], s71 offen offset:0
    s_cmp_lg_u32 s6, 0
    s_cbranch_scc1 L_end
    buffer_load_dwordx4 v[140:143], v12, s[8:11], s62 offen offset:1024 sc1
    v_mul_f32 v44, v36, v36
    v_fmac_f32 v44, v37, v37
    v_fmac_f32 v44, v38, v38
    v_fmac_f32 v44, v39, v39
    v_fmac_f32 v44, v40, v40
    v_fmac_f32 v44, v41, v41
    v_fmac_f32 v44, v42, v42
    v_fmac_f32 v44, v43, v43
    v_add_f32 v36, v36, v40
    v_add_f32 v37, v37, v41
    v_add_f32 v38, v38, v42
    v_add_f32 v39, v39, v43
    buffer_load_dwordx4 v[144:147], v12, s[8:11], s62 offen offset:2048 sc1
    v_add_f32 v36, v36, v38
    v_add_f32 v37, v37, v39
    v_add_f32 v36, v36, v37
    s_nop 1
    v_permlane32_swap_b32 v36, v44
    v_add_f32 v36, v36, v44
    v_mov_b32 v37, v36
    s_nop 1
    v_permlane16_swap_b32 v36, v37
    v_add_f32 v36, v36, v37
    s_nop 1
    v_add_f32_dpp v36, v36, v36 row_ror:8 row_mask:0xf bank_mask:0xf
    buffer_store_dwordx4 v[24:27], v31, s[12:15], s71 offen offset:0 sc1
    buffer_atomic_add_f32 v36, v33, s[12:15], s72 offen offset:1024
    ds_read_b64_tr_b16 a[192:193], v9 offset:0
    ds_read_b64_tr_b16 a[194:195], v9 offset:1024
    ds_read_b64_tr_b16 a[196:197], v10 offset:0
    ds_read_b64_tr_b16 a[198:199], v10 offset:1024
    ds_read_b64_tr_b16 a[200:201], v11 offset:0
    ds_read_b64_tr_b16 a[202:203], v11 offset:512
    ds_read_b64_tr_b16 a[204:205], v9 offset:3072
    ds_read_b64_tr_b16 a[206:207], v9 offset:4096
    ds_read_b64_tr_b16 a[208:209], v10 offset:3072
    ds_read_b64_tr_b16 a[210:211], v10 offset:4096
    ds_read_b64_tr_b16 a[212:213], v11 offset:3072
    ds_read_b64_tr_b16 a[214:215], v11 offset:3584
    s_mov_b32 s6, 1
    s_add_u32 s47, s47, 20054016
    s_add_u32 s12, s12, 20054016
    s_addc_u32 s13, s13, 0
    s_mov_b32 s14, 20054016
    s_mov_b64 s[16:17], s[12:13]
    s_mov_b32 s18, 20054016
    s_waitcnt vmcnt(9)
    s_waitcnt lgkmcnt(6)
    v_mfma_f32_32x32x16_bf16 v[20:35], a[192:195], v[120:123], 0
    ds_read_b64_tr_b16 a[216:217], v9 offset:6144
    ds_read_b64_tr_b16 a[218:219], v9 offset:7168
    buffer_load_dwordx4 v[148:151], v12, s[8:11], s62 offen offset:3072 sc1
    s_add_u32 s62, s62, 4096
    v_mfma_f32_32x32x16_bf16 v[36:51], a[196:199], v[120:123], 0
    ds_read_b64_tr_b16 a[220:221], v10 offset:6144
    ds_read_b64_tr_b16 a[222:223], v10 offset:7168
    v_and_b32 v255, 31, v1
    v_cmp_eq_u32 vcc, 16, v255
    v_mov_b32 v255, 0x3f803f80
    s_nop 0
    v_cndmask_b32 v255, 0, v255, vcc
    v_mfma_f32_32x32x16_bf16 v[52:67], v[120:123], a[200:203], 0
    ds_read_b64_tr_b16 a[224:225], v11 offset:6144
    ds_read_b64_tr_b16 a[226:227], v11 offset:6656
    buffer_load_dwordx4 v[152:155], v12, s[8:11], s62 offen offset:0 sc1
    v_accvgpr_write_b32 a64, v255
    s_waitcnt vmcnt(10)
    s_waitcnt lgkmcnt(6)
    v_mfma_f32_32x32x16_bf16 v[20:35], a[204:207], v[124:127], v[20:35]
    ds_read_b64_tr_b16 a[192:193], v9 offset:9216
    ds_read_b64_tr_b16 a[194:195], v9 offset:10240
    buffer_load_dwordx4 v[156:159], v12, s[8:11], s62 offen offset:1024 sc1
    v_accvgpr_write_b32 a65, v255
    v_accvgpr_write_b32 a66, v255
    v_accvgpr_write_b32 a67, v255
    v_mfma_f32_32x32x16_bf16 v[36:51], a[208:211], v[124:127], v[36:51]
    ds_read_b64_tr_b16 a[196:197], v10 offset:9216
    ds_read_b64_tr_b16 a[198:199], v10 offset:10240
    buffer_load_dwordx4 v[160:163], v12, s[8:11], s62 offen offset:2048 sc1
    v_accvgpr_write_b32 a68, v255
    v_accvgpr_write_b32 a69, v255
    v_mfma_f32_32x32x16_bf16 v[52:67], v[124:127], a[212:215], v[52:67]
    ds_read_b64_tr_b16 a[200:201], v11 offset:9216
    ds_read_b64_tr_b16 a[202:203], v11 offset:9728
    v_accvgpr_write_b32 a70, v255
    v_accvgpr_write_b32 a71, v255
    s_waitcnt vmcnt(11)
    s_waitcnt lgkmcnt(6)
    v_mfma_f32_32x32x16_bf16 v[20:35], a[216:219], v[128:131], v[20:35]
    ds_read_b64_tr_b16 a[204:205], v9 offset:12288
    ds_read_b64_tr_b16 a[206:207], v9 offset:13312
    buffer_load_dwordx4 v[164:167], v12, s[8:11], s62 offen offset:3072 sc1
    s_add_u32 s62, s62, 4096
    v_accvgpr_write_b32 a72, v255
    v_accvgpr_write_b32 a73, v255
    v_mfma_f32_32x32x16_bf16 v[36:51], a[220:223], v[128:131], v[36:51]
    ds_read_b64_tr_b16 a[208:209], v10 offset:12288
    ds_read_b64_tr_b16 a[210:211], v10 offset:13312
    v_accvgpr_write_b32 a74, v255
    v_accvgpr_write_b32 a75, v255
    v_mfma_f32_32x32x16_bf16 v[52:67], v[128:131], a[224:227], v[52:67]
    ds_read_b64_tr_b16 a[212:213], v11 offset:12288
    ds_read_b64_tr_b16 a[214:215], v11 offset:12800
    v_accvgpr_write_b32 a76, v255
    v_accvgpr_write_b32 a77, v255
    s_waitcnt vmcnt(11)
    s_waitcnt lgkmcnt(6)
    v_mfma_f32_32x32x16_bf16 v[20:35], a[192:195], v[132:135], v[20:35]
    ds_read_b64_tr_b16 a[216:217], v9 offset:15360
    ds_read_b64_tr_b16 a[218:219], v9 offset:16384
    buffer_load_dwordx4 v[168:171], v12, s[8:11], s62 offen offset:0 sc1
    v_accvgpr_write_b32 a78, v255
    v_accvgpr_write_b32 a79, v255
    v_mfma_f32_32x32x16_bf16 v[36:51], a[196:199], v[132:135], v[36:51]
    ds_read_b64_tr_b16 a[220:221], v10 offset:15360
    ds_read_b64_tr_b16 a[222:223], v10 offset:16384
    v_accvgpr_write_b32 a80, v255
    v_accvgpr_write_b32 a81, v255
    v_mfma_f32_32x32x16_bf16 v[52:67], v[132:135], a[200:203], v[52:67]
    ds_read_b64_tr_b16 a[224:225], v11 offset:15360
    ds_read_b64_tr_b16 a[226:227], v11 offset:15872
    buffer_load_dwordx4 v[172:175], v12, s[8:11], s62 offen offset:1024 sc1
    v_accvgpr_write_b32 a82, v255
    s_waitcnt vmcnt(12)
    s_waitcnt lgkmcnt(6)
    v_mfma_f32_32x32x16_bf16 v[20:35], a[204:207], v[136:139], v[20:35]
    ds_read_b64_tr_b16 a[192:193], v9 offset:18432
    ds_read_b64_tr_b16 a[194:195], v9 offset:19456
    v_accvgpr_write_b32 a83, v255
    v_accvgpr_write_b32 a84, v255
    v_accvgpr_write_b32 a85, v255
    v_mfma_f32_32x32x16_bf16 v[36:51], a[208:211], v[136:139], v[36:51]
    ds_read_b64_tr_b16 a[196:197], v10 offset:18432
    ds_read_b64_tr_b16 a[198:199], v10 offset:19456
    buffer_load_dwordx4 v[176:179], v12, s[8:11], s62 offen offset:2048 sc1
    v_accvgpr_write_b32 a86, v255
    v_accvgpr_write_b32 a87, v255
    v_mfma_f32_32x32x16_bf16 v[52:67], v[136:139], a[212:215], v[52:67]
    ds_read_b64_tr_b16 a[200:201], v11 offset:18432
    ds_read_b64_tr_b16 a[202:203], v11 offset:18944
    v_accvgpr_write_b32 a88, v255
    v_accvgpr_write_b32 a89, v255
    s_waitcnt vmcnt(11)
    s_waitcnt lgkmcnt(6)
    v_mfma_f32_32x32x16_bf16 v[20:35], a[216:219], v[140:143], v[20:35]
    ds_read_b64_tr_b16 a[204:205], v9 offset:21504
    ds_read_b64_tr_b16 a[206:207], v9 offset:22528
    buffer_load_dwordx4 v[180:183], v12, s[8:11], s62 offen offset:3072 sc1
    s_add_u32 s62, s62, 118784
    v_accvgpr_write_b32 a90, v255
    v_accvgpr_write_b32 a91, v255
    v_mfma_f32_32x32x16_bf16 v[36:51], a[220:223], v[140:143], v[36:51]
    ds_read_b64_tr_b16 a[208:209], v10 offset:21504
    ds_read_b64_tr_b16 a[210:211], v10 offset:22528
    s_lshl_b32 s23, s54, 1
    s_add_u32 s23, s23, s56
    s_mul_i32 s23, s23, 1536
    s_add_u32 s23, s23, 4456448
    v_lshlrev_b32 v7, 3, v1
    v_mfma_f32_32x32x16_bf16 v[52:67], v[140:143], a[224:227], v[52:67]
    ds_read_b64_tr_b16 a[212:213], v11 offset:21504
    ds_read_b64_tr_b16 a[214:215], v11 offset:22016
    v_accvgpr_write_b32 a230, 0
    v_accvgpr_write_b32 a92, v255
    s_waitcnt vmcnt(11)
    s_waitcnt lgkmcnt(6)
    v_mfma_f32_32x32x16_bf16 v[20:35], a[192:195], v[144:147], v[20:35]
    ds_read_b64_tr_b16 a[216:217], v9 offset:24576
    ds_read_b64_tr_b16 a[218:219], v9 offset:25600
    v_accvgpr_write_b32 a93, v255
    v_accvgpr_write_b32 a231, 0
    v_accvgpr_write_b32 a94, v255
    v_accvgpr_write_b32 a95, v255
    v_mfma_f32_32x32x16_bf16 v[36:51], a[196:199], v[144:147], v[36:51]
    ds_read_b64_tr_b16 a[220:221], v10 offset:24576
    ds_read_b64_tr_b16 a[222:223], v10 offset:25600
    v_accvgpr_write_b32 a234, 0
    v_accvgpr_write_b32 a96, v255
    v_accvgpr_write_b32 a97, v255
    v_accvgpr_write_b32 a235, 0
    v_mfma_f32_32x32x16_bf16 v[52:67], v[144:147], a[200:203], v[52:67]
    ds_read_b64_tr_b16 a[224:225], v11 offset:24576
    ds_read_b64_tr_b16 a[226:227], v11 offset:25088
    v_accvgpr_write_b32 a98, v255
    v_accvgpr_write_b32 a99, v255
    s_waitcnt vmcnt(8)
    s_waitcnt lgkmcnt(6)
    v_mfma_f32_32x32x16_bf16 v[20:35], a[204:207], v[148:151], v[20:35]
    ds_read_b64_tr_b16 a[192:193], v9 offset:27648
    ds_read_b64_tr_b16 a[194:195], v9 offset:28672
    v_accvgpr_write_b32 a238, 0
    v_accvgpr_write_b32 a100, v255
    v_accvgpr_write_b32 a101, v255
    v_accvgpr_write_b32 a239, 0
    v_mfma_f32_32x32x16_bf16 v[36:51], a[208:211], v[148:151], v[36:51]
    ds_read_b64_tr_b16 a[196:197], v10 offset:27648
    ds_read_b64_tr_b16 a[198:199], v10 offset:28672
    buffer_load_dword v68, v251, s[12:15], s64 offen offset:0 sc1
    v_accvgpr_write_b32 a102, v255
    v_accvgpr_write_b32 a103, v255
    v_accvgpr_write_b32 a104, v255
    v_mfma_f32_32x32x16_bf16 v[52:67], v[148:151], a[212:215], v[52:67]
    ds_read_b64_tr_b16 a[200:201], v11 offset:27648
    ds_read_b64_tr_b16 a[202:203], v11 offset:28160
    buffer_load_dwordx2 a[228:229], v7, s[8:11], s23 offen offset:0 sc1
    v_accvgpr_write_b32 a105, v255
    s_waitcnt vmcnt(9)
    s_waitcnt lgkmcnt(6)
    v_mfma_f32_32x32x16_bf16 v[20:35], a[216:219], v[152:155], v[20:35]
    ds_read_b64_tr_b16 a[204:205], v9 offset:30720
    ds_read_b64_tr_b16 a[206:207], v9 offset:31744
    buffer_load_dwordx2 a[232:233], v7, s[8:11], s23 offen offset:512 sc1
    v_accvgpr_write_b32 a106, v255
    v_accvgpr_write_b32 a107, v255
    v_accvgpr_write_b32 a108, v255
    v_mfma_f32_32x32x16_bf16 v[36:51], a[220:223], v[152:155], v[36:51]
    ds_read_b64_tr_b16 a[208:209], v10 offset:30720
    ds_read_b64_tr_b16 a[210:211], v10 offset:31744
    s_barrier
    s_cmp_lg_u32 s3, 0
    s_cbranch_scc1 sg21
    s_atomic_add s7, s[8:9], s59
sg21:
    v_mfma_f32_32x32x16_bf16 v[52:67], v[152:155], a[224:227], v[52:67]
    ds_read_b64_tr_b16 a[212:213], v11 offset:30720
    ds_read_b64_tr_b16 a[214:215], v11 offset:31232
    buffer_load_dwordx2 a[236:237], v7, s[8:11], s23 offen offset:1024 sc1
    v_accvgpr_write_b32 a109, v255
    s_waitcnt vmcnt(10)
    s_waitcnt lgkmcnt(6)
    v_mfma_f32_32x32x16_bf16 v[20:35], a[192:195], v[156:159], v[20:35]
    ds_read_b64_tr_b16 a[216:217], v9 offset:33792
    ds_read_b64_tr_b16 a[218:219], v9 offset:34816
    v_accvgpr_write_b32 a110, v255
    v_accvgpr_write_b32 a111, v255
    v_accvgpr_write_b32 a112, v255
    v_accvgpr_write_b32 a113, v255
    v_mfma_f32_32x32x16_bf16 v[36:51], a[196:199], v[156:159], v[36:51]
    ds_read_b64_tr_b16 a[220:221], v10 offset:33792
    ds_read_b64_tr_b16 a[222:223], v10 offset:34816
    v_accvgpr_write_b32 a114, v255
    v_accvgpr_write_b32 a115, v255
    v_accvgpr_write_b32 a116, v255
    v_accvgpr_write_b32 a117, v255
    v_mfma_f32_32x32x16_bf16 v[52:67], v[156:159], a[200:203], v[52:67]
    ds_read_b64_tr_b16 a[224:225], v11 offset:33792
    ds_read_b64_tr_b16 a[226:227], v11 offset:34304
    v_accvgpr_write_b32 a118, v255
    v_accvgpr_write_b32 a119, v255
    s_waitcnt vmcnt(9)
    s_waitcnt lgkmcnt(6)
    v_mfma_f32_32x32x16_bf16 v[20:35], a[204:207], v[160:163], v[20:35]
    ds_read_b64_tr_b16 a[192:193], v9 offset:36864
    ds_read_b64_tr_b16 a[194:195], v9 offset:37888
    v_accvgpr_write_b32 a120, v255
    v_accvgpr_write_b32 a121, v255
    s_waitcnt vmcnt(0)
    v_mov_b32 v69, v68
    v_mfma_f32_32x32x16_bf16 v[36:51], a[208:211], v[160:163], v[36:51]
    ds_read_b64_tr_b16 a[196:197], v10 offset:36864
    ds_read_b64_tr_b16 a[198:199], v10 offset:37888
    v_permlane32_swap_b32 v68, v69
    v_accvgpr_write_b32 a122, v255
    v_accvgpr_write_b32 a123, v255
    v_mfma_f32_32x32x16_bf16 v[52:67], v[160:163], a[212:215], v[52:67]
    ds_read_b64_tr_b16 a[200:201], v11 offset:36864
    ds_read_b64_tr_b16 a[202:203], v11 offset:37376
    v_mul_f32 v68, 0.001953125, v68
    v_mul_f32 v69, 0.001953125, v69
    s_waitcnt lgkmcnt(6)
    v_mfma_f32_32x32x16_bf16 v[20:35], a[216:219], v[164:167], v[20:35]
    ds_read_b64_tr_b16 a[204:205], v9 offset:39936
    ds_read_b64_tr_b16 a[206:207], v9 offset:40960
    s_add_u32 s74, s74, 8192
    s_cmp_lg_u32 s3, 1
    s_cbranch_scc1 pl22
    s_mov_b32 s36, 0
    s_atomic_add s36, s[8:9], s74 glc
pl22:
    v_mfma_f32_32x32x16_bf16 v[36:51], a[220:223], v[164:167], v[36:51]
    ds_read_b64_tr_b16 a[208:209], v10 offset:39936
    ds_read_b64_tr_b16 a[210:211], v10 offset:40960
    v_accvgpr_write_b32 a124, v255
    v_accvgpr_write_b32 a125, v255
    v_accvgpr_write_b32 a126, v255
    v_accvgpr_write_b32 a127, v255
    v_mfma_f32_32x32x16_bf16 v[52:67], v[164:167], a[224:227], v[52:67]
    ds_read_b64_tr_b16 a[212:213], v11 offset:39936
    ds_read_b64_tr_b16 a[214:215], v11 offset:40448
    v_fma_f32 v69, -v68, v68, v69
    v_max_f32 v69, 0, v69
    s_waitcnt lgkmcnt(6)
    v_mfma_f32_32x32x16_bf16 v[20:35], a[192:195], v[168:171], v[20:35]
    ds_read_b64_tr_b16 a[216:217], v9 offset:43008
    ds_read_b64_tr_b16 a[218:219], v9 offset:44032
    v_add_f32 v69, 0x3727c5ac, v69
    v_rsq_f32 v18, v69
    v_mul_f32 v70, 0xbf000000, v68
    v_mfma_f32_32x32x16_bf16 v[36:51], a[196:199], v[168:171], v[36:51]
    ds_read_b64_tr_b16 a[220:221], v10 offset:43008
    ds_read_b64_tr_b16 a[222:223], v10 offset:44032
    v_mov_b32 v118, 0
    v_mov_b32 v119, 0
    v_cvt_pk_bf16_f32 v116, v70, v70
    v_lshlrev_b32 v69, 16, v116
    v_mfma_f32_32x32x16_bf16 v[52:67], v[168:171], a[200:203], v[52:67]
    ds_read_b64_tr_b16 a[224:225], v11 offset:43008
    ds_read_b64_tr_b16 a[226:227], v11 offset:43520
    v_sub_f32 v69, v70, v69
    v_cvt_pk_bf16_f32 v117, v69, v118
    s_waitcnt lgkmcnt(6)
    v_mfma_f32_32x32x16_bf16 v[20:35], a[204:207], v[172:175], v[20:35]
    ds_read_b64_tr_b16 a[192:193], v9 offset:46080
    ds_read_b64_tr_b16 a[194:195], v9 offset:47104
    v_and_b32 v7, 31, v1
    v_sub_u32 v8, v13, v0
    v_lshl_add_u32 v7, v7, 2, v8
    v_mfma_f32_32x32x16_bf16 v[36:51], a[208:211], v[172:175], v[36:51]
    ds_read_b64_tr_b16 a[196:197], v10 offset:46080
    ds_read_b64_tr_b16 a[198:199], v10 offset:47104
    ds_write_b32 v7, v18 offset:7168
    v_lshrrev_b32 v7, 5, v1
    v_lshl_add_u32 v7, v7, 4, v8
    v_mul_f32 v17, s58, v18
    v_mfma_f32_32x32x16_bf16 v[52:67], v[172:175], a[212:215], v[52:67]
    ds_read_b64_tr_b16 a[200:201], v11 offset:46080
    ds_read_b64_tr_b16 a[202:203], v11 offset:46592
    s_waitcnt lgkmcnt(2)
    v_mfma_f32_32x32x16_bf16 v[20:35], a[216:219], v[176:179], v[20:35]
    ds_read_b128 v[120:123], v7 offset:7168
    ds_read_b128 v[124:127], v7 offset:7200
    s_waitcnt lgkmcnt(2)
    v_mfma_f32_32x32x16_bf16 v[20:35], a[192:195], v[180:183], v[20:35]
    v_mfma_f32_32x32x16_bf16 v[20:35], a[228:231], v[116:119], v[20:35]
    s_nop 4
    v_mfma_f32_32x32x16_bf16 v[36:51], a[220:223], v[176:179], v[36:51]
    s_nop 4
    v_mfma_f32_32x32x16_bf16 v[36:51], a[196:199], v[180:183], v[36:51]
    ds_write_b128 v13, v[28:31] offset:0
    v_mfma_f32_32x32x16_bf16 v[36:51], a[232:235], v[116:119], v[36:51]
    ds_write_b128 v13, v[32:35] offset:1024
    s_nop 4
    v_mfma_f32_32x32x16_bf16 v[52:67], v[176:179], a[224:227], v[52:67]
    s_nop 4
    v_mfma_f32_32x32x16_bf16 v[52:67], v[180:183], a[200:203], v[52:67]
    ds_write_b128 v13, v[44:47] offset:2048
    v_mfma_f32_32x32x16_bf16 v[52:67], v[116:119], a[236:239], v[52:67]
    ds_write_b128 v13, v[48:51] offset:3072
    s_nop 10
    ds_write_b128 v13, v[60:63] offset:4096
    ds_write_b128 v13, v[64:67] offset:5120
    ds_read_b32 a255, v0
    ds_read_b32 a255, v0
    s_waitcnt lgkmcnt(2)
    s_waitcnt lgkmcnt(0)
    s_cmp_lt_u32 s36, s44
    s_cbranch_scc1 tq_sp
tq_go:
    s_barrier
    buffer_load_dwordx4 v[184:187], v12, s[8:11], s62 offen offset:0 sc1
    v_xor_b32 v8, 256, v14
    ds_read_b128 v[28:31], v8 offset:0
    ds_read_b128 v[32:35], v8 offset:1024
    ds_read_b128 v[44:47], v8 offset:2048
    ds_read_b128 v[48:51], v8 offset:3072
    ds_read_b128 v[60:63], v14 offset:4096
    ds_read_b128 v[64:67], v14 offset:5120
    s_waitcnt lgkmcnt(4)
    buffer_load_dwordx4 v[188:191], v12, s[8:11], s62 offen offset:1024 sc1
    v_add_f32 v20, v20, v28
    v_add_f32 v21, v21, v29
    v_add_f32 v22, v22, v30
    v_add_f32 v23, v23, v31
    v_add_f32 v24, v24, v32
    v_add_f32 v25, v25, v33
    v_add_f32 v26, v26, v34
    v_add_f32 v27, v27, v35
    buffer_load_dwordx4 v[192:195], v12, s[8:11], s62 offen offset:2048 sc1
    v_mul_f32 v20, v20, v17
    v_mul_f32 v21, v21, v17
    v_mul_f32 v22, v22, v17
    v_mul_f32 v23, v23, v17
    v_mul_f32 v24, v24, v17
    v_mul_f32 v25, v25, v17
    v_mul_f32 v26, v26, v17
    v_mul_f32 v27, v27, v17
    buffer_load_dwordx4 v[196:199], v12, s[8:11], s62 offen offset:3072 sc1
    s_add_u32 s62, s62, 4096
    v_cvt_pk_bf16_f32 v20, v20, v21
    v_cvt_pk_bf16_f32 v21, v22, v23
    v_cvt_pk_bf16_f32 v22, v24, v25
    v_cvt_pk_bf16_f32 v23, v26, v27
    s_waitcnt lgkmcnt(2)
    v_add_f32 v36, v36, v44
    v_add_f32 v37, v37, v45
    v_add_f32 v38, v38, v46
    v_add_f32 v39, v39, v47
    v_add_f32 v40, v40, v48
    v_add_f32 v41, v41, v49
    v_add_f32 v42, v42, v50
    v_add_f32 v43, v43, v51
    v_mul_f32 v36, v36, v17
    v_mul_f32 v37, v37, v17
    v_mul_f32 v38, v38, v17
    buffer_load_dwordx4 v[200:203], v12, s[8:11], s62 offen offset:0 sc1
    v_mul_f32 v39, v39, v17
    v_mul_f32 v40, v40, v17
    v_mul_f32 v41, v41, v17
    v_mul_f32 v42, v42, v17
    v_mul_f32 v43, v43, v17
    v_cvt_pk_bf16_f32 v36, v36, v37
    v_cvt_pk_bf16_f32 v37, v38, v39
    v_cvt_pk_bf16_f32 v38, v40, v41
    buffer_load_dwordx4 v[204:207], v12, s[8:11], s62 offen offset:1024 sc1
    v_cvt_pk_bf16_f32 v39, v42, v43
    s_waitcnt lgkmcnt(0)
    v_add_f32 v52, v52, v60
    v_add_f32 v53, v53, v61
    v_add_f32 v54, v54, v62
    v_add_f32 v55, v55, v63
    v_add_f32 v56, v56, v64
    v_add_f32 v57, v57, v65
    buffer_load_dwordx4 v[208:211], v12, s[8:11], s62 offen offset:2048 sc1
    v_add_f32 v58, v58, v66
    v_add_f32 v59, v59, v67
    v_mul_f32 v52, v52, v120
    v_mul_f32 v53, v53, v121
    v_mul_f32 v54, v54, v122
    v_mul_f32 v55, v55, v123
    v_mul_f32 v56, v56, v124
    buffer_load_dword v136, v251, s[12:15], s64 offen offset:1024 sc1
    v_mul_f32 v57, v57, v125
    v_mul_f32 v58, v58, v126
    v_mul_f32 v59, v59, v127
    v_cvt_pk_bf16_f32 v52, v52, v53
    v_cvt_pk_bf16_f32 v53, v54, v55
    v_cvt_pk_bf16_f32 v54, v56, v57
    v_cvt_pk_bf16_f32 v55, v58, v59
    ds_read_b64_tr_b16 a[192:193], v9 offset:0
    ds_read_b64_tr_b16 a[194:195], v9 offset:1024
    ds_read_b64_tr_b16 a[196:197], v10 offset:0
    ds_read_b64_tr_b16 a[198:199], v10 offset:1024
    ds_read_b64_tr_b16 a[200:201], v11 offset:0
    ds_read_b64_tr_b16 a[202:203], v11 offset:512
    ds_read_b64_tr_b16 a[204:205], v9 offset:3072
    ds_read_b64_tr_b16 a[206:207], v9 offset:4096
    ds_read_b64_tr_b16 a[208:209], v10 offset:3072
    ds_read_b64_tr_b16 a[210:211], v10 offset:4096
    ds_read_b64_tr_b16 a[212:213], v11 offset:3072
    ds_read_b64_tr_b16 a[214:215], v11 offset:3584
    s_waitcnt vmcnt(7)
    s_waitcnt lgkmcnt(6)
    v_mfma_f32_32x32x16_bf16 v[68:83], a[192:195], v[184:187], 0
    ds_read_b64_tr_b16 a[216:217], v9 offset:6144
    ds_read_b64_tr_b16 a[218:219], v9 offset:7168
    s_and_b32 s76, s5, 3
    s_lshl_b32 s79, s4, 2
    s_add_u32 s76, s76, s79
    v_mfma_f32_32x32x16_bf16 v[84:99], a[196:199], v[184:187], 0
    ds_read_b64_tr_b16 a[220:221], v10 offset:6144
    ds_read_b64_tr_b16 a[222:223], v10 offset:7168
    s_lshr_b32 s77, s5, 2
    s_lshl_b32 s79, s76, 16
    v_mfma_f32_32x32x16_bf16 v[100:115], v[184:187], a[200:203], 0
    ds_read_b64_tr_b16 a[224:225], v11 offset:6144
    ds_read_b64_tr_b16 a[226:227], v11 offset:6656
    buffer_load_dwordx4 v[212:215], v12, s[8:11], s62 offen offset:3072 sc1
    s_add_u32 s62, s62, 4096
    s_waitcnt vmcnt(7)
    s_waitcnt lgkmcnt(6)
    v_mfma_f32_32x32x16_bf16 v[68:83], a[204:207], v[188:191], v[68:83]
    ds_read_b64_tr_b16 a[192:193], v9 offset:9216
    ds_read_b64_tr_b16 a[194:195], v9 offset:10240
    s_lshl_b32 s88, s77, 13
    s_add_u32 s78, s79, s88
    s_add_u32 s78, s78, 2228224
    s_lshl_b32 s88, s3, 14
    v_mfma_f32_32x32x16_bf16 v[84:99], a[208:211], v[188:191], v[84:99]
    ds_read_b64_tr_b16 a[196:197], v10 offset:9216
    ds_read_b64_tr_b16 a[198:199], v10 offset:10240
    buffer_load_dwordx4 v[216:219], v12, s[8:11], s62 offen offset:0 sc1
    s_add_u32 s79, s79, s88
    s_add_u32 s80, s79, 4325376
    v_mfma_f32_32x32x16_bf16 v[100:115], v[188:191], a[212:215], v[100:115]
    ds_read_b64_tr_b16 a[200:201], v11 offset:9216
    ds_read_b64_tr_b16 a[202:203], v11 offset:9728
    s_add_u32 s84, s79, 6422528
    s_add_u32 s81, s79, 4333568
    s_waitcnt vmcnt(7)
    s_waitcnt lgkmcnt(6)
    v_mfma_f32_32x32x16_bf16 v[68:83], a[216:219], v[192:195], v[68:83]
    ds_read_b64_tr_b16 a[204:205], v9 offset:12288
    ds_read_b64_tr_b16 a[206:207], v9 offset:13312
    s_add_u32 s85, s79, 6430720
    s_add_u32 s82, s79, 4329472
    v_mfma_f32_32x32x16_bf16 v[84:99], a[220:223], v[192:195], v[84:99]
    ds_read_b64_tr_b16 a[208:209], v10 offset:12288
    ds_read_b64_tr_b16 a[210:211], v10 offset:13312
    buffer_load_dwordx4 v[220:223], v12, s[8:11], s62 offen offset:1024 sc1
    s_add_u32 s86, s79, 6426624
    s_add_u32 s83, s79, 4337664
    v_mfma_f32_32x32x16_bf16 v[100:115], v[192:195], a[224:227], v[100:115]
    ds_read_b64_tr_b16 a[212:213], v11 offset:12288
    ds_read_b64_tr_b16 a[214:215], v11 offset:12800
    s_add_u32 s87, s79, 6434816
    v_lshrrev_b32 v248, 5, v1
    s_waitcnt vmcnt(7)
    s_waitcnt lgkmcnt(6)
    v_mfma_f32_32x32x16_bf16 v[68:83], a[192:195], v[196:199], v[68:83]
    ds_read_b64_tr_b16 a[216:217], v9 offset:15360
    ds_read_b64_tr_b16 a[218:219], v9 offset:16384
    buffer_load_dwordx4 v[224:227], v12, s[8:11], s62 offen offset:2048 sc1
    v_and_b32 v249, 15, v1
    v_lshlrev_b32 v249, 4, v249
    v_mfma_f32_32x32x16_bf16 v[84:99], a[196:199], v[196:199], v[84:99]
    ds_read_b64_tr_b16 a[220:221], v10 offset:15360
    ds_read_b64_tr_b16 a[222:223], v10 offset:16384
    v_lshl_add_u32 v248, v248, 8, v249
    s_lshr_b32 s40, s76, 1
    v_mfma_f32_32x32x16_bf16 v[100:115], v[196:199], a[200:203], v[100:115]
    ds_read_b64_tr_b16 a[224:225], v11 offset:15360
    ds_read_b64_tr_b16 a[226:227], v11 offset:15872
    buffer_load_dwordx4 v[228:231], v12, s[8:11], s62 offen offset:3072 sc1
    s_add_u32 s62, s62, 4096
    s_waitcnt vmcnt(8)
    s_waitcnt lgkmcnt(6)
    v_mfma_f32_32x32x16_bf16 v[68:83], a[204:207], v[200:203], v[68:83]
    ds_read_b64_tr_b16 a[192:193], v9 offset:18432
    ds_read_b64_tr_b16 a[194:195], v9 offset:19456
    s_lshl_b32 s40, s40, 9
    s_add_u32 s40, s40, s47
    v_mfma_f32_32x32x16_bf16 v[84:99], a[208:211], v[200:203], v[84:99]
    ds_read_b64_tr_b16 a[196:197], v10 offset:18432
    ds_read_b64_tr_b16 a[198:199], v10 offset:19456
    buffer_store_dwordx4 v[20:23], v15, s[12:15], s66 offen offset:0 sc1
    s_bfe_u32 s33, s5, 65538
    s_lshl_b32 s33, s33, 7
    s_add_u32 s40, s40, s33
    v_mfma_f32_32x32x16_bf16 v[100:115], v[200:203], a[212:215], v[100:115]
    ds_read_b64_tr_b16 a[200:201], v11 offset:18432
    ds_read_b64_tr_b16 a[202:203], v11 offset:18944
    v_accvgpr_write_b32 a128, v255
    v_accvgpr_write_b32 a129, v255
    s_waitcnt vmcnt(8)
    s_waitcnt lgkmcnt(6)
    v_mfma_f32_32x32x16_bf16 v[68:83], a[216:219], v[204:207], v[68:83]
    ds_read_b64_tr_b16 a[204:205], v9 offset:21504
    ds_read_b64_tr_b16 a[206:207], v9 offset:22528
    v_accvgpr_write_b32 a130, v255
    v_accvgpr_write_b32 a131, v255
    v_accvgpr_write_b32 a132, v255
    v_accvgpr_write_b32 a133, v255
    v_mfma_f32_32x32x16_bf16 v[84:99], a[220:223], v[204:207], v[84:99]
    ds_read_b64_tr_b16 a[208:209], v10 offset:21504
    ds_read_b64_tr_b16 a[210:211], v10 offset:22528
    buffer_store_dwordx4 v[36:39], v15, s[12:15], s67 offen offset:0 sc1
    v_accvgpr_write_b32 a134, v255
    v_accvgpr_write_b32 a135, v255
    v_mfma_f32_32x32x16_bf16 v[100:115], v[204:207], a[224:227], v[100:115]
    ds_read_b64_tr_b16 a[212:213], v11 offset:21504
    ds_read_b64_tr_b16 a[214:215], v11 offset:22016
    v_accvgpr_write_b32 a136, v255
    v_accvgpr_write_b32 a137, v255
    s_waitcnt vmcnt(8)
    s_waitcnt lgkmcnt(6)
    v_mfma_f32_32x32x16_bf16 v[68:83], a[192:195], v[208:211], v[68:83]
    ds_read_b64_tr_b16 a[216:217], v9 offset:24576
    ds_read_b64_tr_b16 a[218:219], v9 offset:25600
    buffer_store_dwordx4 v[52:55], v16, s[12:15], s68 offen offset:0 sc1
    s_add_u32 s66, s66, 4096
    s_add_u32 s67, s67, 4096
    s_add_u32 s68, s68, 4096
    v_mfma_f32_32x32x16_bf16 v[84:99], a[196:199], v[208:211], v[84:99]
    ds_read_b64_tr_b16 a[220:221], v10 offset:24576
    ds_read_b64_tr_b16 a[222:223], v10 offset:25600
    v_accvgpr_write_b32 a138, v255
    v_accvgpr_write_b32 a139, v255
    v_accvgpr_write_b32 a140, v255
    v_accvgpr_write_b32 a141, v255
    v_mfma_f32_32x32x16_bf16 v[100:115], v[208:211], a[200:203], v[100:115]
    ds_read_b64_tr_b16 a[224:225], v11 offset:24576
    ds_read_b64_tr_b16 a[226:227], v11 offset:25088
    s_waitcnt vmcnt(8)
    v_mov_b32 v137, v136
    s_waitcnt vmcnt(7)
    s_waitcnt lgkmcnt(6)
    v_mfma_f32_32x32x16_bf16 v[68:83], a[204:207], v[212:215], v[68:83]
    ds_read_b64_tr_b16 a[192:193], v9 offset:27648
    ds_read_b64_tr_b16 a[194:195], v9 offset:28672
    buffer_load_dwordx4 v[232:235], v12, s[8:11], s62 offen offset:0 sc1
    v_accvgpr_write_b32 a142, v255
    v_accvgpr_write_b32 a143, v255
    v_accvgpr_write_b32 a144, v255
    v_mfma_f32_32x32x16_bf16 v[84:99], a[208:211], v[212:215], v[84:99]
    ds_read_b64_tr_b16 a[196:197], v10 offset:27648
    ds_read_b64_tr_b16 a[198:199], v10 offset:28672
    v_permlane32_swap_b32 v136, v137
    v_accvgpr_write_b32 a145, v255
    v_mul_f32 v136, 0.001953125, v136
    v_mfma_f32_32x32x16_bf16 v[100:115], v[212:215], a[212:215], v[100:115]
    ds_read_b64_tr_b16 a[200:201], v11 offset:27648
    ds_read_b64_tr_b16 a[202:203], v11 offset:28160
    v_accvgpr_write_b32 a146, v255
    v_accvgpr_write_b32 a147, v255
    s_waitcnt vmcnt(7)
    s_waitcnt lgkmcnt(6)
    v_mfma_f32_32x32x16_bf16 v[68:83], a[216:219], v[216:219], v[68:83]
    ds_read_b64_tr_b16 a[204:205], v9 offset:30720
    ds_read_b64_tr_b16 a[206:207], v9 offset:31744
    buffer_load_dwordx4 v[236:239], v12, s[8:11], s62 offen offset:1024 sc1
    v_accvgpr_write_b32 a148, v255
    v_mul_f32 v137, 0.001953125, v137
    v_accvgpr_write_b32 a149, v255
    v_mfma_f32_32x32x16_bf16 v[84:99], a[220:223], v[216:219], v[84:99]
    ds_read_b64_tr_b16 a[208:209], v10 offset:30720
    ds_read_b64_tr_b16 a[210:211], v10 offset:31744
    v_accvgpr_write_b32 a150, v255
    v_fma_f32 v137, -v136, v136, v137
    v_accvgpr_write_b32 a151, v255
    v_accvgpr_write_b32 a152, v255
    v_mfma_f32_32x32x16_bf16 v[100:115], v[216:219], a[224:227], v[100:115]
    ds_read_b64_tr_b16 a[212:213], v11 offset:30720
    ds_read_b64_tr_b16 a[214:215], v11 offset:31232
    buffer_load_dwordx4 v[240:243], v12, s[8:11], s62 offen offset:2048 sc1
    v_max_f32 v137, 0, v137
    s_waitcnt vmcnt(8)
    s_waitcnt lgkmcnt(6)
    v_mfma_f32_32x32x16_bf16 v[68:83], a[192:195], v[220:223], v[68:83]
    ds_read_b64_tr_b16 a[216:217], v9 offset:33792
    ds_read_b64_tr_b16 a[218:219], v9 offset:34816
    v_add_f32 v137, 0x3727c5ac, v137
    v_accvgpr_write_b32 a153, v255
    v_accvgpr_write_b32 a154, v255
    v_accvgpr_write_b32 a155, v255
    v_mfma_f32_32x32x16_bf16 v[84:99], a[196:199], v[220:223], v[84:99]
    ds_read_b64_tr_b16 a[220:221], v10 offset:33792
    ds_read_b64_tr_b16 a[222:223], v10 offset:34816
    buffer_load_dwordx4 v[244:247], v12, s[8:11], s62 offen offset:3072 sc1
    s_add_u32 s62, s62, 118784
    v_rsq_f32 v18, v137
    v_mfma_f32_32x32x16_bf16 v[100:115], v[220:223], a[200:203], v[100:115]
    ds_read_b64_tr_b16 a[224:225], v11 offset:33792
    ds_read_b64_tr_b16 a[226:227], v11 offset:34304
    v_accvgpr_write_b32 a156, v255
    v_mul_f32 v138, 0xbf000000, v136
    s_waitcnt vmcnt(8)
    s_waitcnt lgkmcnt(6)
    v_mfma_f32_32x32x16_bf16 v[68:83], a[204:207], v[224:227], v[68:83]
    ds_read_b64_tr_b16 a[192:193], v9 offset:36864
    ds_read_b64_tr_b16 a[194:195], v9 offset:37888
    v_accvgpr_write_b32 a157, v255
    v_accvgpr_write_b32 a158, v255
    v_mov_b32 v118, 0
    v_accvgpr_write_b32 a159, v255
    v_mfma_f32_32x32x16_bf16 v[84:99], a[208:211], v[224:227], v[84:99]
    ds_read_b64_tr_b16 a[196:197], v10 offset:36864
    ds_read_b64_tr_b16 a[198:199], v10 offset:37888
    v_accvgpr_write_b32 a160, v255
    v_mov_b32 v119, 0
    v_accvgpr_write_b32 a161, v255
    v_accvgpr_write_b32 a162, v255
    v_mfma_f32_32x32x16_bf16 v[100:115], v[224:227], a[212:215], v[100:115]
    ds_read_b64_tr_b16 a[200:201], v11 offset:36864
    ds_read_b64_tr_b16 a[202:203], v11 offset:37376
    v_cvt_pk_bf16_f32 v116, v138, v138
    v_lshlrev_b32 v137, 16, v116
    s_waitcnt vmcnt(7)
    s_waitcnt lgkmcnt(6)
    v_mfma_f32_32x32x16_bf16 v[68:83], a[216:219], v[228:231], v[68:83]
    ds_read_b64_tr_b16 a[204:205], v9 offset:39936
    ds_read_b64_tr_b16 a[206:207], v9 offset:40960
    v_accvgpr_write_b32 a163, v255
    v_accvgpr_write_b32 a164, v255
    v_sub_f32 v137, v138, v137
    v_accvgpr_write_b32 a165, v255
    v_mfma_f32_32x32x16_bf16 v[84:99], a[220:223], v[228:231], v[84:99]
    ds_read_b64_tr_b16 a[208:209], v10 offset:39936
    ds_read_b64_tr_b16 a[210:211], v10 offset:40960
    s_waitcnt vmcnt(4)
    s_barrier
    s_cmp_lg_u32 s3, 0
    s_cbranch_scc1 sg23
    s_atomic_add s7, s[8:9], s69
    s_add_u32 s51, s69, 128
    s_atomic_add s7, s[8:9], s51
    s_atomic_add s7, s[8:9], s41
    s_add_u32 s51, s41, 128
    s_atomic_add s7, s[8:9], s51
    s_add_u32 s51, s41, 512
    s_atomic_add s7, s[8:9], s51
    s_add_u32 s51, s41, 640
    s_atomic_add s7, s[8:9], s51
sg23:
    v_mfma_f32_32x32x16_bf16 v[100:115], v[228:231], a[224:227], v[100:115]
    ds_read_b64_tr_b16 a[212:213], v11 offset:39936
    ds_read_b64_tr_b16 a[214:215], v11 offset:40448
    v_accvgpr_write_b32 a166, v255
    v_cvt_pk_bf16_f32 v117, v137, v118
    s_waitcnt vmcnt(3)
    s_waitcnt lgkmcnt(6)
    v_mfma_f32_32x32x16_bf16 v[68:83], a[192:195], v[232:235], v[68:83]
    ds_read_b64_tr_b16 a[216:217], v9 offset:43008
    ds_read_b64_tr_b16 a[218:219], v9 offset:44032
    v_and_b32 v7, 31, v1
    v_accvgpr_write_b32 a167, v255
    v_accvgpr_write_b32 a168, v255
    v_sub_u32 v8, v13, v0
    v_mfma_f32_32x32x16_bf16 v[84:99], a[196:199], v[232:235], v[84:99]
    ds_read_b64_tr_b16 a[220:221], v10 offset:43008
    ds_read_b64_tr_b16 a[222:223], v10 offset:44032
    v_accvgpr_write_b32 a169, v255
    v_accvgpr_write_b32 a170, v255
    v_accvgpr_write_b32 a171, v255
    v_lshl_add_u32 v7, v7, 2, v8
    v_mfma_f32_32x32x16_bf16 v[100:115], v[232:235], a[200:203], v[100:115]
    ds_read_b64_tr_b16 a[224:225], v11 offset:43008
    ds_read_b64_tr_b16 a[226:227], v11 offset:43520
    v_accvgpr_write_b32 a172, v255
    v_accvgpr_write_b32 a173, v255
    s_waitcnt vmcnt(2)
    s_waitcnt lgkmcnt(6)
    v_mfma_f32_32x32x16_bf16 v[68:83], a[204:207], v[236:239], v[68:83]
    ds_read_b64_tr_b16 a[192:193], v9 offset:46080
    ds_read_b64_tr_b16 a[194:195], v9 offset:47104
    ds_write_b32 v7, v18 offset:7168
    v_lshrrev_b32 v7, 5, v1
    v_accvgpr_write_b32 a174, v255
    v_accvgpr_write_b32 a175, v255
    v_mfma_f32_32x32x16_bf16 v[84:99], a[208:211], v[236:239], v[84:99]
    ds_read_b64_tr_b16 a[196:197], v10 offset:46080
    ds_read_b64_tr_b16 a[198:199], v10 offset:47104
    v_lshl_add_u32 v7, v7, 4, v8
    v_mul_f32 v17, s58, v18
    ds_read_b32 a255, v0
    ds_read_b32 a255, v0
    ds_read_b32 a255, v0
    ds_read_b32 a255, v0
    s_waitcnt lgkmcnt(6)
    v_accvgpr_write_b32 a176, v255
    v_mfma_f32_32x32x16_bf16 v[100:115], v[236:239], a[212:215], v[100:115]
    ds_read_b64_tr_b16 a[200:201], v11 offset:46080
    ds_read_b64_tr_b16 a[202:203], v11 offset:46592
    ds_read_b128 v[128:131], v7 offset:7168
    ds_read_b128 v[132:135], v7 offset:7200
    s_cmp_lg_u32 s3, 1
    s_cbranch_scc1 pl24
    s_mov_b32 s36, 0
    s_atomic_add s36, s[8:9], s40 glc
pl24:
    s_waitcnt vmcnt(0)
    v_mfma_f32_32x32x16_bf16 v[68:83], a[216:219], v[240:243], v[68:83]
    v_accvgpr_write_b32 a177, v255
    v_accvgpr_write_b32 a178, v255
    v_accvgpr_write_b32 a179, v255
    v_accvgpr_write_b32 a180, v255
    v_accvgpr_write_b32 a181, v255
    ds_read_b32 a255, v0
    ds_read_b32 a255, v0
    ds_read_b32 a255, v0
    ds_read_b32 a255, v0
    ds_read_b32 a255, v0
    s_waitcnt lgkmcnt(7)
    v_mfma_f32_32x32x16_bf16 v[68:83], a[192:195], v[244:247], v[68:83]
    v_accvgpr_write_b32 a182, v255
    v_accvgpr_write_b32 a183, v255
    v_accvgpr_write_b32 a184, v255
    v_accvgpr_write_b32 a185, v255
    v_accvgpr_write_b32 a186, v255
    v_mfma_f32_32x32x16_bf16 v[68:83], a[228:231], v[116:119], v[68:83]
    v_accvgpr_write_b32 a187, v255
    v_accvgpr_write_b32 a188, v255
    v_accvgpr_write_b32 a189, v255
    v_accvgpr_write_b32 a190, v255
    v_accvgpr_write_b32 a191, v255
    v_mfma_f32_32x32x16_bf16 v[84:99], a[220:223], v[240:243], v[84:99]
    s_nop 4
    v_mfma_f32_32x32x16_bf16 v[84:99], a[196:199], v[244:247], v[84:99]
    ds_write_b128 v13, v[76:79] offset:0
    v_mfma_f32_32x32x16_bf16 v[84:99], a[232:235], v[116:119], v[84:99]
    ds_write_b128 v13, v[80:83] offset:1024
    s_nop 4
    v_mfma_f32_32x32x16_bf16 v[100:115], v[240:243], a[224:227], v[100:115]
    s_nop 4
    v_mfma_f32_32x32x16_bf16 v[100:115], v[244:247], a[200:203], v[100:115]
    ds_write_b128 v13, v[92:95] offset:2048
    v_mfma_f32_32x32x16_bf16 v[100:115], v[116:119], a[236:239], v[100:115]
    ds_write_b128 v13, v[96:99] offset:3072
    s_nop 10
    ds_write_b128 v13, v[108:111] offset:4096
    ds_write_b128 v13, v[112:115] offset:5120
    ds_read_b32 a255, v0
    ds_read_b32 a255, v0
    ds_read_b32 a255, v0
    ds_read_b32 a255, v0
    ds_read_b32 a255, v0
    ds_read_b32 a255, v0
    ds_read_b32 a255, v0
    s_waitcnt lgkmcnt(7)
    s_waitcnt lgkmcnt(0)
    s_cmp_lt_u32 s36, s42
    s_cbranch_scc1 ta1_sp
ta1_go:
    s_barrier
    buffer_load_dwordx4 v[20:23], v0, s[12:15], s78 offen offset:0 sc1
    v_xor_b32 v8, 256, v14
    ds_read_b128 v[76:79], v8 offset:0
    ds_read_b128 v[80:83], v8 offset:1024
    ds_read_b128 v[92:95], v8 offset:2048
    ds_read_b128 v[96:99], v8 offset:3072
    buffer_load_dwordx4 a[0:3], v0, s[12:15], s80 offen offset:0 sc1
    ds_read_b128 v[108:111], v14 offset:4096
    ds_read_b128 v[112:115], v14 offset:5120
    s_waitcnt lgkmcnt(4)
    v_add_f32 v68, v68, v76
    v_add_f32 v69, v69, v77
    buffer_load_dwordx4 v[24:27], v0, s[12:15], s78 offen offset:1024 sc1
    v_add_f32 v70, v70, v78
    v_add_f32 v71, v71, v79
    v_add_f32 v72, v72, v80
    v_add_f32 v73, v73, v81
    v_add_f32 v74, v74, v82
    s_mov_b64 exec, s[20:21]
    buffer_load_dwordx4 a[64:67], v248, s[12:15], s84 offen offset:0 sc1
    buffer_load_dwordx4 a[68:71], v248, s[12:15], s84 offen offset:512 sc1
    s_mov_b64 exec, -1
    v_add_f32 v75, v75, v83
    v_mul_f32 v68, v68, v17
    v_mul_f32 v69, v69, v17
    v_mul_f32 v70, v70, v17
    v_mul_f32 v71, v71, v17
    v_mul_f32 v72, v72, v17
    v_mul_f32 v73, v73, v17
    v_mul_f32 v74, v74, v17
    v_mul_f32 v75, v75, v17
    v_cvt_pk_bf16_f32 v68, v68, v69
    v_cvt_pk_bf16_f32 v69, v70, v71
    v_cvt_pk_bf16_f32 v70, v72, v73
    v_cvt_pk_bf16_f32 v71, v74, v75
    s_waitcnt lgkmcnt(2)
    v_add_f32 v84, v84, v92
    v_add_f32 v85, v85, v93
    v_add_f32 v86, v86, v94
    v_add_f32 v87, v87, v95
    v_add_f32 v88, v88, v96
    buffer_load_dwordx4 v[172:175], v0, s[12:15], s78 offen offset:2048 sc1
    v_add_f32 v89, v89, v97
    v_add_f32 v90, v90, v98
    v_add_f32 v91, v91, v99
    v_mul_f32 v84, v84, v17
    buffer_load_dwordx4 v[176:179], v0, s[12:15], s78 offen offset:3072 sc1
    v_mul_f32 v85, v85, v17
    v_mul_f32 v86, v86, v17
    v_mul_f32 v87, v87, v17
    v_mul_f32 v88, v88, v17
    v_mul_f32 v89, v89, v17
    buffer_load_dwordx4 a[4:7], v0, s[12:15], s80 offen offset:1024 sc1
    v_mul_f32 v90, v90, v17
    v_mul_f32 v91, v91, v17
    v_cvt_pk_bf16_f32 v84, v84, v85
    v_cvt_pk_bf16_f32 v85, v86, v87
    v_cvt_pk_bf16_f32 v86, v88, v89
    s_mov_b64 exec, s[20:21]
    buffer_load_dwordx4 a[72:75], v248, s[12:15], s84 offen offset:1024 sc1
    buffer_load_dwordx4 a[76:79], v248, s[12:15], s84 offen offset:1536 sc1
    s_mov_b64 exec, -1
    v_cvt_pk_bf16_f32 v87, v90, v91
    s_waitcnt lgkmcnt(0)
    v_add_f32 v100, v100, v108
    v_add_f32 v101, v101, v109
    v_add_f32 v102, v102, v110
    v_add_f32 v103, v103, v111
    v_add_f32 v104, v104, v112
    v_add_f32 v105, v105, v113
    v_add_f32 v106, v106, v114
    v_add_f32 v107, v107, v115
    v_mul_f32 v100, v100, v128
    v_mul_f32 v101, v101, v129
    v_mul_f32 v102, v102, v130
    v_mul_f32 v103, v103, v131
    v_mul_f32 v104, v104, v132
    v_mul_f32 v105, v105, v133
    v_mul_f32 v106, v106, v134
    v_mul_f32 v107, v107, v135
    buffer_load_dwordx4 a[8:11], v0, s[12:15], s80 offen offset:2048 sc1
    v_cvt_pk_bf16_f32 v100, v100, v101
    v_cvt_pk_bf16_f32 v101, v102, v103
    v_cvt_pk_bf16_f32 v102, v104, v105
    v_cvt_pk_bf16_f32 v103, v106, v107
    buffer_store_dwordx4 v[68:71], v15, s[12:15], s66 offen offset:0 sc1
    buffer_store_dwordx4 v[84:87], v15, s[12:15], s67 offen offset:0 sc1
    buffer_store_dwordx4 v[100:103], v16, s[12:15], s68 offen offset:0 sc1
    s_branch L_att
L_end:
    s_endpgm
init_sp:
    s_mov_b32 s33, 0
init_s2:
    s_sleep 2
    buffer_load_dword v5, v2, s[24:27], s32 offen sc1
    s_waitcnt vmcnt(0)
    v_cmp_gt_u32 vcc, s39, v5
    s_cbranch_vccz init_go
    s_add_u32 s33, s33, 1
    s_cmp_lt_u32 s33, 65536
    s_cbranch_scc1 init_s2
    s_branch init_go
ta0_sp:
    s_mov_b32 s33, 0
ta0_s2:
    s_cmp_eq_u32 s3, 1
    s_cselect_b32 s51, s40, s50
    s_mov_b32 s36, 0
    s_atomic_add s36, s[8:9], s51 glc
    s_waitcnt lgkmcnt(0)
    s_cmp_ge_u32 s36, s42
    s_cbranch_scc1 ta0_go
    s_add_u32 s33, s33, 1
    s_cmp_lt_u32 s33, 65536
    s_cbranch_scc1 ta0_s2
    s_branch ta0_go
tb_sp:
    s_mov_b32 s33, 0
tb_s2:
    s_cmp_eq_u32 s3, 1
    s_cselect_b32 s51, s40, s50
    s_mov_b32 s36, 0
    s_atomic_add s36, s[8:9], s51 glc
    s_waitcnt lgkmcnt(0)
    s_cmp_ge_u32 s36, s42
    s_cbranch_scc1 tb_go
    s_add_u32 s33, s33, 1
    s_cmp_lt_u32 s33, 65536
    s_cbranch_scc1 tb_s2
    s_branch tb_go
tc_sp:
    s_mov_b32 s33, 0
tc_s2:
    s_sleep 2
    buffer_load_dword v5, v2, s[8:11], s32 offen sc1
    s_waitcnt vmcnt(0)
    v_cmp_gt_u32 vcc, s39, v5
    s_cbranch_vccz tc_go
    s_add_u32 s33, s33, 1
    s_cmp_lt_u32 s33, 65536
    s_cbranch_scc1 tc_s2
    s_branch tc_go
tw_sp:
    s_mov_b32 s33, 0
tw_s2:
    s_cmp_eq_u32 s3, 1
    s_cselect_b32 s51, s32, s50
    s_mov_b32 s36, 0
    s_atomic_add s36, s[8:9], s51 glc
    s_waitcnt lgkmcnt(0)
    s_cmp_ge_u32 s36, s45
    s_cbranch_scc1 tw_go
    s_add_u32 s33, s33, 1
    s_cmp_lt_u32 s33, 65536
    s_cbranch_scc1 tw_s2
    s_branch tw_go
to_sp:
    s_waitcnt lgkmcnt(0)
    s_mov_b32 s33, s36
    s_mov_b32 s51, s46
    s_max_u32 s33, s33, s51
    s_cmp_ge_u32 s33, s45
    s_cbranch_scc1 to_go
    s_mov_b32 s33, 0
to_s2:
    s_cmp_eq_u32 s3, 1
    s_cselect_b32 s51, s32, s50
    s_mov_b32 s36, 0
    s_atomic_add s36, s[8:9], s51 glc
    s_waitcnt lgkmcnt(0)
    s_cmp_ge_u32 s36, s45
    s_cbranch_scc1 to_go
    s_add_u32 s33, s33, 1
    s_cmp_lt_u32 s33, 65536
    s_cbranch_scc1 to_s2
    s_branch to_go
t1_sp:
    s_mov_b32 s33, 0
t1_s2:
    s_cmp_eq_u32 s3, 1
    s_cselect_b32 s51, s32, s50
    s_mov_b32 s36, 0
    s_atomic_add s36, s[8:9], s51 glc
    s_waitcnt lgkmcnt(0)
    s_cmp_ge_u32 s36, s44
    s_cbranch_scc1 t1_go
    s_add_u32 s33, s33, 1
    s_cmp_lt_u32 s33, 65536
    s_cbranch_scc1 t1_s2
    s_branch t1_go
t2_sp:
    s_waitcnt lgkmcnt(0)
    s_mov_b32 s33, s36
    s_mov_b32 s51, s46
    s_max_u32 s33, s33, s51
    s_cmp_ge_u32 s33, s44
    s_cbranch_scc1 t2_go
    s_mov_b32 s33, 0
t2_s2:
    s_cmp_eq_u32 s3, 1
    s_cselect_b32 s51, s32, s50
    s_mov_b32 s36, 0
    s_atomic_add s36, s[8:9], s51 glc
    s_waitcnt lgkmcnt(0)
    s_cmp_ge_u32 s36, s44
    s_cbranch_scc1 t2_go
    s_add_u32 s33, s33, 1
    s_cmp_lt_u32 s33, 65536
    s_cbranch_scc1 t2_s2
    s_branch t2_go
t3_sp:
    s_mov_b32 s33, 0
t3_s2:
    s_cmp_eq_u32 s3, 1
    s_cselect_b32 s51, s32, s50
    s_mov_b32 s36, 0
    s_atomic_add s36, s[8:9], s51 glc
    s_waitcnt lgkmcnt(0)
    s_cmp_ge_u32 s36, s43
    s_cbranch_scc1 t3_go
    s_add_u32 s33, s33, 1
    s_cmp_lt_u32 s33, 65536
    s_cbranch_scc1 t3_s2
    s_branch t3_go
t4_sp:
    s_mov_b32 s33, 0
t4_s2:
    s_cmp_eq_u32 s3, 1
    s_cselect_b32 s51, s32, s50
    s_mov_b32 s36, 0
    s_atomic_add s36, s[8:9], s51 glc
    s_waitcnt lgkmcnt(0)
    s_cmp_ge_u32 s36, s43
    s_cbranch_scc1 t4_go
    s_add_u32 s33, s33, 1
    s_cmp_lt_u32 s33, 65536
    s_cbranch_scc1 t4_s2
    s_branch t4_go
t5_sp:
    s_mov_b32 s33, 0
t5_s2:
    s_cmp_eq_u32 s3, 1
    s_cselect_b32 s51, s74, s50
    s_mov_b32 s36, 0
    s_atomic_add s36, s[8:9], s51 glc
    s_waitcnt lgkmcnt(0)
    s_cmp_ge_u32 s36, s44
    s_cbranch_scc1 t5_go
    s_add_u32 s33, s33, 1
    s_cmp_lt_u32 s33, 65536
    s_cbranch_scc1 t5_s2
    s_branch t5_go
tq_sp:
    s_mov_b32 s33, 0
tq_s2:
    s_cmp_eq_u32 s3, 1
    s_cselect_b32 s51, s74, s50
    s_mov_b32 s36, 0
    s_atomic_add s36, s[8:9], s51 glc
    s_waitcnt lgkmcnt(0)
    s_cmp_ge_u32 s36, s44
    s_cbranch_scc1 tq_go
    s_add_u32 s33, s33, 1
    s_cmp_lt_u32 s33, 65536
    s_cbranch_scc1 tq_s2
    s_branch tq_go
ta1_sp:
    s_mov_b32 s33, 0
ta1_s2:
    s_cmp_eq_u32 s3, 1
    s_cselect_b32 s51, s40, s50
    s_mov_b32 s36, 0
    s_atomic_add s36, s[8:9], s51 glc
    s_waitcnt lgkmcnt(0)
    s_cmp_ge_u32 s36, s42
    s_cbranch_scc1 ta1_go
    s_add_u32 s33, s33, 1
    s_cmp_lt_u32 s33, 65536
    s_cbranch_scc1 ta1_s2
    s_branch ta1_go
att_slow:
    s_waitcnt vmcnt(0) lgkmcnt(0)
    v_mov_b32 v172, 0x3f803f80
    v_and_b32 v173, 31, v1
    v_cmp_eq_u32 vcc, 16, v173
    s_nop 1
    v_cndmask_b32 v172, 0, v172, vcc
    v_accvgpr_write_b32 a64, v172
    v_accvgpr_write_b32 a65, v172
    v_accvgpr_write_b32 a66, v172
    v_accvgpr_write_b32 a67, v172
    v_accvgpr_write_b32 a68, v172
    v_accvgpr_write_b32 a69, v172
    v_accvgpr_write_b32 a70, v172
    v_accvgpr_write_b32 a71, v172
    v_accvgpr_write_b32 a72, v172
    v_accvgpr_write_b32 a73, v172
    v_accvgpr_write_b32 a74, v172
    v_accvgpr_write_b32 a75, v172
    v_accvgpr_write_b32 a76, v172
    v_accvgpr_write_b32 a77, v172
    v_accvgpr_write_b32 a78, v172
    v_accvgpr_write_b32 a79, v172
    v_accvgpr_write_b32 a80, v172
    v_accvgpr_write_b32 a81, v172
    v_accvgpr_write_b32 a82, v172
    v_accvgpr_write_b32 a83, v172
    v_accvgpr_write_b32 a84, v172
    v_accvgpr_write_b32 a85, v172
    v_accvgpr_write_b32 a86, v172
    v_accvgpr_write_b32 a87, v172
    v_accvgpr_write_b32 a88, v172
    v_accvgpr_write_b32 a89, v172
    v_accvgpr_write_b32 a90, v172
    v_accvgpr_write_b32 a91, v172
    v_accvgpr_write_b32 a92, v172
    v_accvgpr_write_b32 a93, v172
    v_accvgpr_write_b32 a94, v172
    v_accvgpr_write_b32 a95, v172
    v_accvgpr_write_b32 a96, v172
    v_accvgpr_write_b32 a97, v172
    v_accvgpr_write_b32 a98, v172
    v_accvgpr_write_b32 a99, v172
    v_accvgpr_write_b32 a100, v172
    v_accvgpr_write_b32 a101, v172
    v_accvgpr_write_b32 a102, v172
    v_accvgpr_write_b32 a103, v172
    v_accvgpr_write_b32 a104, v172
    v_accvgpr_write_b32 a105, v172
    v_accvgpr_write_b32 a106, v172
    v_accvgpr_write_b32 a107, v172
    v_accvgpr_write_b32 a108, v172
    v_accvgpr_write_b32 a109, v172
    v_accvgpr_write_b32 a110, v172
    v_accvgpr_write_b32 a111, v172
    v_accvgpr_write_b32 a112, v172
    v_accvgpr_write_b32 a113, v172
    v_accvgpr_write_b32 a114, v172
    v_accvgpr_write_b32 a115, v172
    v_accvgpr_write_b32 a116, v172
    v_accvgpr_write_b32 a117, v172
    v_accvgpr_write_b32 a118, v172
    v_accvgpr_write_b32 a119, v172
    v_accvgpr_write_b32 a120, v172
    v_accvgpr_write_b32 a121, v172
    v_accvgpr_write_b32 a122, v172
    v_accvgpr_write_b32 a123, v172
    v_accvgpr_write_b32 a124, v172
    v_accvgpr_write_b32 a125, v172
    v_accvgpr_write_b32 a126, v172
    v_accvgpr_write_b32 a127, v172
    v_accvgpr_write_b32 a128, v172
    v_accvgpr_write_b32 a129, v172
    v_accvgpr_write_b32 a130, v172
    v_accvgpr_write_b32 a131, v172
    v_accvgpr_write_b32 a132, v172
    v_accvgpr_write_b32 a133, v172
    v_accvgpr_write_b32 a134, v172
    v_accvgpr_write_b32 a135, v172
    v_accvgpr_write_b32 a136, v172
    v_accvgpr_write_b32 a137, v172
    v_accvgpr_write_b32 a138, v172
    v_accvgpr_write_b32 a139, v172
    v_accvgpr_write_b32 a140, v172
    v_accvgpr_write_b32 a141, v172
    v_accvgpr_write_b32 a142, v172
    v_accvgpr_write_b32 a143, v172
    v_accvgpr_write_b32 a144, v172
    v_accvgpr_write_b32 a145, v172
    v_accvgpr_write_b32 a146, v172
    v_accvgpr_write_b32 a147, v172
    v_accvgpr_write_b32 a148, v172
    v_accvgpr_write_b32 a149, v172
    v_accvgpr_write_b32 a150, v172
    v_accvgpr_write_b32 a151, v172
    v_accvgpr_write_b32 a152, v172
    v_accvgpr_write_b32 a153, v172
    v_accvgpr_write_b32 a154, v172
    v_accvgpr_write_b32 a155, v172
    v_accvgpr_write_b32 a156, v172
    v_accvgpr_write_b32 a157, v172
    v_accvgpr_write_b32 a158, v172
    v_accvgpr_write_b32 a159, v172
    v_accvgpr_write_b32 a160, v172
    v_accvgpr_write_b32 a161, v172
    v_accvgpr_write_b32 a162, v172
    v_accvgpr_write_b32 a163, v172
    v_accvgpr_write_b32 a164, v172
    v_accvgpr_write_b32 a165, v172
    v_accvgpr_write_b32 a166, v172
    v_accvgpr_write_b32 a167, v172
    v_accvgpr_write_b32 a168, v172
    v_accvgpr_write_b32 a169, v172
    v_accvgpr_write_b32 a170, v172
    v_accvgpr_write_b32 a171, v172
    v_accvgpr_write_b32 a172, v172
    v_accvgpr_write_b32 a173, v172
    v_accvgpr_write_b32 a174, v172
    v_accvgpr_write_b32 a175, v172
    v_accvgpr_write_b32 a176, v172
    v_accvgpr_write_b32 a177, v172
    v_accvgpr_write_b32 a178, v172
    v_accvgpr_write_b32 a179, v172
    v_accvgpr_write_b32 a180, v172
    v_accvgpr_write_b32 a181, v172
    v_accvgpr_write_b32 a182, v172
    v_accvgpr_write_b32 a183, v172
    v_accvgpr_write_b32 a184, v172
    v_accvgpr_write_b32 a185, v172
    v_accvgpr_write_b32 a186, v172
    v_accvgpr_write_b32 a187, v172
    v_accvgpr_write_b32 a188, v172
    v_accvgpr_write_b32 a189, v172
    v_accvgpr_write_b32 a190, v172
    v_accvgpr_write_b32 a191, v172
    buffer_load_dwordx4 a[0:3], v0, s[12:15], s80 offen offset:0 sc1
    s_mov_b64 exec, s[20:21]
    buffer_load_dwordx4 a[64:67], v248, s[12:15], s84 offen offset:0 sc1
    buffer_load_dwordx4 a[68:71], v248, s[12:15], s84 offen offset:512 sc1
    s_mov_b64 exec, -1
    buffer_load_dwordx4 a[4:7], v0, s[12:15], s80 offen offset:1024 sc1
    s_mov_b64 exec, s[20:21]
    buffer_load_dwordx4 a[72:75], v248, s[12:15], s84 offen offset:1024 sc1
    buffer_load_dwordx4 a[76:79], v248, s[12:15], s84 offen offset:1536 sc1
    s_mov_b64 exec, -1
    buffer_load_dwordx4 a[8:11], v0, s[12:15], s80 offen offset:2048 sc1
    s_mov_b64 exec, s[20:21]
    buffer_load_dwordx4 a[80:83], v248, s[12:15], s84 offen offset:2048 sc1
    buffer_load_dwordx4 a[84:87], v248, s[12:15], s84 offen offset:2560 sc1
    s_mov_b64 exec, -1
    buffer_load_dwordx4 a[12:15], v0, s[12:15], s80 offen offset:3072 sc1
    s_mov_b64 exec, s[20:21]
    buffer_load_dwordx4 a[88:91], v248, s[12:15], s84 offen offset:3072 sc1
    buffer_load_dwordx4 a[92:95], v248, s[12:15], s84 offen offset:3584 sc1
    s_mov_b64 exec, -1
    buffer_load_dwordx4 a[16:19], v0, s[12:15], s81 offen offset:0 sc1
    s_mov_b64 exec, s[20:21]
    buffer_load_dwordx4 a[96:99], v248, s[12:15], s85 offen offset:0 sc1
    buffer_load_dwordx4 a[100:103], v248, s[12:15], s85 offen offset:512 sc1
    s_mov_b64 exec, -1
    buffer_load_dwordx4 a[20:23], v0, s[12:15], s81 offen offset:1024 sc1
    s_mov_b64 exec, s[20:21]
    buffer_load_dwordx4 a[104:107], v248, s[12:15], s85 offen offset:1024 sc1
    buffer_load_dwordx4 a[108:111], v248, s[12:15], s85 offen offset:1536 sc1
    s_mov_b64 exec, -1
    buffer_load_dwordx4 a[24:27], v0, s[12:15], s81 offen offset:2048 sc1
    s_mov_b64 exec, s[20:21]
    buffer_load_dwordx4 a[112:115], v248, s[12:15], s85 offen offset:2048 sc1
    buffer_load_dwordx4 a[116:119], v248, s[12:15], s85 offen offset:2560 sc1
    s_mov_b64 exec, -1
    buffer_load_dwordx4 a[28:31], v0, s[12:15], s81 offen offset:3072 sc1
    s_mov_b64 exec, s[20:21]
    buffer_load_dwordx4 a[120:123], v248, s[12:15], s85 offen offset:3072 sc1
    buffer_load_dwordx4 a[124:127], v248, s[12:15], s85 offen offset:3584 sc1
    s_mov_b64 exec, -1
    buffer_load_dwordx4 a[32:35], v0, s[12:15], s82 offen offset:0 sc1
    s_mov_b64 exec, s[20:21]
    buffer_load_dwordx4 a[128:131], v248, s[12:15], s86 offen offset:0 sc1
    buffer_load_dwordx4 a[132:135], v248, s[12:15], s86 offen offset:512 sc1
    s_mov_b64 exec, -1
    buffer_load_dwordx4 a[36:39], v0, s[12:15], s82 offen offset:1024 sc1
    s_mov_b64 exec, s[20:21]
    buffer_load_dwordx4 a[136:139], v248, s[12:15], s86 offen offset:1024 sc1
    buffer_load_dwordx4 a[140:143], v248, s[12:15], s86 offen offset:1536 sc1
    s_mov_b64 exec, -1
    buffer_load_dwordx4 a[40:43], v0, s[12:15], s82 offen offset:2048 sc1
    s_mov_b64 exec, s[20:21]
    buffer_load_dwordx4 a[144:147], v248, s[12:15], s86 offen offset:2048 sc1
    buffer_load_dwordx4 a[148:151], v248, s[12:15], s86 offen offset:2560 sc1
    s_mov_b64 exec, -1
    buffer_load_dwordx4 a[44:47], v0, s[12:15], s82 offen offset:3072 sc1
    s_mov_b64 exec, s[20:21]
    buffer_load_dwordx4 a[152:155], v248, s[12:15], s86 offen offset:3072 sc1
    buffer_load_dwordx4 a[156:159], v248, s[12:15], s86 offen offset:3584 sc1
    s_mov_b64 exec, -1
    buffer_load_dwordx4 a[48:51], v0, s[12:15], s83 offen offset:0 sc1
    s_mov_b64 exec, s[20:21]
    buffer_load_dwordx4 a[160:163], v248, s[12:15], s87 offen offset:0 sc1
    buffer_load_dwordx4 a[164:167], v248, s[12:15], s87 offen offset:512 sc1
    s_mov_b64 exec, -1
    buffer_load_dwordx4 a[52:55], v0, s[12:15], s83 offen offset:1024 sc1
    s_mov_b64 exec, s[20:21]
    buffer_load_dwordx4 a[168:171], v248, s[12:15], s87 offen offset:1024 sc1
    buffer_load_dwordx4 a[172:175], v248, s[12:15], s87 offen offset:1536 sc1
    s_mov_b64 exec, -1
    buffer_load_dwordx4 a[56:59], v0, s[12:15], s83 offen offset:2048 sc1
    s_mov_b64 exec, s[20:21]
    buffer_load_dwordx4 a[176:179], v248, s[12:15], s87 offen offset:2048 sc1
    buffer_load_dwordx4 a[180:183], v248, s[12:15], s87 offen offset:2560 sc1
    s_mov_b64 exec, -1
    buffer_load_dwordx4 a[60:63], v0, s[12:15], s83 offen offset:3072 sc1
    s_mov_b64 exec, s[20:21]
    buffer_load_dwordx4 a[184:187], v248, s[12:15], s87 offen offset:3072 sc1
    buffer_load_dwordx4 a[188:191], v248, s[12:15], s87 offen offset:3584 sc1
    s_mov_b64 exec, -1
    v_mov_b32 v172, 0xff800000
    v_lshlrev_b32 v173, 2, v1
    v_add_u32 v173, 135168, v173
    ds_write_b32 v173, v172
    ds_write_b32 v173, v172 offset:256
    s_waitcnt lgkmcnt(0)
    s_barrier
    s_lshl_b32 s22, s79, 12
    s_add_u32 s96, s78, s22
    s_mov_b32 s97, 0
    v_and_b32 v173, 31, v1
    v_lshlrev_b32 v173, 2, v173
    v_add_u32 v173, 135168, v173
att_s1:
    buffer_load_dwordx4 v[120:123], v0, s[12:15], s96 offen offset:0 sc1
    v_mov_b32 v172, 0xff800000
    s_waitcnt vmcnt(0)
    v_mfma_f32_32x32x16_bf16 v[124:139], a[0:3], v[120:123], 0
    s_nop 11
    v_max3_f32 v172, v172, v124, v125
    v_max3_f32 v172, v172, v126, v127
    v_max3_f32 v172, v172, v128, v129
    v_max3_f32 v172, v172, v130, v131
    v_max3_f32 v172, v172, v132, v133
    v_max3_f32 v172, v172, v134, v135
    v_max3_f32 v172, v172, v136, v137
    v_max3_f32 v172, v172, v138, v139
    v_mfma_f32_32x32x16_bf16 v[124:139], a[4:7], v[120:123], 0
    s_nop 11
    v_max3_f32 v172, v172, v124, v125
    v_max3_f32 v172, v172, v126, v127
    v_max3_f32 v172, v172, v128, v129
    v_max3_f32 v172, v172, v130, v131
    v_max3_f32 v172, v172, v132, v133
    v_max3_f32 v172, v172, v134, v135
    v_max3_f32 v172, v172, v136, v137
    v_max3_f32 v172, v172, v138, v139
    v_mfma_f32_32x32x16_bf16 v[124:139], a[8:11], v[120:123], 0
    s_nop 11
    v_max3_f32 v172, v172, v124, v125
    v_max3_f32 v172, v172, v126, v127
    v_max3_f32 v172, v172, v128, v129
    v_max3_f32 v172, v172, v130, v131
    v_max3_f32 v172, v172, v132, v133
    v_max3_f32 v172, v172, v134, v135
    v_max3_f32 v172, v172, v136, v137
    v_max3_f32 v172, v172, v138, v139
    v_mfma_f32_32x32x16_bf16 v[124:139], a[12:15], v[120:123], 0
    s_nop 11
    v_max3_f32 v172, v172, v124, v125
    v_max3_f32 v172, v172, v126, v127
    v_max3_f32 v172, v172, v128, v129
    v_max3_f32 v172, v172, v130, v131
    v_max3_f32 v172, v172, v132, v133
    v_max3_f32 v172, v172, v134, v135
    v_max3_f32 v172, v172, v136, v137
    v_max3_f32 v172, v172, v138, v139
    v_mfma_f32_32x32x16_bf16 v[124:139], a[16:19], v[120:123], 0
    s_nop 11
    v_max3_f32 v172, v172, v124, v125
    v_max3_f32 v172, v172, v126, v127
    v_max3_f32 v172, v172, v128, v129
    v_max3_f32 v172, v172, v130, v131
    v_max3_f32 v172, v172, v132, v133
    v_max3_f32 v172, v172, v134, v135
    v_max3_f32 v172, v172, v136, v137
    v_max3_f32 v172, v172, v138, v139
    v_mfma_f32_32x32x16_bf16 v[124:139], a[20:23], v[120:123], 0
    s_nop 11
    v_max3_f32 v172, v172, v124, v125
    v_max3_f32 v172, v172, v126, v127
    v_max3_f32 v172, v172, v128, v129
    v_max3_f32 v172, v172, v130, v131
    v_max3_f32 v172, v172, v132, v133
    v_max3_f32 v172, v172, v134, v135
    v_max3_f32 v172, v172, v136, v137
    v_max3_f32 v172, v172, v138, v139
    v_mfma_f32_32x32x16_bf16 v[124:139], a[24:27], v[120:123], 0
    s_nop 11
    v_max3_f32 v172, v172, v124, v125
    v_max3_f32 v172, v172, v126, v127
    v_max3_f32 v172, v172, v128, v129
    v_max3_f32 v172, v172, v130, v131
    v_max3_f32 v172, v172, v132, v133
    v_max3_f32 v172, v172, v134, v135
    v_max3_f32 v172, v172, v136, v137
    v_max3_f32 v172, v172, v138, v139
    v_mfma_f32_32x32x16_bf16 v[124:139], a[28:31], v[120:123], 0
    s_nop 11
    v_max3_f32 v172, v172, v124, v125
    v_max3_f32 v172, v172, v126, v127
    v_max3_f32 v172, v172, v128, v129
    v_max3_f32 v172, v172, v130, v131
    v_max3_f32 v172, v172, v132, v133
    v_max3_f32 v172, v172, v134, v135
    v_max3_f32 v172, v172, v136, v137
    v_max3_f32 v172, v172, v138, v139
    v_mfma_f32_32x32x16_bf16 v[124:139], a[32:35], v[120:123], 0
    s_nop 11
    v_max3_f32 v172, v172, v124, v125
    v_max3_f32 v172, v172, v126, v127
    v_max3_f32 v172, v172, v128, v129
    v_max3_f32 v172, v172, v130, v131
    v_max3_f32 v172, v172, v132, v133
    v_max3_f32 v172, v172, v134, v135
    v_max3_f32 v172, v172, v136, v137
    v_max3_f32 v172, v172, v138, v139
    v_mfma_f32_32x32x16_bf16 v[124:139], a[36:39], v[120:123], 0
    s_nop 11
    v_max3_f32 v172, v172, v124, v125
    v_max3_f32 v172, v172, v126, v127
    v_max3_f32 v172, v172, v128, v129
    v_max3_f32 v172, v172, v130, v131
    v_max3_f32 v172, v172, v132, v133
    v_max3_f32 v172, v172, v134, v135
    v_max3_f32 v172, v172, v136, v137
    v_max3_f32 v172, v172, v138, v139
    v_mfma_f32_32x32x16_bf16 v[124:139], a[40:43], v[120:123], 0
    s_nop 11
    v_max3_f32 v172, v172, v124, v125
    v_max3_f32 v172, v172, v126, v127
    v_max3_f32 v172, v172, v128, v129
    v_max3_f32 v172, v172, v130, v131
    v_max3_f32 v172, v172, v132, v133
    v_max3_f32 v172, v172, v134, v135
    v_max3_f32 v172, v172, v136, v137
    v_max3_f32 v172, v172, v138, v139
    v_mfma_f32_32x32x16_bf16 v[124:139], a[44:47], v[120:123], 0
    s_nop 11
    v_max3_f32 v172, v172, v124, v125
    v_max3_f32 v172, v172, v126, v127
    v_max3_f32 v172, v172, v128, v129
    v_max3_f32 v172, v172, v130, v131
    v_max3_f32 v172, v172, v132, v133
    v_max3_f32 v172, v172, v134, v135
    v_max3_f32 v172, v172, v136, v137
    v_max3_f32 v172, v172, v138, v139
    v_mfma_f32_32x32x16_bf16 v[124:139], a[48:51], v[120:123], 0
    s_nop 11
    v_max3_f32 v172, v172, v124, v125
    v_max3_f32 v172, v172, v126, v127
    v_max3_f32 v172, v172, v128, v129
    v_max3_f32 v172, v172, v130, v131
    v_max3_f32 v172, v172, v132, v133
    v_max3_f32 v172, v172, v134, v135
    v_max3_f32 v172, v172, v136, v137
    v_max3_f32 v172, v172, v138, v139
    v_mfma_f32_32x32x16_bf16 v[124:139], a[52:55], v[120:123], 0
    s_nop 11
    v_max3_f32 v172, v172, v124, v125
    v_max3_f32 v172, v172, v126, v127
    v_max3_f32 v172, v172, v128, v129
    v_max3_f32 v172, v172, v130, v131
    v_max3_f32 v172, v172, v132, v133
    v_max3_f32 v172, v172, v134, v135
    v_max3_f32 v172, v172, v136, v137
    v_max3_f32 v172, v172, v138, v139
    v_mfma_f32_32x32x16_bf16 v[124:139], a[56:59], v[120:123], 0
    s_nop 11
    v_max3_f32 v172, v172, v124, v125
    v_max3_f32 v172, v172, v126, v127
    v_max3_f32 v172, v172, v128, v129
    v_max3_f32 v172, v172, v130, v131
    v_max3_f32 v172, v172, v132, v133
    v_max3_f32 v172, v172, v134, v135
    v_max3_f32 v172, v172, v136, v137
    v_max3_f32 v172, v172, v138, v139
    v_mfma_f32_32x32x16_bf16 v[124:139], a[60:63], v[120:123], 0
    s_nop 11
    v_max3_f32 v172, v172, v124, v125
    v_max3_f32 v172, v172, v126, v127
    v_max3_f32 v172, v172, v128, v129
    v_max3_f32 v172, v172, v130, v131
    v_max3_f32 v172, v172, v132, v133
    v_max3_f32 v172, v172, v134, v135
    v_max3_f32 v172, v172, v136, v137
    v_max3_f32 v172, v172, v138, v139
    ds_max_f32 v173, v172
    v_add_u32 v173, 128, v173
    s_add_u32 s96, s96, 1024
    s_add_u32 s97, s97, 1
    s_cmp_lt_u32 s97, 4
    s_cbranch_scc1 att_s1
    s_waitcnt lgkmcnt(0)
    s_barrier
    s_sub_u32 s96, s96, 4096
    s_mov_b32 s97, 0
    v_subrev_u32 v173, 512, v173
    v_mov_b32 v174, v10
    v_mov_b32 v175, v11
att_s2:
    buffer_load_dwordx4 v[120:123], v0, s[12:15], s96 offen offset:0 sc1
    ds_read_b32 v172, v173
    s_waitcnt vmcnt(0) lgkmcnt(0)
    v_sub_f32 v156, 0, v172
    v_sub_f32 v157, 0, v172
    v_sub_f32 v158, 0, v172
    v_sub_f32 v159, 0, v172
    v_sub_f32 v160, 0, v172
    v_sub_f32 v161, 0, v172
    v_sub_f32 v162, 0, v172
    v_sub_f32 v163, 0, v172
    v_sub_f32 v164, 0, v172
    v_sub_f32 v165, 0, v172
    v_sub_f32 v166, 0, v172
    v_sub_f32 v167, 0, v172
    v_sub_f32 v168, 0, v172
    v_sub_f32 v169, 0, v172
    v_sub_f32 v170, 0, v172
    v_sub_f32 v171, 0, v172
    v_mfma_f32_32x32x8_bf16 v[140:155], v[14:15], v[14:15], 0
    s_nop 0
    v_mfma_f32_32x32x16_bf16 v[124:139], a[0:3], v[120:123], v[156:171]
    s_nop 11
    v_exp_f32 v124, v124
    v_exp_f32 v125, v125
    v_exp_f32 v126, v126
    v_exp_f32 v127, v127
    v_exp_f32 v128, v128
    v_exp_f32 v129, v129
    v_exp_f32 v130, v130
    v_exp_f32 v131, v131
    v_exp_f32 v132, v132
    v_exp_f32 v133, v133
    v_exp_f32 v134, v134
    v_exp_f32 v135, v135
    v_exp_f32 v136, v136
    v_exp_f32 v137, v137
    v_exp_f32 v138, v138
    v_exp_f32 v139, v139
    v_smfmac_f32_32x32x32_bf16 v[140:155], a[64:67], v[124:131], v9
    s_nop 0
    v_smfmac_f32_32x32x32_bf16 v[140:155], a[68:71], v[132:139], v9
    v_mfma_f32_32x32x16_bf16 v[124:139], a[4:7], v[120:123], v[156:171]
    s_nop 11
    v_exp_f32 v124, v124
    v_exp_f32 v125, v125
    v_exp_f32 v126, v126
    v_exp_f32 v127, v127
    v_exp_f32 v128, v128
    v_exp_f32 v129, v129
    v_exp_f32 v130, v130
    v_exp_f32 v131, v131
    v_exp_f32 v132, v132
    v_exp_f32 v133, v133
    v_exp_f32 v134, v134
    v_exp_f32 v135, v135
    v_exp_f32 v136, v136
    v_exp_f32 v137, v137
    v_exp_f32 v138, v138
    v_exp_f32 v139, v139
    v_smfmac_f32_32x32x32_bf16 v[140:155], a[72:75], v[124:131], v9
    s_nop 0
    v_smfmac_f32_32x32x32_bf16 v[140:155], a[76:79], v[132:139], v9
    v_mfma_f32_32x32x16_bf16 v[124:139], a[8:11], v[120:123], v[156:171]
    s_nop 11
    v_exp_f32 v124, v124
    v_exp_f32 v125, v125
    v_exp_f32 v126, v126
    v_exp_f32 v127, v127
    v_exp_f32 v128, v128
    v_exp_f32 v129, v129
    v_exp_f32 v130, v130
    v_exp_f32 v131, v131
    v_exp_f32 v132, v132
    v_exp_f32 v133, v133
    v_exp_f32 v134, v134
    v_exp_f32 v135, v135
    v_exp_f32 v136, v136
    v_exp_f32 v137, v137
    v_exp_f32 v138, v138
    v_exp_f32 v139, v139
    v_smfmac_f32_32x32x32_bf16 v[140:155], a[80:83], v[124:131], v9
    s_nop 0
    v_smfmac_f32_32x32x32_bf16 v[140:155], a[84:87], v[132:139], v9
    v_mfma_f32_32x32x16_bf16 v[124:139], a[12:15], v[120:123], v[156:171]
    s_nop 11
    v_exp_f32 v124, v124
    v_exp_f32 v125, v125
    v_exp_f32 v126, v126
    v_exp_f32 v127, v127
    v_exp_f32 v128, v128
    v_exp_f32 v129, v129
    v_exp_f32 v130, v130
    v_exp_f32 v131, v131
    v_exp_f32 v132, v132
    v_exp_f32 v133, v133
    v_exp_f32 v134, v134
    v_exp_f32 v135, v135
    v_exp_f32 v136, v136
    v_exp_f32 v137, v137
    v_exp_f32 v138, v138
    v_exp_f32 v139, v139
    v_smfmac_f32_32x32x32_bf16 v[140:155], a[88:91], v[124:131], v9
    s_nop 0
    v_smfmac_f32_32x32x32_bf16 v[140:155], a[92:95], v[132:139], v9
    v_mfma_f32_32x32x16_bf16 v[124:139], a[16:19], v[120:123], v[156:171]
    s_nop 11
    v_exp_f32 v124, v124
    v_exp_f32 v125, v125
    v_exp_f32 v126, v126
    v_exp_f32 v127, v127
    v_exp_f32 v128, v128
    v_exp_f32 v129, v129
    v_exp_f32 v130, v130
    v_exp_f32 v131, v131
    v_exp_f32 v132, v132
    v_exp_f32 v133, v133
    v_exp_f32 v134, v134
    v_exp_f32 v135, v135
    v_exp_f32 v136, v136
    v_exp_f32 v137, v137
    v_exp_f32 v138, v138
    v_exp_f32 v139, v139
    v_smfmac_f32_32x32x32_bf16 v[140:155], a[96:99], v[124:131], v9
    s_nop 0
    v_smfmac_f32_32x32x32_bf16 v[140:155], a[100:103], v[132:139], v9
    v_mfma_f32_32x32x16_bf16 v[124:139], a[20:23], v[120:123], v[156:171]
    s_nop 11
    v_exp_f32 v124, v124
    v_exp_f32 v125, v125
    v_exp_f32 v126, v126
    v_exp_f32 v127, v127
    v_exp_f32 v128, v128
    v_exp_f32 v129, v129
    v_exp_f32 v130, v130
    v_exp_f32 v131, v131
    v_exp_f32 v132, v132
    v_exp_f32 v133, v133
    v_exp_f32 v134, v134
    v_exp_f32 v135, v135
    v_exp_f32 v136, v136
    v_exp_f32 v137, v137
    v_exp_f32 v138, v138
    v_exp_f32 v139, v139
    v_smfmac_f32_32x32x32_bf16 v[140:155], a[104:107], v[124:131], v9
    s_nop 0
    v_smfmac_f32_32x32x32_bf16 v[140:155], a[108:111], v[132:139], v9
    v_mfma_f32_32x32x16_bf16 v[124:139], a[24:27], v[120:123], v[156:171]
    s_nop 11
    v_exp_f32 v124, v124
    v_exp_f32 v125, v125
    v_exp_f32 v126, v126
    v_exp_f32 v127, v127
    v_exp_f32 v128, v128
    v_exp_f32 v129, v129
    v_exp_f32 v130, v130
    v_exp_f32 v131, v131
    v_exp_f32 v132, v132
    v_exp_f32 v133, v133
    v_exp_f32 v134, v134
    v_exp_f32 v135, v135
    v_exp_f32 v136, v136
    v_exp_f32 v137, v137
    v_exp_f32 v138, v138
    v_exp_f32 v139, v139
    v_smfmac_f32_32x32x32_bf16 v[140:155], a[112:115], v[124:131], v9
    s_nop 0
    v_smfmac_f32_32x32x32_bf16 v[140:155], a[116:119], v[132:139], v9
    v_mfma_f32_32x32x16_bf16 v[124:139], a[28:31], v[120:123], v[156:171]
    s_nop 11
    v_exp_f32 v124, v124
    v_exp_f32 v125, v125
    v_exp_f32 v126, v126
    v_exp_f32 v127, v127
    v_exp_f32 v128, v128
    v_exp_f32 v129, v129
    v_exp_f32 v130, v130
    v_exp_f32 v131, v131
    v_exp_f32 v132, v132
    v_exp_f32 v133, v133
    v_exp_f32 v134, v134
    v_exp_f32 v135, v135
    v_exp_f32 v136, v136
    v_exp_f32 v137, v137
    v_exp_f32 v138, v138
    v_exp_f32 v139, v139
    v_smfmac_f32_32x32x32_bf16 v[140:155], a[120:123], v[124:131], v9
    s_nop 0
    v_smfmac_f32_32x32x32_bf16 v[140:155], a[124:127], v[132:139], v9
    v_mfma_f32_32x32x16_bf16 v[124:139], a[32:35], v[120:123], v[156:171]
    s_nop 11
    v_exp_f32 v124, v124
    v_exp_f32 v125, v125
    v_exp_f32 v126, v126
    v_exp_f32 v127, v127
    v_exp_f32 v128, v128
    v_exp_f32 v129, v129
    v_exp_f32 v130, v130
    v_exp_f32 v131, v131
    v_exp_f32 v132, v132
    v_exp_f32 v133, v133
    v_exp_f32 v134, v134
    v_exp_f32 v135, v135
    v_exp_f32 v136, v136
    v_exp_f32 v137, v137
    v_exp_f32 v138, v138
    v_exp_f32 v139, v139
    v_smfmac_f32_32x32x32_bf16 v[140:155], a[128:131], v[124:131], v9
    s_nop 0
    v_smfmac_f32_32x32x32_bf16 v[140:155], a[132:135], v[132:139], v9
    v_mfma_f32_32x32x16_bf16 v[124:139], a[36:39], v[120:123], v[156:171]
    s_nop 11
    v_exp_f32 v124, v124
    v_exp_f32 v125, v125
    v_exp_f32 v126, v126
    v_exp_f32 v127, v127
    v_exp_f32 v128, v128
    v_exp_f32 v129, v129
    v_exp_f32 v130, v130
    v_exp_f32 v131, v131
    v_exp_f32 v132, v132
    v_exp_f32 v133, v133
    v_exp_f32 v134, v134
    v_exp_f32 v135, v135
    v_exp_f32 v136, v136
    v_exp_f32 v137, v137
    v_exp_f32 v138, v138
    v_exp_f32 v139, v139
    v_smfmac_f32_32x32x32_bf16 v[140:155], a[136:139], v[124:131], v9
    s_nop 0
    v_smfmac_f32_32x32x32_bf16 v[140:155], a[140:143], v[132:139], v9
    v_mfma_f32_32x32x16_bf16 v[124:139], a[40:43], v[120:123], v[156:171]
    s_nop 11
    v_exp_f32 v124, v124
    v_exp_f32 v125, v125
    v_exp_f32 v126, v126
    v_exp_f32 v127, v127
    v_exp_f32 v128, v128
    v_exp_f32 v129, v129
    v_exp_f32 v130, v130
    v_exp_f32 v131, v131
    v_exp_f32 v132, v132
    v_exp_f32 v133, v133
    v_exp_f32 v134, v134
    v_exp_f32 v135, v135
    v_exp_f32 v136, v136
    v_exp_f32 v137, v137
    v_exp_f32 v138, v138
    v_exp_f32 v139, v139
    v_smfmac_f32_32x32x32_bf16 v[140:155], a[144:147], v[124:131], v9
    s_nop 0
    v_smfmac_f32_32x32x32_bf16 v[140:155], a[148:151], v[132:139], v9
    v_mfma_f32_32x32x16_bf16 v[124:139], a[44:47], v[120:123], v[156:171]
    s_nop 11
    v_exp_f32 v124, v124
    v_exp_f32 v125, v125
    v_exp_f32 v126, v126
    v_exp_f32 v127, v127
    v_exp_f32 v128, v128
    v_exp_f32 v129, v129
    v_exp_f32 v130, v130
    v_exp_f32 v131, v131
    v_exp_f32 v132, v132
    v_exp_f32 v133, v133
    v_exp_f32 v134, v134
    v_exp_f32 v135, v135
    v_exp_f32 v136, v136
    v_exp_f32 v137, v137
    v_exp_f32 v138, v138
    v_exp_f32 v139, v139
    v_smfmac_f32_32x32x32_bf16 v[140:155], a[152:155], v[124:131], v9
    s_nop 0
    v_smfmac_f32_32x32x32_bf16 v[140:155], a[156:159], v[132:139], v9
    v_mfma_f32_32x32x16_bf16 v[124:139], a[48:51], v[120:123], v[156:171]
    s_nop 11
    v_exp_f32 v124, v124
    v_exp_f32 v125, v125
    v_exp_f32 v126, v126
    v_exp_f32 v127, v127
    v_exp_f32 v128, v128
    v_exp_f32 v129, v129
    v_exp_f32 v130, v130
    v_exp_f32 v131, v131
    v_exp_f32 v132, v132
    v_exp_f32 v133, v133
    v_exp_f32 v134, v134
    v_exp_f32 v135, v135
    v_exp_f32 v136, v136
    v_exp_f32 v137, v137
    v_exp_f32 v138, v138
    v_exp_f32 v139, v139
    v_smfmac_f32_32x32x32_bf16 v[140:155], a[160:163], v[124:131], v9
    s_nop 0
    v_smfmac_f32_32x32x32_bf16 v[140:155], a[164:167], v[132:139], v9
    v_mfma_f32_32x32x16_bf16 v[124:139], a[52:55], v[120:123], v[156:171]
    s_nop 11
    v_exp_f32 v124, v124
    v_exp_f32 v125, v125
    v_exp_f32 v126, v126
    v_exp_f32 v127, v127
    v_exp_f32 v128, v128
    v_exp_f32 v129, v129
    v_exp_f32 v130, v130
    v_exp_f32 v131, v131
    v_exp_f32 v132, v132
    v_exp_f32 v133, v133
    v_exp_f32 v134, v134
    v_exp_f32 v135, v135
    v_exp_f32 v136, v136
    v_exp_f32 v137, v137
    v_exp_f32 v138, v138
    v_exp_f32 v139, v139
    v_smfmac_f32_32x32x32_bf16 v[140:155], a[168:171], v[124:131], v9
    s_nop 0
    v_smfmac_f32_32x32x32_bf16 v[140:155], a[172:175], v[132:139], v9
    v_mfma_f32_32x32x16_bf16 v[124:139], a[56:59], v[120:123], v[156:171]
    s_nop 11
    v_exp_f32 v124, v124
    v_exp_f32 v125, v125
    v_exp_f32 v126, v126
    v_exp_f32 v127, v127
    v_exp_f32 v128, v128
    v_exp_f32 v129, v129
    v_exp_f32 v130, v130
    v_exp_f32 v131, v131
    v_exp_f32 v132, v132
    v_exp_f32 v133, v133
    v_exp_f32 v134, v134
    v_exp_f32 v135, v135
    v_exp_f32 v136, v136
    v_exp_f32 v137, v137
    v_exp_f32 v138, v138
    v_exp_f32 v139, v139
    v_smfmac_f32_32x32x32_bf16 v[140:155], a[176:179], v[124:131], v9
    s_nop 0
    v_smfmac_f32_32x32x32_bf16 v[140:155], a[180:183], v[132:139], v9
    v_mfma_f32_32x32x16_bf16 v[124:139], a[60:63], v[120:123], v[156:171]
    s_nop 11
    v_exp_f32 v124, v124
    v_exp_f32 v125, v125
    v_exp_f32 v126, v126
    v_exp_f32 v127, v127
    v_exp_f32 v128, v128
    v_exp_f32 v129, v129
    v_exp_f32 v130, v130
    v_exp_f32 v131, v131
    v_exp_f32 v132, v132
    v_exp_f32 v133, v133
    v_exp_f32 v134, v134
    v_exp_f32 v135, v135
    v_exp_f32 v136, v136
    v_exp_f32 v137, v137
    v_exp_f32 v138, v138
    v_exp_f32 v139, v139
    v_smfmac_f32_32x32x32_bf16 v[140:155], a[184:187], v[124:131], v9
    s_nop 0
    v_smfmac_f32_32x32x32_bf16 v[140:155], a[188:191], v[132:139], v9
    s_nop 11
    ds_write_b128 v174, v[140:143]
    ds_write_b128 v174, v[144:147] offset:1024
    ds_write_b32 v175, v148
    v_add_u32 v174, 8192, v174
    v_add_u32 v175, 1024, v175
    v_add_u32 v173, 128, v173
    s_add_u32 s96, s96, 1024
    s_add_u32 s97, s97, 1
    s_cmp_lt_u32 s97, 4
    s_cbranch_scc1 att_s2
    s_waitcnt lgkmcnt(0)
    s_barrier
    v_and_b32 v16, 0x1f0, v0
    v_add_u32 v16, 131072, v16
    s_lshl_b32 s22, s3, 10
    v_add_u32 v13, s22, v16
    ds_read_b128 v[124:127], v16 offset:0
    ds_read_b128 v[128:131], v16 offset:1024
    ds_read_b128 v[132:135], v16 offset:2048
    ds_read_b128 v[136:139], v16 offset:3072
    ds_read_b128 v[140:143], v13
    s_waitcnt lgkmcnt(0)
    v_add_f32 v140, v140, v141
    v_add_f32 v142, v142, v143
    v_add_f32 v140, v140, v142
    v_add_f32 v124, v124, v125
    v_add_f32 v126, v126, v127
    v_add_f32 v124, v124, v126
    v_add_f32 v128, v128, v129
    v_add_f32 v130, v130, v131
    v_add_f32 v128, v128, v130
    v_add_f32 v132, v132, v133
    v_add_f32 v134, v134, v135
    v_add_f32 v132, v132, v134
    v_add_f32 v136, v136, v137
    v_add_f32 v138, v138, v139
    v_add_f32 v136, v136, v138
    v_rcp_f32 v12, v140
    s_mov_b32 s96, s62
    s_mov_b32 s97, s63
    s_lshr_b32 s62, s5, 1
    s_lshl_b32 s62, s62, 2
    s_add_u32 s62, s62, s3
    s_lshl_b32 s62, s62, 15
    s_add_u32 s62, s62, 2359296
    s_add_u32 s63, s62, 16384
    s_mov_b64 s[28:29], s[8:9]
    s_cmp_lt_u32 s5, 28
    s_cselect_b32 s30, s10, 0
    buffer_load_dwordx4 v[120:123], v0, s[28:31], s62 offen offset:0 sc1
    buffer_load_dwordx4 v[124:127], v0, s[28:31], s62 offen offset:1024 sc1
    buffer_load_dwordx4 v[128:131], v0, s[28:31], s62 offen offset:2048 sc1
    buffer_load_dwordx4 v[132:135], v0, s[28:31], s62 offen offset:3072 sc1
    buffer_load_dwordx4 v[136:139], v252, s[28:31], s62 offen offset:0 sc1
    buffer_load_dwordx4 v[140:143], v252, s[28:31], s62 offen offset:1024 sc1
    buffer_load_dwordx4 v[144:147], v252, s[28:31], s62 offen offset:2048 sc1
    buffer_load_dwordx4 v[148:151], v252, s[28:31], s62 offen offset:3072 sc1
    buffer_load_dwordx4 v[152:155], v253, s[28:31], s62 offen offset:0 sc1
    buffer_load_dwordx4 v[156:159], v253, s[28:31], s62 offen offset:1024 sc1
    buffer_load_dwordx4 v[160:163], v253, s[28:31], s62 offen offset:2048 sc1
    buffer_load_dwordx4 v[164:167], v253, s[28:31], s62 offen offset:3072 sc1
    buffer_load_dwordx4 v[168:171], v254, s[28:31], s62 offen offset:0 sc1
    buffer_load_dwordx4 v[172:175], v254, s[28:31], s62 offen offset:1024 sc1
    buffer_load_dwordx4 v[176:179], v254, s[28:31], s62 offen offset:2048 sc1
    buffer_load_dwordx4 v[180:183], v254, s[28:31], s62 offen offset:3072 sc1
    buffer_load_dwordx4 v[184:187], v0, s[28:31], s63 offen offset:0 sc1
    buffer_load_dwordx4 v[188:191], v0, s[28:31], s63 offen offset:1024 sc1
    buffer_load_dwordx4 v[192:195], v0, s[28:31], s63 offen offset:2048 sc1
    buffer_load_dwordx4 v[196:199], v0, s[28:31], s63 offen offset:3072 sc1
    buffer_load_dwordx4 v[200:203], v252, s[28:31], s63 offen offset:0 sc1
    buffer_load_dwordx4 v[204:207], v252, s[28:31], s63 offen offset:1024 sc1
    buffer_load_dwordx4 v[208:211], v252, s[28:31], s63 offen offset:2048 sc1
    buffer_load_dwordx4 v[212:215], v252, s[28:31], s63 offen offset:3072 sc1
    buffer_load_dwordx4 v[216:219], v253, s[28:31], s63 offen offset:0 sc1
    buffer_load_dwordx4 v[220:223], v253, s[28:31], s63 offen offset:1024 sc1
    buffer_load_dwordx4 v[224:227], v253, s[28:31], s63 offen offset:2048 sc1
    buffer_load_dwordx4 v[228:231], v253, s[28:31], s63 offen offset:3072 sc1
    buffer_load_dwordx4 v[232:235], v254, s[28:31], s63 offen offset:0 sc1
    buffer_load_dwordx4 v[236:239], v254, s[28:31], s63 offen offset:1024 sc1
    buffer_load_dwordx4 v[240:243], v254, s[28:31], s63 offen offset:2048 sc1
    buffer_load_dwordx4 v[244:247], v254, s[28:31], s63 offen offset:3072 sc1
    s_mov_b32 s62, s96
    s_mov_b32 s63, s97
    s_waitcnt vmcnt(0)
    s_cmp_eq_u32 s79, 0
    s_cbranch_scc1 att_ret0
    buffer_load_dwordx4 a[0:3], v0, s[12:15], s62 offen offset:0 sc1
    buffer_load_dwordx4 a[4:7], v0, s[12:15], s62 offen offset:1024 sc1
    buffer_load_dwordx4 a[8:11], v0, s[12:15], s62 offen offset:2048 sc1
    buffer_load_dwordx4 a[12:15], v0, s[12:15], s62 offen offset:3072 sc1
    buffer_load_dwordx4 a[16:19], v252, s[12:15], s62 offen offset:0 sc1
    buffer_load_dwordx4 a[20:23], v252, s[12:15], s62 offen offset:1024 sc1
    buffer_load_dwordx4 a[24:27], v252, s[12:15], s62 offen offset:2048 sc1
    buffer_load_dwordx4 a[28:31], v252, s[12:15], s62 offen offset:3072 sc1
    buffer_load_dwordx4 a[32:35], v253, s[8:11], s66 offen offset:0 sc1
    buffer_load_dwordx4 a[36:39], v253, s[8:11], s66 offen offset:1024 sc1
    buffer_load_dwordx4 a[40:43], v253, s[8:11], s66 offen offset:2048 sc1
    buffer_load_dwordx4 a[44:47], v253, s[8:11], s66 offen offset:3072 sc1
    buffer_load_dwordx4 a[64:67], v0, s[8:11], s67 offen offset:0 sc1
    buffer_load_dwordx4 a[68:71], v0, s[8:11], s67 offen offset:1024 sc1
    buffer_load_dwordx4 a[72:75], v0, s[8:11], s67 offen offset:2048 sc1
    buffer_load_dwordx4 a[76:79], v0, s[8:11], s67 offen offset:3072 sc1
    buffer_load_dwordx4 a[80:83], v252, s[8:11], s67 offen offset:0 sc1
    buffer_load_dwordx4 a[84:87], v252, s[8:11], s67 offen offset:1024 sc1
    buffer_load_dwordx4 a[88:91], v252, s[8:11], s67 offen offset:2048 sc1
    buffer_load_dwordx4 a[92:95], v252, s[8:11], s67 offen offset:3072 sc1
    buffer_load_dwordx4 a[96:99], v253, s[8:11], s67 offen offset:0 sc1
    buffer_load_dwordx4 a[100:103], v253, s[8:11], s67 offen offset:1024 sc1
    buffer_load_dwordx4 a[104:107], v253, s[8:11], s67 offen offset:2048 sc1
    buffer_load_dwordx4 a[108:111], v253, s[8:11], s67 offen offset:3072 sc1
    buffer_load_dwordx4 a[112:115], v254, s[8:11], s67 offen offset:0 sc1
    buffer_load_dwordx4 a[116:119], v254, s[8:11], s67 offen offset:1024 sc1
    buffer_load_dwordx4 a[120:123], v254, s[8:11], s67 offen offset:2048 sc1
    buffer_load_dwordx4 a[124:127], v254, s[8:11], s67 offen offset:3072 sc1
    buffer_load_dwordx4 a[128:131], v0, s[8:11], s68 offen offset:0 sc1
    buffer_load_dwordx4 a[132:135], v0, s[8:11], s68 offen offset:1024 sc1
    buffer_load_dwordx4 a[136:139], v0, s[8:11], s68 offen offset:2048 sc1
    buffer_load_dwordx4 a[140:143], v0, s[8:11], s68 offen offset:3072 sc1
    buffer_load_dwordx4 a[144:147], v252, s[8:11], s68 offen offset:0 sc1
    buffer_load_dwordx4 a[148:151], v252, s[8:11], s68 offen offset:1024 sc1
    buffer_load_dwordx4 a[152:155], v252, s[8:11], s68 offen offset:2048 sc1
    buffer_load_dwordx4 a[156:159], v252, s[8:11], s68 offen offset:3072 sc1
    buffer_load_dwordx4 a[160:163], v253, s[8:11], s68 offen offset:0 sc1
    s_lshl_b32 s22, s3, 13
    s_add_u32 s22, s22, 98304
    v_add_u32 v17, s22, v0
    ds_read_b128 v[88:91], v17 offset:0
    ds_read_b128 v[92:95], v17 offset:1024
    ds_read_b128 v[96:99], v17 offset:2048
    ds_read_b128 v[100:103], v17 offset:3072
    ds_read_b128 v[104:107], v17 offset:4096
    ds_read_b128 v[108:111], v17 offset:5120
    ds_read_b128 v[112:115], v17 offset:6144
    ds_read_b128 v[116:119], v17 offset:7168
    s_waitcnt vmcnt(0) lgkmcnt(0)
    s_branch att_ret1
CODE_END:
.section .rodata,"a"
.p2align 6
.amdhsa_kernel interleave_layers__mha_block__dense_activation_silu__prompt_kernel
  .amdhsa_next_free_vgpr 512
  .amdhsa_next_free_sgpr 102
  .amdhsa_accum_offset 256
  .amdhsa_group_segment_fixed_size 0
  .amdhsa_kernarg_size 72
  .amdhsa_user_sgpr_count 2
  .amdhsa_user_sgpr_kernarg_segment_ptr 1
  .amdhsa_system_sgpr_workgroup_id_x 1
.end_amdhsa_kernel
```
